```python
import torch

def _softmax(x, axis=-1):
    return torch.softmax(x, dim=axis)
def _gelu(x):
    return torch.nn.functional.gelu(x, approximate="tanh")
def _silu(x):
    return torch.nn.functional.silu(x)
def _sigmoid(x):
    return torch.sigmoid(x)
def _layernorm(x, axis=-1, eps=1e-5):
    m = x.mean(dim=axis, keepdim=True)
    v = x.var(dim=axis, keepdim=True, unbiased=False)
    return (x - m) / torch.sqrt(v + eps)
def _scatter_add(tgt, idx, src, axis=0):
    return tgt.clone().index_add_(axis, idx, src)
def _segment_sum(src, seg, n):
    out = torch.zeros((n,) + src.shape[1:], dtype=src.dtype)
    return out.index_add_(0, seg, src)
def _pad(x, pw):
    flat = tuple(v for pair in reversed(pw) for v in pair)
    return torch.nn.functional.pad(x, flat)

kernel_name = 'gated_mix__linear_kernel_hedgehog__swiglu_ffn__prompt'

def setup_inputs():

    _w = (lambda a: (lambda t: t.to(torch.bfloat16) if t.is_floating_point() else t)(torch.as_tensor(a)))
    def _A_setup():
        B, S, D, H = 1, 2048, 640, 32
        Dh = D // H
        return {
            "x": _w((lambda *s: torch.randn(*s, dtype=torch.bfloat16) * 0.05)(B, S, D)),
            "wqkv": _w((lambda *s: torch.randn(*s, dtype=torch.bfloat16) * 0.8)(D, 3 * D)),
            "w_phi": _w((lambda *s: torch.randn(*s, dtype=torch.bfloat16) * 0.8)(H, Dh, Dh) * (Dh ** -0.5)),
            "wo": _w((lambda *s: torch.randn(*s, dtype=torch.bfloat16) * 0.05)(D, D)),
        }
    _A_in = _A_setup()

    def _B_setup():
        B, S, D, F = 1, 2048, 640, 1728
        return {
            "x": _w((lambda *s: torch.randn(*s, dtype=torch.bfloat16) * 0.05)(B, S, D)),
            "w_gate": _w((lambda *s: torch.randn(*s, dtype=torch.bfloat16) * 0.05)(D, F)),
            "w_up": _w((lambda *s: torch.randn(*s, dtype=torch.bfloat16) * 0.05)(D, F)),
            "w_down": _w((lambda *s: torch.randn(*s, dtype=torch.bfloat16) * 0.05)(F, D)),
        }
    _B_in = _B_setup()

    return {
        "A_x": _A_in["x"],
        "A_wqkv": _A_in["wqkv"],
        "A_w_phi": _A_in["w_phi"],
        "A_wo": _A_in["wo"],
        "B_x": _B_in["x"],
        "B_w_gate": _B_in["w_gate"],
        "B_w_up": _B_in["w_up"],
        "B_w_down": _B_in["w_down"],
        "gate_w": _w((lambda *s: torch.randn(*s, dtype=torch.bfloat16) * 0.05)(640) * 16.0),
    }

def reference(A_x, A_wqkv, A_w_phi, A_wo, B_x, B_w_gate, B_w_up, B_w_down, gate_w):
    def _A_ref(x, wqkv, w_phi, wo):
        B, S, D = x.shape
        H = 32; Dh = D // H
        qkv = (lambda x, *d: x.permute(*d))((x @ wqkv).reshape(B, S, 3, H, Dh), 2, 0, 3, 1, 4)
        q, k, v = qkv[0], qkv[1], qkv[2]
        pq = torch.einsum("bhsd,hdf->bhsf", q, w_phi)
        pk = torch.einsum("bhsd,hdf->bhsf", k, w_phi)
        phi_q = torch.concatenate([_softmax(pq, axis=-1), _softmax(-pq, axis=-1)], axis=-1)
        phi_k = torch.concatenate([_softmax(pk, axis=-1), _softmax(-pk, axis=-1)], axis=-1)
        kv = torch.einsum("bhsf,bhsd->bhfd", phi_k, v)
        z  = torch.einsum("bhsf->bhf", phi_k)
        num = torch.einsum("bhqf,bhfd->bhqd", phi_q, kv)
        den = torch.einsum("bhqf,bhf->bhq", phi_q, z)[..., None] + 1e-6
        o = num / den
        return (lambda x, *d: x.permute(*d))(o, 0, 2, 1, 3).reshape(B, S, D) @ wo

    def _B_ref(x, w_gate, w_up, w_down):
        g = _silu(x @ w_gate)
        u = x @ w_up
        return (g * u) @ w_down

    x = A_x
    g = _sigmoid((x * gate_w).sum(-1, keepdims=True))
    a = _A_ref(x, A_wqkv, A_w_phi, A_wo)
    b = _B_ref(x, B_w_gate, B_w_up, B_w_down)
    return g * a + (1 - g) * b
```

```asm
; @launch grid=(256,1,1) block=(512,1,1) lds=163840
.amdgcn_target "amdgcn-amd-amdhsa--gfx950"
.text
.globl gated_mix__linear_kernel_hedgehog__swiglu_ffn__prompt_kernel
.p2align 8
.type gated_mix__linear_kernel_hedgehog__swiglu_ffn__prompt_kernel,@function
gated_mix__linear_kernel_hedgehog__swiglu_ffn__prompt_kernel:
  s_cmp_ge_u32 s2, 256
  s_cbranch_scc1 K_END
  s_load_dwordx16 s[16:31], s[0:1], 0
  s_load_dwordx8 s[32:39], s[0:1], 64
  v_lshrrev_b32 v2, 6, v0
  v_mov_b32 v1, v0
  v_readfirstlane_b32 s3, v2
  v_and_b32 v0, 63, v0
  s_bfe_u32 s75, s2, 0x30003
  s_lshr_b32 s76, s2, 6
  s_and_b32 s63, s2, 1
  s_lshl_b32 s63, s63, 2
  s_add_u32 s63, s63, s76
  s_bfe_u32 s67, s2, 0x20001
  s_and_b32 s71, s3, 3
  s_lshr_b32 s72, s3, 2
  v_lshrrev_b32 v7, 4, v0
  v_bfe_u32 v8, v0, 2, 2
  v_and_b32 v9, 3, v0
  v_and_b32 v10, 15, v0
  v_lshrrev_b32 v2, 3, v0
  v_mul_u32_u24 v2, 1280, v2
  v_and_b32 v3, 7, v0
  v_xor_b32 v3, v3, v7
  v_lshl_add_u32 v11, v3, 4, v2
  v_xor_b32 v3, 4, v3
  v_lshl_add_u32 v12, v3, 4, v2
  v_add_u32 v12, 9216, v12
  v_add_u32 v13, 18432, v11
  v_add_u32 v14, 18432, v12
  s_mul_i32 s64, s63, 327680
  s_mul_i32 s68, s3, 40960
  s_add_u32 s64, s64, s68
  s_lshl_b32 s66, s3, 12
  s_add_u32 s62, s75, s76
  s_and_b32 s62, s62, 1
  s_lshl_b32 s68, s62, 7
  s_add_u32 s64, s64, s68
  v_lshlrev_b32 v4, 3, v1
  v_min_u32 v4, 2808, v4
  v_add_u32 v4, 161024, v4
  v_mov_b32 v32, 0
  v_mov_b32 v33, 0
  ds_write_b64 v4, v[32:33]
  s_mul_i32 s73, s67, 9
  s_add_u32 s73, s73, 1
  s_lshr_b32 s73, s73, 1
  s_add_u32 s73, s73, s75
  s_sub_u32 s73, s73, 3
  s_and_b32 s68, s67, 1
  s_add_u32 s68, s68, s75
  s_mov_b32 s60, 0x3fb8aa3b
  s_mov_b32 s61, 0x3fb8aa3b
  s_lshr_b32 s9, s3, 1
  s_mov_b32 s98, 2621440
  s_movk_i32 s95, 128
  s_cmp_eq_u32 s9, 1
  s_cselect_b32 s98, 2457600, s98
  s_cselect_b32 s95, 245760, s95
  s_cmp_ge_u32 s9, 2
  s_cselect_b32 s98, 2211840, s98
  s_cselect_b32 s95, 221184, s95
  s_mov_b32 s99, 0x20000
  s_cmp_eq_u32 s9, 0
  s_movk_i32 s7, 128
  s_cselect_b32 s5, 1280, s7
  s_cselect_b32 s6, 640, s7
  s_cselect_b32 s7, 512, 0
  v_mul_u32_u24 v22, s5, v0
  v_mul_u32_u24 v23, s6, v0
  v_and_b32 v2, 1, v0
  v_mul_u32_u24 v2, s7, v2
  v_sub_u32 v23, v23, v2
  s_and_b32 s4, s3, 1
  s_lshl1_add_u32 s101, s2, s4
  s_lshl_b32 s101, s101, 3
  s_mul_i32 s101, s101, s6
  s_and_b32 s100, s2, 7
  s_lshl2_add_u32 s100, s100, s76
  s_lshl1_add_u32 s100, s100, s4
  s_lshl_b32 s100, s100, 5
  s_mul_i32 s100, s100, s5
  v_add_u32 v6, s101, v23
  s_mov_b32 s42, 2621440
  s_mov_b32 s43, 0x20000
  s_mov_b32 m0, s66
  s_waitcnt lgkmcnt(0)
  s_cmp_eq_u32 s9, 1
  s_cselect_b64 s[96:97], s[18:19], s[16:17]
  s_cmp_eq_u32 s9, 2
  s_cselect_b64 s[96:97], s[26:27], s[96:97]
  s_cmp_eq_u32 s9, 3
  s_cselect_b64 s[96:97], s[28:29], s[96:97]
  s_and_b32 s97, s97, 0xffff
  s_mov_b64 exec, 0xff
  buffer_load_dword v19, v6, s[96:99], 0 offen
  s_mov_b64 exec, -1
  s_mov_b32 s40, s16
  s_and_b32 s41, s17, 0xffff
  s_cmp_eq_u32 s68, 8
  s_cbranch_scc1 NOX0
  s_barrier
  buffer_load_dwordx4 v11, s[40:43], s64 offen offset:0 lds
  buffer_load_dwordx4 v12, s[40:43], s64 offen offset:1024 lds
  buffer_load_dwordx4 v13, s[40:43], s64 offen offset:2048 lds
  buffer_load_dwordx4 v14, s[40:43], s64 offen offset:3072 lds
NOX0:
  s_mov_b32 s48, s38
  s_and_b32 s49, s39, 0xffff
  s_mov_b32 s50, 23068672
  s_mov_b32 s51, 0x20000
  s_mov_b32 s84, s36
  s_and_b32 s85, s37, 0xffff
  s_mov_b32 s86, 256
  s_mov_b32 s87, 0x20000
  s_cmp_lg_u32 s3, 7
  s_cbranch_scc1 NOCPF
  s_getpc_b64 s[90:91]
CPF_PC:
  s_lshr_b32 s6, s2, 3
  s_mul_i32 s6, s6, 1536
  v_lshlrev_b32 v2, 7, v0
  v_add_u32 v2, s6, v2
  v_min_u32 v2, K_LAST-CPF_PC, v2
  s_mov_b64 exec, 0xfff
  global_load_dword v31, v2, s[90:91]
  s_mov_b64 exec, -1
NOCPF:
  s_lshl_b32 s4, s62, 8
  s_sub_u32 s6, 128, s4
  s_add_u32 s7, s4, 128
  s_cmp_lt_u32 s75, 3
  s_cbranch_scc1 R_QKV
  s_cmp_eq_u32 s68, 8
  s_cbranch_scc1 R_SPARE
  s_mul_i32 s70, s73, 192
  s_bitcmp1_b32 s3, 0
  s_cselect_b32 s44, s28, s26
  s_cselect_b32 s45, s29, s27
  s_and_b32 s45, s45, 0xffff
  s_mov_b32 s46, 2211840
  s_mov_b32 s47, 0x20000
  s_bfe_u32 s67, s3, 0x10001
  s_lshl_b32 s68, s67, 1
  v_add_u32 v2, 0, v0
  v_mul_u32_u24 v3, 43, v2
  v_lshrrev_b32 v3, 9, v3
  v_mul_u32_u24 v4, 12, v3
  v_sub_u32 v4, v2, v4
  v_lshrrev_b32 v5, 2, v4
  v_cmp_eq_u32 vcc, 1, v5
  v_mov_b32 v5, s68
  v_mov_b32 v6, s67
  v_cndmask_b32 v5, v5, v6, vcc
  v_xor_b32 v4, v4, v5
  v_mul_u32_u24 v3, 3456, v3
  v_lshl_add_u32 v24, v4, 4, v3
  v_add_u32 v2, 64, v0
  v_mul_u32_u24 v3, 43, v2
  v_lshrrev_b32 v3, 9, v3
  v_mul_u32_u24 v4, 12, v3
  v_sub_u32 v4, v2, v4
  v_lshrrev_b32 v5, 2, v4
  v_cmp_eq_u32 vcc, 1, v5
  v_mov_b32 v5, s68
  v_mov_b32 v6, s67
  v_cndmask_b32 v5, v5, v6, vcc
  v_xor_b32 v4, v4, v5
  v_mul_u32_u24 v3, 3456, v3
  v_lshl_add_u32 v25, v4, 4, v3
  v_subrev_u32 v25, 1024, v25
  s_lshr_b32 s67, s3, 1
  s_mul_i32 s65, s67, 27648
  s_add_u32 s65, s65, s70
  s_mul_i32 s74, s67, 1536
  s_and_b32 s68, s3, 1
  s_mul_i32 s68, s68, 6144
  s_add_u32 s74, s74, s68
  s_mul_i32 s68, s62, 221184
  s_add_u32 s65, s65, s68
  s_lshl_b32 s68, s68, 1
  s_sub_u32 s54, 110592, s68
  s_add_u32 s55, s68, 110592
  s_add_u32 m0, s74, 98304
  s_nop 0
  buffer_load_dwordx4 v24, s[44:47], s65 offen  lds
  s_mov_b32 exec_hi, 0
  buffer_load_dwordx4 v25, s[44:47], s65 offen offset:1024  lds
  s_mov_b32 exec_hi, -1
  s_add_u32 m0, s74, 110592
  s_add_u32 s65, s65, 110592
  buffer_load_dwordx4 v24, s[44:47], s65 offen  lds
  s_mov_b32 exec_hi, 0
  buffer_load_dwordx4 v25, s[44:47], s65 offen offset:1024  lds
  s_mov_b32 exec_hi, -1
  v_lshrrev_b32 v2, 1, v10
  v_xor_b32 v2, v2, v7
  v_lshlrev_b32 v2, 4, v2
  v_lshl_add_u32 v2, v10, 7, v2
  s_lshl_b32 s67, s71, 13
  v_add_u32 v15, s67, v2
  v_xor_b32 v16, 64, v15
  v_add_u32 v17, 0x10000, v15
  v_add_u32 v18, 0x10000, v16
  v_lshl_add_u32 v2, v7, 3, v8
  v_mul_u32_u24 v2, 192, v2
  v_add_u32 v2, 98304, v2
  v_and_b32 v3, 1, v7
  v_lshlrev_b32 v4, 5, v3
  v_lshl_add_u32 v4, v9, 3, v4
  s_lshl_b32 s67, s72, 7
  v_add3_u32 v26, v2, v4, s67
  v_xor_b32 v27, 32, v26
  v_and_b32 v4, 2, v9
  v_add_u32 v4, s72, v4
  v_xor_b32 v4, v4, v3
  v_lshlrev_b32 v4, 4, v4
  v_and_b32 v5, 1, v9
  v_lshl_add_u32 v4, v5, 3, v4
  v_add3_u32 v28, v2, v4, 64
  s_barrier
  s_mul_i32 s4, s95, 2
  s_add_u32 s4, s4, s101
  v_add_u32 v21, s4, v23
  s_mov_b64 exec, 0xff
  buffer_load_dword v19, v21, s[96:99], 0 offen
  s_mov_b64 exec, -1
  s_bfe_u32 s16, s2, 0x20001
  s_lshr_b32 s4, s2, 5
  s_lshl3_add_u32 s16, s16, s4
  s_lshr_b32 s17, s2, 3
  s_lshr_b32 s4, s2, 6
  s_add_u32 s17, s17, s4
  s_and_b32 s17, s17, 3
  s_and_b32 s4, s2, 1
  s_lshl2_add_u32 s17, s4, s17
  v_lshlrev_b32 v20, 4, v0
  v_add_u32 v21, 4096, v20
  s_lshl3_add_u32 s19, s71, s17
  s_mul_i32 s19, s19, 5120
  s_add_u32 s19, s19, 10485760
  s_mov_b32 s56, s38
  s_and_b32 s57, s39, 0xffff
  s_mul_i32 s58, s72, 23068672
  s_mov_b32 s59, 0x20000
  s_mul_i32 s21, s71, 5120
  s_mul_i32 s22, s72, 163840
  s_mul_i32 s23, s72, 20480
  s_xor_b32 s4, s72, 1
  s_mul_i32 s20, s4, 655360
  s_add_u32 s20, s20, s19
  s_mul_i32 s18, s16, 74
  s_mul_i32 s4, s4, 16
  s_add_u32 s18, s18, s4
  s_add_u32 s18, s18, s71
  s_lshl_b32 s18, s18, 12
  s_lshr_b32 s4, s17, 1
  s_mul_i32 s4, s4, 5
  s_mul_i32 s80, s16, 74
  s_add_u32 s80, s80, s4
  s_add_u32 s80, s80, 54
  s_lshl2_add_u32 s80, s80, s71
  s_lshl_b32 s80, s80, 10
  s_and_b32 s4, s17, 1
  s_mul_i32 s79, s4, 12288
  s_add_u32 s79, s79, s80
  s_lshl_b32 s4, s4, 9
  s_add_u32 s80, s80, s4
  s_add_u32 s80, s80, 8192
  s_lshl_b32 s78, s16, 7
  s_add_u32 s78, s78, 19075072
  s_waitcnt vmcnt(3)
  s_barrier
  ds_read_b128 v[32:35], v15 offset:0
  ds_read_b128 v[36:39], v15 offset:2048
  ds_read_b128 v[40:43], v15 offset:4096
  ds_read_b128 v[44:47], v15 offset:6144
  ds_read_b64_tr_b16 v[48:49], v26 offset:0
  ds_read_b64_tr_b16 v[50:51], v26 offset:768
  ds_read_b64_tr_b16 v[52:53], v27 offset:0
  ds_read_b64_tr_b16 v[54:55], v27 offset:768
  ds_read_b64_tr_b16 v[56:57], v28 offset:0
  ds_read_b64_tr_b16 v[58:59], v28 offset:768
  ds_read_b64_tr_b16 v[60:61], v26 offset:6144
  ds_read_b64_tr_b16 v[62:63], v26 offset:6912
  ds_read_b64_tr_b16 v[64:65], v27 offset:6144
  ds_read_b64_tr_b16 v[66:67], v27 offset:6912
  ds_read_b64_tr_b16 v[68:69], v28 offset:6144
  ds_read_b64_tr_b16 v[70:71], v28 offset:6912
  s_add_u32 m0, s66, 32768
  s_add_u32 s64, s64, s6
  buffer_load_dwordx4 v11, s[40:43], s64 offen offset:0  lds
  buffer_load_dwordx4 v12, s[40:43], s64 offen offset:1024  lds
  s_add_u32 m0, s66, 32768
  s_nop 0
  buffer_load_dwordx4 v13, s[40:43], s64 offen offset:2048  lds
  buffer_load_dwordx4 v14, s[40:43], s64 offen offset:3072  lds
  s_add_u32 m0, s74, 122880
  s_add_u32 s65, s65, s54
  buffer_load_dwordx4 v24, s[44:47], s65 offen  lds
  s_mov_b32 exec_hi, 0
  buffer_load_dwordx4 v25, s[44:47], s65 offen offset:1024  lds
  s_mov_b32 exec_hi, -1
  s_waitcnt vmcnt(7) lgkmcnt(0)
  s_barrier
  v_mfma_f32_16x16x32_bf16 v[112:115], v[48:51], v[32:35], 0
  ds_read_b128 v[72:75], v16 offset:0
  ds_read_b128 v[76:79], v16 offset:2048
  v_mfma_f32_16x16x32_bf16 v[116:119], v[48:51], v[36:39], 0
  ds_read_b128 v[80:83], v16 offset:4096
  ds_read_b128 v[84:87], v16 offset:6144
  v_mfma_f32_16x16x32_bf16 v[120:123], v[48:51], v[40:43], 0
  ds_read_b64_tr_b16 v[88:89], v26 offset:12288
  v_mfma_f32_16x16x32_bf16 v[124:127], v[48:51], v[44:47], 0
  ds_read_b64_tr_b16 v[90:91], v26 offset:13056
  ds_read_b64_tr_b16 v[92:93], v27 offset:12288
  v_mfma_f32_16x16x32_bf16 v[128:131], v[52:55], v[32:35], 0
  ds_read_b64_tr_b16 v[94:95], v27 offset:13056
  v_mfma_f32_16x16x32_bf16 v[132:135], v[52:55], v[36:39], 0
  ds_read_b64_tr_b16 v[96:97], v28 offset:12288
  ds_read_b64_tr_b16 v[98:99], v28 offset:13056
  v_mfma_f32_16x16x32_bf16 v[136:139], v[52:55], v[40:43], 0
  ds_read_b64_tr_b16 v[100:101], v26 offset:18432
  v_mfma_f32_16x16x32_bf16 v[140:143], v[52:55], v[44:47], 0
  ds_read_b64_tr_b16 v[102:103], v26 offset:19200
  ds_read_b64_tr_b16 v[104:105], v27 offset:18432
  v_mfma_f32_16x16x32_bf16 v[144:147], v[56:59], v[32:35], 0
  ds_read_b64_tr_b16 v[106:107], v27 offset:19200
  v_mfma_f32_16x16x32_bf16 v[148:151], v[56:59], v[36:39], 0
  ds_read_b64_tr_b16 v[108:109], v28 offset:18432
  ds_read_b64_tr_b16 v[110:111], v28 offset:19200
  v_mfma_f32_16x16x32_bf16 v[152:155], v[56:59], v[40:43], 0
  s_add_u32 m0, s74, 135168
  v_mfma_f32_16x16x32_bf16 v[156:159], v[56:59], v[44:47], 0
  s_add_u32 s65, s65, 110592
  buffer_load_dwordx4 v24, s[44:47], s65 offen  lds
  v_mfma_f32_16x16x32_bf16 v[160:163], v[60:63], v[32:35], 0
  s_mov_b32 exec_hi, 0
  buffer_load_dwordx4 v25, s[44:47], s65 offen offset:1024  lds
  s_mov_b32 exec_hi, -1
  v_mfma_f32_16x16x32_bf16 v[164:167], v[60:63], v[36:39], 0
  s_add_u32 m0, s66, 65536
  s_add_u32 s64, s64, s7
  v_mfma_f32_16x16x32_bf16 v[168:171], v[60:63], v[40:43], 0
  buffer_load_dwordx4 v11, s[40:43], s64 offen offset:0  lds
  v_mfma_f32_16x16x32_bf16 v[172:175], v[60:63], v[44:47], 0
  buffer_load_dwordx4 v12, s[40:43], s64 offen offset:1024  lds
  s_add_u32 m0, s66, 65536
  v_mfma_f32_16x16x32_bf16 v[176:179], v[64:67], v[32:35], 0
  buffer_load_dwordx4 v13, s[40:43], s64 offen offset:2048  lds
  v_mfma_f32_16x16x32_bf16 v[180:183], v[64:67], v[36:39], 0
  buffer_load_dwordx4 v14, s[40:43], s64 offen offset:3072  lds
  s_add_u32 m0, s74, 147456
  v_mfma_f32_16x16x32_bf16 v[184:187], v[64:67], v[40:43], 0
  s_add_u32 s65, s65, s55
  v_mfma_f32_16x16x32_bf16 v[188:191], v[64:67], v[44:47], 0
  buffer_load_dwordx4 v24, s[44:47], s65 offen  lds
  s_mov_b32 exec_hi, 0
  buffer_load_dwordx4 v25, s[44:47], s65 offen offset:1024  lds
  s_mov_b32 exec_hi, -1
  v_mfma_f32_16x16x32_bf16 v[192:195], v[68:71], v[32:35], 0
  s_cmp_eq_u32 s75, 6
  s_cbranch_scc1 T2_1o
T2_1:
  v_mfma_f32_16x16x32_bf16 v[196:199], v[68:71], v[36:39], 0
  s_add_u32 m0, s74, 98304
  s_add_u32 s65, s65, 110592
  v_mfma_f32_16x16x32_bf16 v[200:203], v[68:71], v[40:43], 0
  buffer_load_dwordx4 v24, s[44:47], s65 offen  lds
  v_mfma_f32_16x16x32_bf16 v[204:207], v[68:71], v[44:47], 0
  s_mov_b32 exec_hi, 0
  buffer_load_dwordx4 v25, s[44:47], s65 offen offset:1024  lds
  s_mov_b32 exec_hi, -1
  s_waitcnt vmcnt(10) lgkmcnt(0)
  s_barrier
  v_mfma_f32_16x16x32_bf16 v[112:115], v[88:91], v[72:75], v[112:115]
  ds_read_b128 v[32:35], v15 offset:32768
  ds_read_b128 v[36:39], v15 offset:34816
  v_mfma_f32_16x16x32_bf16 v[116:119], v[88:91], v[76:79], v[116:119]
  ds_read_b128 v[40:43], v15 offset:36864
  v_mfma_f32_16x16x32_bf16 v[120:123], v[88:91], v[80:83], v[120:123]
  ds_read_b128 v[44:47], v15 offset:38912
  v_mfma_f32_16x16x32_bf16 v[124:127], v[88:91], v[84:87], v[124:127]
  ds_read_b64_tr_b16 v[48:49], v26 offset:24576
  v_mfma_f32_16x16x32_bf16 v[128:131], v[92:95], v[72:75], v[128:131]
  ds_read_b64_tr_b16 v[50:51], v26 offset:25344
  v_mfma_f32_16x16x32_bf16 v[132:135], v[92:95], v[76:79], v[132:135]
  ds_read_b64_tr_b16 v[52:53], v27 offset:24576
  v_mfma_f32_16x16x32_bf16 v[136:139], v[92:95], v[80:83], v[136:139]
  ds_read_b64_tr_b16 v[54:55], v27 offset:25344
  v_mfma_f32_16x16x32_bf16 v[140:143], v[92:95], v[84:87], v[140:143]
  ds_read_b64_tr_b16 v[56:57], v28 offset:24576
  v_mfma_f32_16x16x32_bf16 v[144:147], v[96:99], v[72:75], v[144:147]
  ds_read_b64_tr_b16 v[58:59], v28 offset:25344
  v_mfma_f32_16x16x32_bf16 v[148:151], v[96:99], v[76:79], v[148:151]
  ds_read_b64_tr_b16 v[60:61], v26 offset:30720
  v_mfma_f32_16x16x32_bf16 v[152:155], v[96:99], v[80:83], v[152:155]
  ds_read_b64_tr_b16 v[62:63], v26 offset:31488
  v_mfma_f32_16x16x32_bf16 v[156:159], v[96:99], v[84:87], v[156:159]
  ds_read_b64_tr_b16 v[64:65], v27 offset:30720
  v_mfma_f32_16x16x32_bf16 v[160:163], v[100:103], v[72:75], v[160:163]
  ds_read_b64_tr_b16 v[66:67], v27 offset:31488
  v_mfma_f32_16x16x32_bf16 v[164:167], v[100:103], v[76:79], v[164:167]
  ds_read_b64_tr_b16 v[68:69], v28 offset:30720
  v_mfma_f32_16x16x32_bf16 v[168:171], v[100:103], v[80:83], v[168:171]
  ds_read_b64_tr_b16 v[70:71], v28 offset:31488
  v_mfma_f32_16x16x32_bf16 v[172:175], v[100:103], v[84:87], v[172:175]
  s_add_u32 m0, s66, 0
  v_mfma_f32_16x16x32_bf16 v[176:179], v[104:107], v[72:75], v[176:179]
  s_add_u32 s64, s64, s6
  v_mfma_f32_16x16x32_bf16 v[180:183], v[104:107], v[76:79], v[180:183]
  buffer_load_dwordx4 v11, s[40:43], s64 offen offset:0  lds
  v_mfma_f32_16x16x32_bf16 v[184:187], v[104:107], v[80:83], v[184:187]
  buffer_load_dwordx4 v12, s[40:43], s64 offen offset:1024  lds
  v_mfma_f32_16x16x32_bf16 v[188:191], v[104:107], v[84:87], v[188:191]
  s_cmp_eq_u32 s75, 3
  s_cbranch_scc1 T2_2o
T2_2:
  v_mfma_f32_16x16x32_bf16 v[192:195], v[108:111], v[72:75], v[192:195]
  s_add_u32 m0, s74, 110592
  v_mfma_f32_16x16x32_bf16 v[196:199], v[108:111], v[76:79], v[196:199]
  s_add_u32 s65, s65, s54
  v_mfma_f32_16x16x32_bf16 v[200:203], v[108:111], v[80:83], v[200:203]
  buffer_load_dwordx4 v24, s[44:47], s65 offen  lds
  v_mfma_f32_16x16x32_bf16 v[204:207], v[108:111], v[84:87], v[204:207]
  s_mov_b32 exec_hi, 0
  buffer_load_dwordx4 v25, s[44:47], s65 offen offset:1024  lds
  s_mov_b32 exec_hi, -1
  s_waitcnt vmcnt(12) lgkmcnt(0)
  s_barrier
  v_mfma_f32_16x16x32_bf16 v[112:115], v[48:51], v[32:35], v[112:115]
  ds_read_b128 v[72:75], v16 offset:32768
  ds_read_b128 v[76:79], v16 offset:34816
  v_mfma_f32_16x16x32_bf16 v[116:119], v[48:51], v[36:39], v[116:119]
  ds_read_b128 v[80:83], v16 offset:36864
  v_mfma_f32_16x16x32_bf16 v[120:123], v[48:51], v[40:43], v[120:123]
  ds_read_b128 v[84:87], v16 offset:38912
  v_mfma_f32_16x16x32_bf16 v[124:127], v[48:51], v[44:47], v[124:127]
  ds_read_b64_tr_b16 v[88:89], v26 offset:36864
  v_mfma_f32_16x16x32_bf16 v[128:131], v[52:55], v[32:35], v[128:131]
  ds_read_b64_tr_b16 v[90:91], v26 offset:37632
  v_mfma_f32_16x16x32_bf16 v[132:135], v[52:55], v[36:39], v[132:135]
  ds_read_b64_tr_b16 v[92:93], v27 offset:36864
  v_mfma_f32_16x16x32_bf16 v[136:139], v[52:55], v[40:43], v[136:139]
  ds_read_b64_tr_b16 v[94:95], v27 offset:37632
  v_mfma_f32_16x16x32_bf16 v[140:143], v[52:55], v[44:47], v[140:143]
  ds_read_b64_tr_b16 v[96:97], v28 offset:36864
  v_mfma_f32_16x16x32_bf16 v[144:147], v[56:59], v[32:35], v[144:147]
  ds_read_b64_tr_b16 v[98:99], v28 offset:37632
  v_mfma_f32_16x16x32_bf16 v[148:151], v[56:59], v[36:39], v[148:151]
  ds_read_b64_tr_b16 v[100:101], v26 offset:43008
  v_mfma_f32_16x16x32_bf16 v[152:155], v[56:59], v[40:43], v[152:155]
  ds_read_b64_tr_b16 v[102:103], v26 offset:43776
  v_mfma_f32_16x16x32_bf16 v[156:159], v[56:59], v[44:47], v[156:159]
  ds_read_b64_tr_b16 v[104:105], v27 offset:43008
  v_mfma_f32_16x16x32_bf16 v[160:163], v[60:63], v[32:35], v[160:163]
  ds_read_b64_tr_b16 v[106:107], v27 offset:43776
  v_mfma_f32_16x16x32_bf16 v[164:167], v[60:63], v[36:39], v[164:167]
  ds_read_b64_tr_b16 v[108:109], v28 offset:43008
  v_mfma_f32_16x16x32_bf16 v[168:171], v[60:63], v[40:43], v[168:171]
  ds_read_b64_tr_b16 v[110:111], v28 offset:43776
  v_mfma_f32_16x16x32_bf16 v[172:175], v[60:63], v[44:47], v[172:175]
  s_add_u32 m0, s66, 0
  v_mfma_f32_16x16x32_bf16 v[176:179], v[64:67], v[32:35], v[176:179]
  buffer_load_dwordx4 v13, s[40:43], s64 offen offset:2048  lds
  v_mfma_f32_16x16x32_bf16 v[180:183], v[64:67], v[36:39], v[180:183]
  buffer_load_dwordx4 v14, s[40:43], s64 offen offset:3072  lds
  v_mfma_f32_16x16x32_bf16 v[184:187], v[64:67], v[40:43], v[184:187]
  s_cmp_eq_u32 s75, 4
  s_cbranch_scc1 T2_3o
T2_3:
  v_mfma_f32_16x16x32_bf16 v[188:191], v[64:67], v[44:47], v[188:191]
  s_add_u32 m0, s74, 122880
  v_mfma_f32_16x16x32_bf16 v[192:195], v[68:71], v[32:35], v[192:195]
  s_add_u32 s65, s65, 110592
  v_mfma_f32_16x16x32_bf16 v[196:199], v[68:71], v[36:39], v[196:199]
  buffer_load_dwordx4 v24, s[44:47], s65 offen  lds
  v_mfma_f32_16x16x32_bf16 v[200:203], v[68:71], v[40:43], v[200:203]
  s_mov_b32 exec_hi, 0
  buffer_load_dwordx4 v25, s[44:47], s65 offen offset:1024  lds
  s_mov_b32 exec_hi, -1
  v_mfma_f32_16x16x32_bf16 v[204:207], v[68:71], v[44:47], v[204:207]
  s_waitcnt vmcnt(10) lgkmcnt(0)
  s_barrier
  v_mfma_f32_16x16x32_bf16 v[112:115], v[88:91], v[72:75], v[112:115]
  ds_read_b128 v[32:35], v17 offset:0
  ds_read_b128 v[36:39], v17 offset:2048
  v_mfma_f32_16x16x32_bf16 v[116:119], v[88:91], v[76:79], v[116:119]
  ds_read_b128 v[40:43], v17 offset:4096
  v_mfma_f32_16x16x32_bf16 v[120:123], v[88:91], v[80:83], v[120:123]
  ds_read_b128 v[44:47], v17 offset:6144
  v_mfma_f32_16x16x32_bf16 v[124:127], v[88:91], v[84:87], v[124:127]
  ds_read_b64_tr_b16 v[48:49], v26 offset:49152
  v_mfma_f32_16x16x32_bf16 v[128:131], v[92:95], v[72:75], v[128:131]
  ds_read_b64_tr_b16 v[50:51], v26 offset:49920
  v_mfma_f32_16x16x32_bf16 v[132:135], v[92:95], v[76:79], v[132:135]
  ds_read_b64_tr_b16 v[52:53], v27 offset:49152
  v_mfma_f32_16x16x32_bf16 v[136:139], v[92:95], v[80:83], v[136:139]
  ds_read_b64_tr_b16 v[54:55], v27 offset:49920
  v_mfma_f32_16x16x32_bf16 v[140:143], v[92:95], v[84:87], v[140:143]
  ds_read_b64_tr_b16 v[56:57], v28 offset:49152
  v_mfma_f32_16x16x32_bf16 v[144:147], v[96:99], v[72:75], v[144:147]
  ds_read_b64_tr_b16 v[58:59], v28 offset:49920
  v_mfma_f32_16x16x32_bf16 v[148:151], v[96:99], v[76:79], v[148:151]
  ds_read_b64_tr_b16 v[60:61], v26 offset:55296
  v_mfma_f32_16x16x32_bf16 v[152:155], v[96:99], v[80:83], v[152:155]
  ds_read_b64_tr_b16 v[62:63], v26 offset:56064
  v_mfma_f32_16x16x32_bf16 v[156:159], v[96:99], v[84:87], v[156:159]
  ds_read_b64_tr_b16 v[64:65], v27 offset:55296
  v_mfma_f32_16x16x32_bf16 v[160:163], v[100:103], v[72:75], v[160:163]
  ds_read_b64_tr_b16 v[66:67], v27 offset:56064
  v_mfma_f32_16x16x32_bf16 v[164:167], v[100:103], v[76:79], v[164:167]
  ds_read_b64_tr_b16 v[68:69], v28 offset:55296
  v_mfma_f32_16x16x32_bf16 v[168:171], v[100:103], v[80:83], v[168:171]
  ds_read_b64_tr_b16 v[70:71], v28 offset:56064
  v_mfma_f32_16x16x32_bf16 v[172:175], v[100:103], v[84:87], v[172:175]
  s_add_u32 m0, s66, 32768
  v_mfma_f32_16x16x32_bf16 v[176:179], v[104:107], v[72:75], v[176:179]
  s_add_u32 s64, s64, s7
  v_mfma_f32_16x16x32_bf16 v[180:183], v[104:107], v[76:79], v[180:183]
  buffer_load_dwordx4 v11, s[40:43], s64 offen offset:0  lds
  v_mfma_f32_16x16x32_bf16 v[184:187], v[104:107], v[80:83], v[184:187]
  buffer_load_dwordx4 v12, s[40:43], s64 offen offset:1024  lds
  v_mfma_f32_16x16x32_bf16 v[188:191], v[104:107], v[84:87], v[188:191]
  s_cmp_eq_u32 s75, 5
  s_cbranch_scc1 T2_4o
T2_4:
  v_mfma_f32_16x16x32_bf16 v[192:195], v[108:111], v[72:75], v[192:195]
  s_add_u32 m0, s74, 135168
  v_mfma_f32_16x16x32_bf16 v[196:199], v[108:111], v[76:79], v[196:199]
  s_add_u32 s65, s65, s55
  v_mfma_f32_16x16x32_bf16 v[200:203], v[108:111], v[80:83], v[200:203]
  buffer_load_dwordx4 v24, s[44:47], s65 offen  lds
  v_mfma_f32_16x16x32_bf16 v[204:207], v[108:111], v[84:87], v[204:207]
  s_mov_b32 exec_hi, 0
  buffer_load_dwordx4 v25, s[44:47], s65 offen offset:1024  lds
  s_mov_b32 exec_hi, -1
  s_waitcnt vmcnt(12) lgkmcnt(0)
  s_barrier
  v_mfma_f32_16x16x32_bf16 v[112:115], v[48:51], v[32:35], v[112:115]
  ds_read_b128 v[72:75], v18 offset:0
  v_mfma_f32_16x16x32_bf16 v[116:119], v[48:51], v[36:39], v[116:119]
  ds_read_b128 v[76:79], v18 offset:2048
  v_mfma_f32_16x16x32_bf16 v[120:123], v[48:51], v[40:43], v[120:123]
  ds_read_b128 v[80:83], v18 offset:4096
  v_mfma_f32_16x16x32_bf16 v[124:127], v[48:51], v[44:47], v[124:127]
  ds_read_b128 v[84:87], v18 offset:6144
  v_mfma_f32_16x16x32_bf16 v[128:131], v[52:55], v[32:35], v[128:131]
  ds_read_b64_tr_b16 v[88:89], v26 offset:0
  v_mfma_f32_16x16x32_bf16 v[132:135], v[52:55], v[36:39], v[132:135]
  ds_read_b64_tr_b16 v[90:91], v26 offset:768
  v_mfma_f32_16x16x32_bf16 v[136:139], v[52:55], v[40:43], v[136:139]
  ds_read_b64_tr_b16 v[92:93], v27 offset:0
  v_mfma_f32_16x16x32_bf16 v[140:143], v[52:55], v[44:47], v[140:143]
  ds_read_b64_tr_b16 v[94:95], v27 offset:768
  v_mfma_f32_16x16x32_bf16 v[144:147], v[56:59], v[32:35], v[144:147]
  ds_read_b64_tr_b16 v[96:97], v28 offset:0
  v_mfma_f32_16x16x32_bf16 v[148:151], v[56:59], v[36:39], v[148:151]
  ds_read_b64_tr_b16 v[98:99], v28 offset:768
  v_mfma_f32_16x16x32_bf16 v[152:155], v[56:59], v[40:43], v[152:155]
  ds_read_b64_tr_b16 v[100:101], v26 offset:6144
  v_mfma_f32_16x16x32_bf16 v[156:159], v[56:59], v[44:47], v[156:159]
  ds_read_b64_tr_b16 v[102:103], v26 offset:6912
  v_mfma_f32_16x16x32_bf16 v[160:163], v[60:63], v[32:35], v[160:163]
  ds_read_b64_tr_b16 v[104:105], v27 offset:6144
  v_mfma_f32_16x16x32_bf16 v[164:167], v[60:63], v[36:39], v[164:167]
  ds_read_b64_tr_b16 v[106:107], v27 offset:6912
  v_mfma_f32_16x16x32_bf16 v[168:171], v[60:63], v[40:43], v[168:171]
  ds_read_b64_tr_b16 v[108:109], v28 offset:6144
  v_mfma_f32_16x16x32_bf16 v[172:175], v[60:63], v[44:47], v[172:175]
  ds_read_b64_tr_b16 v[110:111], v28 offset:6912
  v_mfma_f32_16x16x32_bf16 v[176:179], v[64:67], v[32:35], v[176:179]
  s_add_u32 m0, s66, 32768
  v_mfma_f32_16x16x32_bf16 v[180:183], v[64:67], v[36:39], v[180:183]
  buffer_load_dwordx4 v13, s[40:43], s64 offen offset:2048  lds
  v_mfma_f32_16x16x32_bf16 v[184:187], v[64:67], v[40:43], v[184:187]
  buffer_load_dwordx4 v14, s[40:43], s64 offen offset:3072  lds
  v_mfma_f32_16x16x32_bf16 v[188:191], v[64:67], v[44:47], v[188:191]
  s_add_u32 m0, s74, 147456
  v_mfma_f32_16x16x32_bf16 v[192:195], v[68:71], v[32:35], v[192:195]
  s_add_u32 s65, s65, 110592
  v_mfma_f32_16x16x32_bf16 v[196:199], v[68:71], v[36:39], v[196:199]
  buffer_load_dwordx4 v24, s[44:47], s65 offen  lds
  v_mfma_f32_16x16x32_bf16 v[200:203], v[68:71], v[40:43], v[200:203]
  s_mov_b32 exec_hi, 0
  buffer_load_dwordx4 v25, s[44:47], s65 offen offset:1024  lds
  s_mov_b32 exec_hi, -1
  v_mfma_f32_16x16x32_bf16 v[204:207], v[68:71], v[44:47], v[204:207]
  s_waitcnt vmcnt(10) lgkmcnt(0)
  s_barrier
  v_mfma_f32_16x16x32_bf16 v[112:115], v[88:91], v[72:75], v[112:115]
  ds_read_b128 v[32:35], v15 offset:0
  ds_read_b128 v[36:39], v15 offset:2048
  v_mfma_f32_16x16x32_bf16 v[116:119], v[88:91], v[76:79], v[116:119]
  ds_read_b128 v[40:43], v15 offset:4096
  v_mfma_f32_16x16x32_bf16 v[120:123], v[88:91], v[80:83], v[120:123]
  ds_read_b128 v[44:47], v15 offset:6144
  v_mfma_f32_16x16x32_bf16 v[124:127], v[88:91], v[84:87], v[124:127]
  ds_read_b64_tr_b16 v[48:49], v26 offset:12288
  v_mfma_f32_16x16x32_bf16 v[128:131], v[92:95], v[72:75], v[128:131]
  ds_read_b64_tr_b16 v[50:51], v26 offset:13056
  v_mfma_f32_16x16x32_bf16 v[132:135], v[92:95], v[76:79], v[132:135]
  ds_read_b64_tr_b16 v[52:53], v27 offset:12288
  v_mfma_f32_16x16x32_bf16 v[136:139], v[92:95], v[80:83], v[136:139]
  ds_read_b64_tr_b16 v[54:55], v27 offset:13056
  v_mfma_f32_16x16x32_bf16 v[140:143], v[92:95], v[84:87], v[140:143]
  ds_read_b64_tr_b16 v[56:57], v28 offset:12288
  v_mfma_f32_16x16x32_bf16 v[144:147], v[96:99], v[72:75], v[144:147]
  ds_read_b64_tr_b16 v[58:59], v28 offset:13056
  v_mfma_f32_16x16x32_bf16 v[148:151], v[96:99], v[76:79], v[148:151]
  ds_read_b64_tr_b16 v[60:61], v26 offset:18432
  v_mfma_f32_16x16x32_bf16 v[152:155], v[96:99], v[80:83], v[152:155]
  ds_read_b64_tr_b16 v[62:63], v26 offset:19200
  v_mfma_f32_16x16x32_bf16 v[156:159], v[96:99], v[84:87], v[156:159]
  ds_read_b64_tr_b16 v[64:65], v27 offset:18432
  v_mfma_f32_16x16x32_bf16 v[160:163], v[100:103], v[72:75], v[160:163]
  ds_read_b64_tr_b16 v[66:67], v27 offset:19200
  v_mfma_f32_16x16x32_bf16 v[164:167], v[100:103], v[76:79], v[164:167]
  ds_read_b64_tr_b16 v[68:69], v28 offset:18432
  v_mfma_f32_16x16x32_bf16 v[168:171], v[100:103], v[80:83], v[168:171]
  ds_read_b64_tr_b16 v[70:71], v28 offset:19200
  v_mfma_f32_16x16x32_bf16 v[172:175], v[100:103], v[84:87], v[172:175]
  s_add_u32 m0, s66, 65536
  v_mfma_f32_16x16x32_bf16 v[176:179], v[104:107], v[72:75], v[176:179]
  s_add_u32 s64, s64, s6
  v_mfma_f32_16x16x32_bf16 v[180:183], v[104:107], v[76:79], v[180:183]
  buffer_load_dwordx4 v11, s[40:43], s64 offen offset:0  lds
  v_mfma_f32_16x16x32_bf16 v[184:187], v[104:107], v[80:83], v[184:187]
  buffer_load_dwordx4 v12, s[40:43], s64 offen offset:1024  lds
  v_mfma_f32_16x16x32_bf16 v[188:191], v[104:107], v[84:87], v[188:191]
  s_cmp_eq_u32 s75, 6
  s_cbranch_scc1 T2_5o
T2_5:
  v_mfma_f32_16x16x32_bf16 v[192:195], v[108:111], v[72:75], v[192:195]
  s_add_u32 m0, s74, 98304
  v_mfma_f32_16x16x32_bf16 v[196:199], v[108:111], v[76:79], v[196:199]
  s_add_u32 s65, s65, s54
  v_mfma_f32_16x16x32_bf16 v[200:203], v[108:111], v[80:83], v[200:203]
  buffer_load_dwordx4 v24, s[44:47], s65 offen  lds
  v_mfma_f32_16x16x32_bf16 v[204:207], v[108:111], v[84:87], v[204:207]
  s_mov_b32 exec_hi, 0
  buffer_load_dwordx4 v25, s[44:47], s65 offen offset:1024  lds
  s_mov_b32 exec_hi, -1
  s_waitcnt vmcnt(12) lgkmcnt(0)
  s_barrier
  v_mfma_f32_16x16x32_bf16 v[112:115], v[48:51], v[32:35], v[112:115]
  ds_read_b128 v[72:75], v16 offset:0
  ds_read_b128 v[76:79], v16 offset:2048
  v_mfma_f32_16x16x32_bf16 v[116:119], v[48:51], v[36:39], v[116:119]
  ds_read_b128 v[80:83], v16 offset:4096
  v_mfma_f32_16x16x32_bf16 v[120:123], v[48:51], v[40:43], v[120:123]
  ds_read_b128 v[84:87], v16 offset:6144
  v_mfma_f32_16x16x32_bf16 v[124:127], v[48:51], v[44:47], v[124:127]
  ds_read_b64_tr_b16 v[88:89], v26 offset:24576
  v_mfma_f32_16x16x32_bf16 v[128:131], v[52:55], v[32:35], v[128:131]
  ds_read_b64_tr_b16 v[90:91], v26 offset:25344
  v_mfma_f32_16x16x32_bf16 v[132:135], v[52:55], v[36:39], v[132:135]
  ds_read_b64_tr_b16 v[92:93], v27 offset:24576
  v_mfma_f32_16x16x32_bf16 v[136:139], v[52:55], v[40:43], v[136:139]
  ds_read_b64_tr_b16 v[94:95], v27 offset:25344
  v_mfma_f32_16x16x32_bf16 v[140:143], v[52:55], v[44:47], v[140:143]
  ds_read_b64_tr_b16 v[96:97], v28 offset:24576
  v_mfma_f32_16x16x32_bf16 v[144:147], v[56:59], v[32:35], v[144:147]
  ds_read_b64_tr_b16 v[98:99], v28 offset:25344
  v_mfma_f32_16x16x32_bf16 v[148:151], v[56:59], v[36:39], v[148:151]
  ds_read_b64_tr_b16 v[100:101], v26 offset:30720
  v_mfma_f32_16x16x32_bf16 v[152:155], v[56:59], v[40:43], v[152:155]
  ds_read_b64_tr_b16 v[102:103], v26 offset:31488
  v_mfma_f32_16x16x32_bf16 v[156:159], v[56:59], v[44:47], v[156:159]
  ds_read_b64_tr_b16 v[104:105], v27 offset:30720
  v_mfma_f32_16x16x32_bf16 v[160:163], v[60:63], v[32:35], v[160:163]
  ds_read_b64_tr_b16 v[106:107], v27 offset:31488
  v_mfma_f32_16x16x32_bf16 v[164:167], v[60:63], v[36:39], v[164:167]
  ds_read_b64_tr_b16 v[108:109], v28 offset:30720
  v_mfma_f32_16x16x32_bf16 v[168:171], v[60:63], v[40:43], v[168:171]
  ds_read_b64_tr_b16 v[110:111], v28 offset:31488
  v_mfma_f32_16x16x32_bf16 v[172:175], v[60:63], v[44:47], v[172:175]
  s_add_u32 m0, s66, 65536
  v_mfma_f32_16x16x32_bf16 v[176:179], v[64:67], v[32:35], v[176:179]
  buffer_load_dwordx4 v13, s[40:43], s64 offen offset:2048  lds
  v_mfma_f32_16x16x32_bf16 v[180:183], v[64:67], v[36:39], v[180:183]
  buffer_load_dwordx4 v14, s[40:43], s64 offen offset:3072  lds
  v_mfma_f32_16x16x32_bf16 v[184:187], v[64:67], v[40:43], v[184:187]
  s_cmp_eq_u32 s75, 3
  s_cbranch_scc1 T2_6o
T2_6:
  v_mfma_f32_16x16x32_bf16 v[188:191], v[64:67], v[44:47], v[188:191]
  s_add_u32 m0, s74, 110592
  v_mfma_f32_16x16x32_bf16 v[192:195], v[68:71], v[32:35], v[192:195]
  s_add_u32 s65, s65, 110592
  v_mfma_f32_16x16x32_bf16 v[196:199], v[68:71], v[36:39], v[196:199]
  buffer_load_dwordx4 v24, s[44:47], s65 offen  lds
  v_mfma_f32_16x16x32_bf16 v[200:203], v[68:71], v[40:43], v[200:203]
  s_mov_b32 exec_hi, 0
  buffer_load_dwordx4 v25, s[44:47], s65 offen offset:1024  lds
  s_mov_b32 exec_hi, -1
  v_mfma_f32_16x16x32_bf16 v[204:207], v[68:71], v[44:47], v[204:207]
  s_waitcnt vmcnt(10) lgkmcnt(0)
  s_barrier
  v_mfma_f32_16x16x32_bf16 v[112:115], v[88:91], v[72:75], v[112:115]
  ds_read_b128 v[32:35], v15 offset:32768
  ds_read_b128 v[36:39], v15 offset:34816
  v_mfma_f32_16x16x32_bf16 v[116:119], v[88:91], v[76:79], v[116:119]
  ds_read_b128 v[40:43], v15 offset:36864
  v_mfma_f32_16x16x32_bf16 v[120:123], v[88:91], v[80:83], v[120:123]
  ds_read_b128 v[44:47], v15 offset:38912
  v_mfma_f32_16x16x32_bf16 v[124:127], v[88:91], v[84:87], v[124:127]
  ds_read_b64_tr_b16 v[48:49], v26 offset:36864
  v_mfma_f32_16x16x32_bf16 v[128:131], v[92:95], v[72:75], v[128:131]
  ds_read_b64_tr_b16 v[50:51], v26 offset:37632
  v_mfma_f32_16x16x32_bf16 v[132:135], v[92:95], v[76:79], v[132:135]
  ds_read_b64_tr_b16 v[52:53], v27 offset:36864
  v_mfma_f32_16x16x32_bf16 v[136:139], v[92:95], v[80:83], v[136:139]
  ds_read_b64_tr_b16 v[54:55], v27 offset:37632
  v_mfma_f32_16x16x32_bf16 v[140:143], v[92:95], v[84:87], v[140:143]
  ds_read_b64_tr_b16 v[56:57], v28 offset:36864
  v_mfma_f32_16x16x32_bf16 v[144:147], v[96:99], v[72:75], v[144:147]
  ds_read_b64_tr_b16 v[58:59], v28 offset:37632
  v_mfma_f32_16x16x32_bf16 v[148:151], v[96:99], v[76:79], v[148:151]
  ds_read_b64_tr_b16 v[60:61], v26 offset:43008
  v_mfma_f32_16x16x32_bf16 v[152:155], v[96:99], v[80:83], v[152:155]
  ds_read_b64_tr_b16 v[62:63], v26 offset:43776
  v_mfma_f32_16x16x32_bf16 v[156:159], v[96:99], v[84:87], v[156:159]
  ds_read_b64_tr_b16 v[64:65], v27 offset:43008
  v_mfma_f32_16x16x32_bf16 v[160:163], v[100:103], v[72:75], v[160:163]
  ds_read_b64_tr_b16 v[66:67], v27 offset:43776
  v_mfma_f32_16x16x32_bf16 v[164:167], v[100:103], v[76:79], v[164:167]
  ds_read_b64_tr_b16 v[68:69], v28 offset:43008
  v_mfma_f32_16x16x32_bf16 v[168:171], v[100:103], v[80:83], v[168:171]
  ds_read_b64_tr_b16 v[70:71], v28 offset:43776
  v_mfma_f32_16x16x32_bf16 v[172:175], v[100:103], v[84:87], v[172:175]
  s_add_u32 m0, s66, 0
  v_mfma_f32_16x16x32_bf16 v[176:179], v[104:107], v[72:75], v[176:179]
  s_add_u32 s64, s64, s7
  v_mfma_f32_16x16x32_bf16 v[180:183], v[104:107], v[76:79], v[180:183]
  buffer_load_dwordx4 v11, s[40:43], s64 offen offset:0  lds
  v_mfma_f32_16x16x32_bf16 v[184:187], v[104:107], v[80:83], v[184:187]
  buffer_load_dwordx4 v12, s[40:43], s64 offen offset:1024  lds
  v_mfma_f32_16x16x32_bf16 v[188:191], v[104:107], v[84:87], v[188:191]
  s_add_u32 m0, s74, 122880
  v_mfma_f32_16x16x32_bf16 v[192:195], v[108:111], v[72:75], v[192:195]
  s_add_u32 s65, s65, s55
  v_mfma_f32_16x16x32_bf16 v[196:199], v[108:111], v[76:79], v[196:199]
  buffer_load_dwordx4 v24, s[44:47], s65 offen  lds
  v_mfma_f32_16x16x32_bf16 v[200:203], v[108:111], v[80:83], v[200:203]
  s_mov_b32 exec_hi, 0
  buffer_load_dwordx4 v25, s[44:47], s65 offen offset:1024  lds
  s_mov_b32 exec_hi, -1
  v_mfma_f32_16x16x32_bf16 v[204:207], v[108:111], v[84:87], v[204:207]
  s_waitcnt vmcnt(12) lgkmcnt(0)
  s_barrier
  v_mfma_f32_16x16x32_bf16 v[112:115], v[48:51], v[32:35], v[112:115]
  ds_read_b128 v[72:75], v16 offset:32768
  v_mfma_f32_16x16x32_bf16 v[116:119], v[48:51], v[36:39], v[116:119]
  ds_read_b128 v[76:79], v16 offset:34816
  v_mfma_f32_16x16x32_bf16 v[120:123], v[48:51], v[40:43], v[120:123]
  ds_read_b128 v[80:83], v16 offset:36864
  v_mfma_f32_16x16x32_bf16 v[124:127], v[48:51], v[44:47], v[124:127]
  ds_read_b128 v[84:87], v16 offset:38912
  v_mfma_f32_16x16x32_bf16 v[128:131], v[52:55], v[32:35], v[128:131]
  ds_read_b64_tr_b16 v[88:89], v26 offset:49152
  v_mfma_f32_16x16x32_bf16 v[132:135], v[52:55], v[36:39], v[132:135]
  ds_read_b64_tr_b16 v[90:91], v26 offset:49920
  v_mfma_f32_16x16x32_bf16 v[136:139], v[52:55], v[40:43], v[136:139]
  ds_read_b64_tr_b16 v[92:93], v27 offset:49152
  v_mfma_f32_16x16x32_bf16 v[140:143], v[52:55], v[44:47], v[140:143]
  ds_read_b64_tr_b16 v[94:95], v27 offset:49920
  v_mfma_f32_16x16x32_bf16 v[144:147], v[56:59], v[32:35], v[144:147]
  ds_read_b64_tr_b16 v[96:97], v28 offset:49152
  v_mfma_f32_16x16x32_bf16 v[148:151], v[56:59], v[36:39], v[148:151]
  ds_read_b64_tr_b16 v[98:99], v28 offset:49920
  v_mfma_f32_16x16x32_bf16 v[152:155], v[56:59], v[40:43], v[152:155]
  ds_read_b64_tr_b16 v[100:101], v26 offset:55296
  v_mfma_f32_16x16x32_bf16 v[156:159], v[56:59], v[44:47], v[156:159]
  ds_read_b64_tr_b16 v[102:103], v26 offset:56064
  v_mfma_f32_16x16x32_bf16 v[160:163], v[60:63], v[32:35], v[160:163]
  ds_read_b64_tr_b16 v[104:105], v27 offset:55296
  v_mfma_f32_16x16x32_bf16 v[164:167], v[60:63], v[36:39], v[164:167]
  ds_read_b64_tr_b16 v[106:107], v27 offset:56064
  v_mfma_f32_16x16x32_bf16 v[168:171], v[60:63], v[40:43], v[168:171]
  ds_read_b64_tr_b16 v[108:109], v28 offset:55296
  v_mfma_f32_16x16x32_bf16 v[172:175], v[60:63], v[44:47], v[172:175]
  ds_read_b64_tr_b16 v[110:111], v28 offset:56064
  v_mfma_f32_16x16x32_bf16 v[176:179], v[64:67], v[32:35], v[176:179]
  s_add_u32 m0, s66, 0
  v_mfma_f32_16x16x32_bf16 v[180:183], v[64:67], v[36:39], v[180:183]
  buffer_load_dwordx4 v13, s[40:43], s64 offen offset:2048  lds
  v_mfma_f32_16x16x32_bf16 v[184:187], v[64:67], v[40:43], v[184:187]
  buffer_load_dwordx4 v14, s[40:43], s64 offen offset:3072  lds
  v_mfma_f32_16x16x32_bf16 v[188:191], v[64:67], v[44:47], v[188:191]
  s_add_u32 m0, s74, 135168
  v_mfma_f32_16x16x32_bf16 v[192:195], v[68:71], v[32:35], v[192:195]
  s_add_u32 s65, s65, 110592
  v_mfma_f32_16x16x32_bf16 v[196:199], v[68:71], v[36:39], v[196:199]
  buffer_load_dwordx4 v24, s[44:47], s65 offen  lds
  v_mfma_f32_16x16x32_bf16 v[200:203], v[68:71], v[40:43], v[200:203]
  s_mov_b32 exec_hi, 0
  buffer_load_dwordx4 v25, s[44:47], s65 offen offset:1024  lds
  s_mov_b32 exec_hi, -1
  v_mfma_f32_16x16x32_bf16 v[204:207], v[68:71], v[44:47], v[204:207]
  s_waitcnt vmcnt(10) lgkmcnt(0)
  s_barrier
  v_mfma_f32_16x16x32_bf16 v[112:115], v[88:91], v[72:75], v[112:115]
  ds_read_b128 v[32:35], v17 offset:0
  ds_read_b128 v[36:39], v17 offset:2048
  v_mfma_f32_16x16x32_bf16 v[116:119], v[88:91], v[76:79], v[116:119]
  ds_read_b128 v[40:43], v17 offset:4096
  v_mfma_f32_16x16x32_bf16 v[120:123], v[88:91], v[80:83], v[120:123]
  ds_read_b128 v[44:47], v17 offset:6144
  v_mfma_f32_16x16x32_bf16 v[124:127], v[88:91], v[84:87], v[124:127]
  ds_read_b64_tr_b16 v[48:49], v26 offset:0
  v_mfma_f32_16x16x32_bf16 v[128:131], v[92:95], v[72:75], v[128:131]
  ds_read_b64_tr_b16 v[50:51], v26 offset:768
  v_mfma_f32_16x16x32_bf16 v[132:135], v[92:95], v[76:79], v[132:135]
  ds_read_b64_tr_b16 v[52:53], v27 offset:0
  v_mfma_f32_16x16x32_bf16 v[136:139], v[92:95], v[80:83], v[136:139]
  ds_read_b64_tr_b16 v[54:55], v27 offset:768
  v_mfma_f32_16x16x32_bf16 v[140:143], v[92:95], v[84:87], v[140:143]
  ds_read_b64_tr_b16 v[56:57], v28 offset:0
  v_mfma_f32_16x16x32_bf16 v[144:147], v[96:99], v[72:75], v[144:147]
  ds_read_b64_tr_b16 v[58:59], v28 offset:768
  v_mfma_f32_16x16x32_bf16 v[148:151], v[96:99], v[76:79], v[148:151]
  ds_read_b64_tr_b16 v[60:61], v26 offset:6144
  v_mfma_f32_16x16x32_bf16 v[152:155], v[96:99], v[80:83], v[152:155]
  ds_read_b64_tr_b16 v[62:63], v26 offset:6912
  v_mfma_f32_16x16x32_bf16 v[156:159], v[96:99], v[84:87], v[156:159]
  ds_read_b64_tr_b16 v[64:65], v27 offset:6144
  v_mfma_f32_16x16x32_bf16 v[160:163], v[100:103], v[72:75], v[160:163]
  ds_read_b64_tr_b16 v[66:67], v27 offset:6912
  v_mfma_f32_16x16x32_bf16 v[164:167], v[100:103], v[76:79], v[164:167]
  ds_read_b64_tr_b16 v[68:69], v28 offset:6144
  v_mfma_f32_16x16x32_bf16 v[168:171], v[100:103], v[80:83], v[168:171]
  ds_read_b64_tr_b16 v[70:71], v28 offset:6912
  v_mfma_f32_16x16x32_bf16 v[172:175], v[100:103], v[84:87], v[172:175]
  s_add_u32 m0, s66, 32768
  v_mfma_f32_16x16x32_bf16 v[176:179], v[104:107], v[72:75], v[176:179]
  s_add_u32 s64, s64, s6
  v_mfma_f32_16x16x32_bf16 v[180:183], v[104:107], v[76:79], v[180:183]
  buffer_load_dwordx4 v11, s[40:43], s64 offen offset:0  lds
  v_mfma_f32_16x16x32_bf16 v[184:187], v[104:107], v[80:83], v[184:187]
  buffer_load_dwordx4 v12, s[40:43], s64 offen offset:1024  lds
  v_mfma_f32_16x16x32_bf16 v[188:191], v[104:107], v[84:87], v[188:191]
  s_add_u32 m0, s74, 147456
  v_mfma_f32_16x16x32_bf16 v[192:195], v[108:111], v[72:75], v[192:195]
  s_add_u32 s65, s65, s54
  v_mfma_f32_16x16x32_bf16 v[196:199], v[108:111], v[76:79], v[196:199]
  buffer_load_dwordx4 v24, s[44:47], s65 offen  lds
  v_mfma_f32_16x16x32_bf16 v[200:203], v[108:111], v[80:83], v[200:203]
  s_mov_b32 exec_hi, 0
  buffer_load_dwordx4 v25, s[44:47], s65 offen offset:1024  lds
  s_mov_b32 exec_hi, -1
  v_mfma_f32_16x16x32_bf16 v[204:207], v[108:111], v[84:87], v[204:207]
  s_waitcnt vmcnt(12) lgkmcnt(0)
  s_barrier
  v_mfma_f32_16x16x32_bf16 v[112:115], v[48:51], v[32:35], v[112:115]
  ds_read_b128 v[72:75], v18 offset:0
  ds_read_b128 v[76:79], v18 offset:2048
  v_mfma_f32_16x16x32_bf16 v[116:119], v[48:51], v[36:39], v[116:119]
  ds_read_b128 v[80:83], v18 offset:4096
  v_mfma_f32_16x16x32_bf16 v[120:123], v[48:51], v[40:43], v[120:123]
  ds_read_b128 v[84:87], v18 offset:6144
  v_mfma_f32_16x16x32_bf16 v[124:127], v[48:51], v[44:47], v[124:127]
  ds_read_b64_tr_b16 v[88:89], v26 offset:12288
  v_mfma_f32_16x16x32_bf16 v[128:131], v[52:55], v[32:35], v[128:131]
  ds_read_b64_tr_b16 v[90:91], v26 offset:13056
  v_mfma_f32_16x16x32_bf16 v[132:135], v[52:55], v[36:39], v[132:135]
  ds_read_b64_tr_b16 v[92:93], v27 offset:12288
  v_mfma_f32_16x16x32_bf16 v[136:139], v[52:55], v[40:43], v[136:139]
  ds_read_b64_tr_b16 v[94:95], v27 offset:13056
  v_mfma_f32_16x16x32_bf16 v[140:143], v[52:55], v[44:47], v[140:143]
  ds_read_b64_tr_b16 v[96:97], v28 offset:12288
  v_mfma_f32_16x16x32_bf16 v[144:147], v[56:59], v[32:35], v[144:147]
  ds_read_b64_tr_b16 v[98:99], v28 offset:13056
  v_mfma_f32_16x16x32_bf16 v[148:151], v[56:59], v[36:39], v[148:151]
  ds_read_b64_tr_b16 v[100:101], v26 offset:18432
  v_mfma_f32_16x16x32_bf16 v[152:155], v[56:59], v[40:43], v[152:155]
  ds_read_b64_tr_b16 v[102:103], v26 offset:19200
  v_mfma_f32_16x16x32_bf16 v[156:159], v[56:59], v[44:47], v[156:159]
  ds_read_b64_tr_b16 v[104:105], v27 offset:18432
  v_mfma_f32_16x16x32_bf16 v[160:163], v[60:63], v[32:35], v[160:163]
  ds_read_b64_tr_b16 v[106:107], v27 offset:19200
  v_mfma_f32_16x16x32_bf16 v[164:167], v[60:63], v[36:39], v[164:167]
  ds_read_b64_tr_b16 v[108:109], v28 offset:18432
  v_mfma_f32_16x16x32_bf16 v[168:171], v[60:63], v[40:43], v[168:171]
  ds_read_b64_tr_b16 v[110:111], v28 offset:19200
  v_mfma_f32_16x16x32_bf16 v[172:175], v[60:63], v[44:47], v[172:175]
  s_add_u32 m0, s66, 32768
  v_mfma_f32_16x16x32_bf16 v[176:179], v[64:67], v[32:35], v[176:179]
  buffer_load_dwordx4 v13, s[40:43], s64 offen offset:2048  lds
  v_mfma_f32_16x16x32_bf16 v[180:183], v[64:67], v[36:39], v[180:183]
  buffer_load_dwordx4 v14, s[40:43], s64 offen offset:3072  lds
  v_mfma_f32_16x16x32_bf16 v[184:187], v[64:67], v[40:43], v[184:187]
  v_mov_b32 v29, 0
  v_mfma_f32_16x16x32_bf16 v[188:191], v[64:67], v[44:47], v[188:191]
  buffer_load_dword v29, v29, s[84:87], 0 offen offset:128 sc1
  v_mfma_f32_16x16x32_bf16 v[192:195], v[68:71], v[32:35], v[192:195]
  s_add_u32 m0, s74, 98304
  v_mfma_f32_16x16x32_bf16 v[196:199], v[68:71], v[36:39], v[196:199]
  s_add_u32 s65, s65, 110592
  v_mfma_f32_16x16x32_bf16 v[200:203], v[68:71], v[40:43], v[200:203]
  buffer_load_dwordx4 v24, s[44:47], s65 offen  lds
  v_mfma_f32_16x16x32_bf16 v[204:207], v[68:71], v[44:47], v[204:207]
  s_mov_b32 exec_hi, 0
  buffer_load_dwordx4 v25, s[44:47], s65 offen offset:1024  lds
  s_mov_b32 exec_hi, -1
  s_waitcnt vmcnt(11) lgkmcnt(0)
  s_barrier
  v_mfma_f32_16x16x32_bf16 v[112:115], v[88:91], v[72:75], v[112:115]
  ds_read_b128 v[32:35], v15 offset:0
  ds_read_b128 v[36:39], v15 offset:2048
  v_mfma_f32_16x16x32_bf16 v[116:119], v[88:91], v[76:79], v[116:119]
  ds_read_b128 v[40:43], v15 offset:4096
  v_mfma_f32_16x16x32_bf16 v[120:123], v[88:91], v[80:83], v[120:123]
  ds_read_b128 v[44:47], v15 offset:6144
  v_mfma_f32_16x16x32_bf16 v[124:127], v[88:91], v[84:87], v[124:127]
  ds_read_b64_tr_b16 v[48:49], v26 offset:24576
  v_mfma_f32_16x16x32_bf16 v[128:131], v[92:95], v[72:75], v[128:131]
  ds_read_b64_tr_b16 v[50:51], v26 offset:25344
  v_mfma_f32_16x16x32_bf16 v[132:135], v[92:95], v[76:79], v[132:135]
  ds_read_b64_tr_b16 v[52:53], v27 offset:24576
  v_mfma_f32_16x16x32_bf16 v[136:139], v[92:95], v[80:83], v[136:139]
  ds_read_b64_tr_b16 v[54:55], v27 offset:25344
  v_mfma_f32_16x16x32_bf16 v[140:143], v[92:95], v[84:87], v[140:143]
  ds_read_b64_tr_b16 v[56:57], v28 offset:24576
  v_mfma_f32_16x16x32_bf16 v[144:147], v[96:99], v[72:75], v[144:147]
  ds_read_b64_tr_b16 v[58:59], v28 offset:25344
  v_mfma_f32_16x16x32_bf16 v[148:151], v[96:99], v[76:79], v[148:151]
  ds_read_b64_tr_b16 v[60:61], v26 offset:30720
  v_mfma_f32_16x16x32_bf16 v[152:155], v[96:99], v[80:83], v[152:155]
  ds_read_b64_tr_b16 v[62:63], v26 offset:31488
  v_mfma_f32_16x16x32_bf16 v[156:159], v[96:99], v[84:87], v[156:159]
  ds_read_b64_tr_b16 v[64:65], v27 offset:30720
  v_mfma_f32_16x16x32_bf16 v[160:163], v[100:103], v[72:75], v[160:163]
  ds_read_b64_tr_b16 v[66:67], v27 offset:31488
  v_mfma_f32_16x16x32_bf16 v[164:167], v[100:103], v[76:79], v[164:167]
  ds_read_b64_tr_b16 v[68:69], v28 offset:30720
  v_mfma_f32_16x16x32_bf16 v[168:171], v[100:103], v[80:83], v[168:171]
  ds_read_b64_tr_b16 v[70:71], v28 offset:31488
  v_mfma_f32_16x16x32_bf16 v[172:175], v[100:103], v[84:87], v[172:175]
  s_add_u32 m0, s66, 65536
  v_mfma_f32_16x16x32_bf16 v[176:179], v[104:107], v[72:75], v[176:179]
  s_add_u32 s64, s64, s7
  v_mfma_f32_16x16x32_bf16 v[180:183], v[104:107], v[76:79], v[180:183]
  buffer_load_dwordx4 v11, s[40:43], s64 offen offset:0  lds
  v_mfma_f32_16x16x32_bf16 v[184:187], v[104:107], v[80:83], v[184:187]
  buffer_load_dwordx4 v12, s[40:43], s64 offen offset:1024  lds
  v_mfma_f32_16x16x32_bf16 v[188:191], v[104:107], v[84:87], v[188:191]
  s_add_u32 m0, s74, 110592
  v_mfma_f32_16x16x32_bf16 v[192:195], v[108:111], v[72:75], v[192:195]
  s_add_u32 s65, s65, s55
  v_mfma_f32_16x16x32_bf16 v[196:199], v[108:111], v[76:79], v[196:199]
  buffer_load_dwordx4 v24, s[44:47], s65 offen  lds
  v_mfma_f32_16x16x32_bf16 v[200:203], v[108:111], v[80:83], v[200:203]
  s_mov_b32 exec_hi, 0
  buffer_load_dwordx4 v25, s[44:47], s65 offen offset:1024  lds
  s_mov_b32 exec_hi, -1
  v_mfma_f32_16x16x32_bf16 v[204:207], v[108:111], v[84:87], v[204:207]
  s_waitcnt vmcnt(6) lgkmcnt(0)
  v_readfirstlane_b32 s14, v29
  s_nop 0
  s_cmp_eq_u32 s14, 0
  s_cbranch_scc1 INITOK_7o
INITOK_7:
  s_barrier
  v_mfma_f32_16x16x32_bf16 v[112:115], v[48:51], v[32:35], v[112:115]
  ds_read_b128 v[72:75], v16 offset:0
  ds_read_b128 v[76:79], v16 offset:2048
  v_mfma_f32_16x16x32_bf16 v[116:119], v[48:51], v[36:39], v[116:119]
  ds_read_b128 v[80:83], v16 offset:4096
  v_mfma_f32_16x16x32_bf16 v[120:123], v[48:51], v[40:43], v[120:123]
  ds_read_b128 v[84:87], v16 offset:6144
  v_mfma_f32_16x16x32_bf16 v[124:127], v[48:51], v[44:47], v[124:127]
  ds_read_b64_tr_b16 v[88:89], v26 offset:36864
  v_mfma_f32_16x16x32_bf16 v[128:131], v[52:55], v[32:35], v[128:131]
  ds_read_b64_tr_b16 v[90:91], v26 offset:37632
  v_mfma_f32_16x16x32_bf16 v[132:135], v[52:55], v[36:39], v[132:135]
  ds_read_b64_tr_b16 v[92:93], v27 offset:36864
  v_mfma_f32_16x16x32_bf16 v[136:139], v[52:55], v[40:43], v[136:139]
  ds_read_b64_tr_b16 v[94:95], v27 offset:37632
  v_mfma_f32_16x16x32_bf16 v[140:143], v[52:55], v[44:47], v[140:143]
  ds_read_b64_tr_b16 v[96:97], v28 offset:36864
  v_mfma_f32_16x16x32_bf16 v[144:147], v[56:59], v[32:35], v[144:147]
  ds_read_b64_tr_b16 v[98:99], v28 offset:37632
  v_mfma_f32_16x16x32_bf16 v[148:151], v[56:59], v[36:39], v[148:151]
  ds_read_b64_tr_b16 v[100:101], v26 offset:43008
  v_mfma_f32_16x16x32_bf16 v[152:155], v[56:59], v[40:43], v[152:155]
  ds_read_b64_tr_b16 v[102:103], v26 offset:43776
  v_mfma_f32_16x16x32_bf16 v[156:159], v[56:59], v[44:47], v[156:159]
  ds_read_b64_tr_b16 v[104:105], v27 offset:43008
  ds_read_b64_tr_b16 v[106:107], v27 offset:43776
  v_mfma_f32_16x16x32_bf16 v[160:163], v[60:63], v[32:35], v[160:163]
  ds_read_b64_tr_b16 v[108:109], v28 offset:43008
  v_mfma_f32_16x16x32_bf16 v[164:167], v[60:63], v[36:39], v[164:167]
  ds_read_b64_tr_b16 v[110:111], v28 offset:43776
  v_mfma_f32_16x16x32_bf16 v[168:171], v[60:63], v[40:43], v[168:171]
  s_add_u32 m0, s66, 65536
  v_mfma_f32_16x16x32_bf16 v[172:175], v[60:63], v[44:47], v[172:175]
  buffer_load_dwordx4 v13, s[40:43], s64 offen offset:2048  lds
  v_mfma_f32_16x16x32_bf16 v[176:179], v[64:67], v[32:35], v[176:179]
  buffer_load_dwordx4 v14, s[40:43], s64 offen offset:3072  lds
  v_mfma_f32_16x16x32_bf16 v[180:183], v[64:67], v[36:39], v[180:183]
  s_add_u32 m0, s74, 122880
  v_mfma_f32_16x16x32_bf16 v[184:187], v[64:67], v[40:43], v[184:187]
  s_add_u32 s65, s65, 110592
  v_mfma_f32_16x16x32_bf16 v[188:191], v[64:67], v[44:47], v[188:191]
  buffer_load_dwordx4 v24, s[44:47], s65 offen  lds
  v_mfma_f32_16x16x32_bf16 v[192:195], v[68:71], v[32:35], v[192:195]
  s_mov_b32 exec_hi, 0
  buffer_load_dwordx4 v25, s[44:47], s65 offen offset:1024  lds
  s_mov_b32 exec_hi, -1
  v_mfma_f32_16x16x32_bf16 v[196:199], v[68:71], v[36:39], v[196:199]
  s_add_u32 s4, s20, 0
  v_mfma_f32_16x16x32_bf16 v[200:203], v[68:71], v[40:43], v[200:203]
  buffer_load_dwordx4 v[208:211], v20, s[48:51], s4 offen offset:0 sc1
  v_mfma_f32_16x16x32_bf16 v[204:207], v[68:71], v[44:47], v[204:207]
  buffer_load_dwordx4 v[212:215], v20, s[48:51], s4 offen offset:1024 sc1
  s_waitcnt vmcnt(12) lgkmcnt(0)
  s_barrier
  v_mfma_f32_16x16x32_bf16 v[112:115], v[88:91], v[72:75], v[112:115]
  ds_read_b128 v[32:35], v15 offset:32768
  ds_read_b128 v[36:39], v15 offset:34816
  v_mfma_f32_16x16x32_bf16 v[116:119], v[88:91], v[76:79], v[116:119]
  ds_read_b128 v[40:43], v15 offset:36864
  v_mfma_f32_16x16x32_bf16 v[120:123], v[88:91], v[80:83], v[120:123]
  ds_read_b128 v[44:47], v15 offset:38912
  v_mfma_f32_16x16x32_bf16 v[124:127], v[88:91], v[84:87], v[124:127]
  ds_read_b64_tr_b16 v[48:49], v26 offset:49152
  v_mfma_f32_16x16x32_bf16 v[128:131], v[92:95], v[72:75], v[128:131]
  ds_read_b64_tr_b16 v[50:51], v26 offset:49920
  v_mfma_f32_16x16x32_bf16 v[132:135], v[92:95], v[76:79], v[132:135]
  ds_read_b64_tr_b16 v[52:53], v27 offset:49152
  v_mfma_f32_16x16x32_bf16 v[136:139], v[92:95], v[80:83], v[136:139]
  ds_read_b64_tr_b16 v[54:55], v27 offset:49920
  v_mfma_f32_16x16x32_bf16 v[140:143], v[92:95], v[84:87], v[140:143]
  ds_read_b64_tr_b16 v[56:57], v28 offset:49152
  ds_read_b64_tr_b16 v[58:59], v28 offset:49920
  v_mfma_f32_16x16x32_bf16 v[144:147], v[96:99], v[72:75], v[144:147]
  ds_read_b64_tr_b16 v[60:61], v26 offset:55296
  v_mfma_f32_16x16x32_bf16 v[148:151], v[96:99], v[76:79], v[148:151]
  ds_read_b64_tr_b16 v[62:63], v26 offset:56064
  v_mfma_f32_16x16x32_bf16 v[152:155], v[96:99], v[80:83], v[152:155]
  ds_read_b64_tr_b16 v[64:65], v27 offset:55296
  v_mfma_f32_16x16x32_bf16 v[156:159], v[96:99], v[84:87], v[156:159]
  ds_read_b64_tr_b16 v[66:67], v27 offset:56064
  v_mfma_f32_16x16x32_bf16 v[160:163], v[100:103], v[72:75], v[160:163]
  ds_read_b64_tr_b16 v[68:69], v28 offset:55296
  v_mfma_f32_16x16x32_bf16 v[164:167], v[100:103], v[76:79], v[164:167]
  ds_read_b64_tr_b16 v[70:71], v28 offset:56064
  v_mfma_f32_16x16x32_bf16 v[168:171], v[100:103], v[80:83], v[168:171]
  s_add_u32 m0, s66, 0
  v_mfma_f32_16x16x32_bf16 v[172:175], v[100:103], v[84:87], v[172:175]
  s_add_u32 s64, s64, s6
  buffer_load_dwordx4 v11, s[40:43], s64 offen offset:0  lds
  v_mfma_f32_16x16x32_bf16 v[176:179], v[104:107], v[72:75], v[176:179]
  buffer_load_dwordx4 v12, s[40:43], s64 offen offset:1024  lds
  v_mfma_f32_16x16x32_bf16 v[180:183], v[104:107], v[76:79], v[180:183]
  s_add_u32 m0, s74, 135168
  v_mfma_f32_16x16x32_bf16 v[184:187], v[104:107], v[80:83], v[184:187]
  s_add_u32 s65, s65, s54
  v_mfma_f32_16x16x32_bf16 v[188:191], v[104:107], v[84:87], v[188:191]
  buffer_load_dwordx4 v24, s[44:47], s65 offen  lds
  v_mfma_f32_16x16x32_bf16 v[192:195], v[108:111], v[72:75], v[192:195]
  s_mov_b32 exec_hi, 0
  buffer_load_dwordx4 v25, s[44:47], s65 offen offset:1024  lds
  s_mov_b32 exec_hi, -1
  v_mfma_f32_16x16x32_bf16 v[196:199], v[108:111], v[76:79], v[196:199]
  s_add_u32 s4, s20, 0
  v_mfma_f32_16x16x32_bf16 v[200:203], v[108:111], v[80:83], v[200:203]
  buffer_load_dwordx4 v[216:219], v20, s[48:51], s4 offen offset:2048 sc1
  v_mfma_f32_16x16x32_bf16 v[204:207], v[108:111], v[84:87], v[204:207]
  buffer_load_dwordx4 v[220:223], v20, s[48:51], s4 offen offset:3072 sc1
  s_waitcnt vmcnt(16) lgkmcnt(0)
  s_barrier
  v_mfma_f32_16x16x32_bf16 v[112:115], v[48:51], v[32:35], v[112:115]
  ds_read_b128 v[72:75], v16 offset:32768
  ds_read_b128 v[76:79], v16 offset:34816
  v_mfma_f32_16x16x32_bf16 v[116:119], v[48:51], v[36:39], v[116:119]
  ds_read_b128 v[80:83], v16 offset:36864
  v_mfma_f32_16x16x32_bf16 v[120:123], v[48:51], v[40:43], v[120:123]
  ds_read_b128 v[84:87], v16 offset:38912
  v_mfma_f32_16x16x32_bf16 v[124:127], v[48:51], v[44:47], v[124:127]
  ds_read_b64_tr_b16 v[88:89], v26 offset:0
  v_mfma_f32_16x16x32_bf16 v[128:131], v[52:55], v[32:35], v[128:131]
  ds_read_b64_tr_b16 v[90:91], v26 offset:768
  ds_read_b64_tr_b16 v[92:93], v27 offset:0
  v_mfma_f32_16x16x32_bf16 v[132:135], v[52:55], v[36:39], v[132:135]
  ds_read_b64_tr_b16 v[94:95], v27 offset:768
  v_mfma_f32_16x16x32_bf16 v[136:139], v[52:55], v[40:43], v[136:139]
  ds_read_b64_tr_b16 v[96:97], v28 offset:0
  v_mfma_f32_16x16x32_bf16 v[140:143], v[52:55], v[44:47], v[140:143]
  ds_read_b64_tr_b16 v[98:99], v28 offset:768
  v_mfma_f32_16x16x32_bf16 v[144:147], v[56:59], v[32:35], v[144:147]
  ds_read_b64_tr_b16 v[100:101], v26 offset:6144
  v_mfma_f32_16x16x32_bf16 v[148:151], v[56:59], v[36:39], v[148:151]
  ds_read_b64_tr_b16 v[102:103], v26 offset:6912
  ds_read_b64_tr_b16 v[104:105], v27 offset:6144
  v_mfma_f32_16x16x32_bf16 v[152:155], v[56:59], v[40:43], v[152:155]
  ds_read_b64_tr_b16 v[106:107], v27 offset:6912
  v_mfma_f32_16x16x32_bf16 v[156:159], v[56:59], v[44:47], v[156:159]
  ds_read_b64_tr_b16 v[108:109], v28 offset:6144
  v_mfma_f32_16x16x32_bf16 v[160:163], v[60:63], v[32:35], v[160:163]
  ds_read_b64_tr_b16 v[110:111], v28 offset:6912
  v_mfma_f32_16x16x32_bf16 v[164:167], v[60:63], v[36:39], v[164:167]
  s_add_u32 m0, s66, 0
  v_mfma_f32_16x16x32_bf16 v[168:171], v[60:63], v[40:43], v[168:171]
  buffer_load_dwordx4 v13, s[40:43], s64 offen offset:2048  lds
  buffer_load_dwordx4 v14, s[40:43], s64 offen offset:3072  lds
  v_mfma_f32_16x16x32_bf16 v[172:175], v[60:63], v[44:47], v[172:175]
  s_add_u32 m0, s74, 147456
  v_mfma_f32_16x16x32_bf16 v[176:179], v[64:67], v[32:35], v[176:179]
  s_add_u32 s65, s65, 110592
  v_mfma_f32_16x16x32_bf16 v[180:183], v[64:67], v[36:39], v[180:183]
  buffer_load_dwordx4 v24, s[44:47], s65 offen  lds
  v_mfma_f32_16x16x32_bf16 v[184:187], v[64:67], v[40:43], v[184:187]
  s_mov_b32 exec_hi, 0
  buffer_load_dwordx4 v25, s[44:47], s65 offen offset:1024  lds
  s_mov_b32 exec_hi, -1
  v_mfma_f32_16x16x32_bf16 v[188:191], v[64:67], v[44:47], v[188:191]
  s_add_u32 s4, s20, 0
  buffer_load_dwordx4 v[224:227], v21, s[48:51], s4 offen sc1
  v_mfma_f32_16x16x32_bf16 v[192:195], v[68:71], v[32:35], v[192:195]
  s_add_u32 s4, s20, 163840
  v_mfma_f32_16x16x32_bf16 v[196:199], v[68:71], v[36:39], v[196:199]
  buffer_load_dwordx4 v[228:231], v20, s[48:51], s4 offen offset:0 sc1
  v_mfma_f32_16x16x32_bf16 v[200:203], v[68:71], v[40:43], v[200:203]
  v_mov_b32 v30, 0
  v_mfma_f32_16x16x32_bf16 v[204:207], v[68:71], v[44:47], v[204:207]
  buffer_load_dword v30, v30, s[84:87], 0 offen offset:136 sc1
  s_waitcnt vmcnt(17) lgkmcnt(0)
  s_barrier
  v_mfma_f32_16x16x32_bf16 v[112:115], v[88:91], v[72:75], v[112:115]
  ds_read_b128 v[32:35], v17 offset:0
  v_mfma_f32_16x16x32_bf16 v[116:119], v[88:91], v[76:79], v[116:119]
  ds_read_b128 v[36:39], v17 offset:2048
  v_mfma_f32_16x16x32_bf16 v[120:123], v[88:91], v[80:83], v[120:123]
  ds_read_b128 v[40:43], v17 offset:4096
  v_mfma_f32_16x16x32_bf16 v[124:127], v[88:91], v[84:87], v[124:127]
  ds_read_b128 v[44:47], v17 offset:6144
  v_mfma_f32_16x16x32_bf16 v[128:131], v[92:95], v[72:75], v[128:131]
  v_mfma_f32_16x16x32_bf16 v[132:135], v[92:95], v[76:79], v[132:135]
  ds_read_b64_tr_b16 v[48:49], v26 offset:12288
  v_mfma_f32_16x16x32_bf16 v[136:139], v[92:95], v[80:83], v[136:139]
  ds_read_b64_tr_b16 v[50:51], v26 offset:13056
  v_mfma_f32_16x16x32_bf16 v[140:143], v[92:95], v[84:87], v[140:143]
  ds_read_b64_tr_b16 v[52:53], v27 offset:12288
  v_mfma_f32_16x16x32_bf16 v[144:147], v[96:99], v[72:75], v[144:147]
  ds_read_b64_tr_b16 v[54:55], v27 offset:13056
  v_mfma_f32_16x16x32_bf16 v[148:151], v[96:99], v[76:79], v[148:151]
  v_mfma_f32_16x16x32_bf16 v[152:155], v[96:99], v[80:83], v[152:155]
  ds_read_b64_tr_b16 v[56:57], v28 offset:12288
  v_mfma_f32_16x16x32_bf16 v[156:159], v[96:99], v[84:87], v[156:159]
  ds_read_b64_tr_b16 v[58:59], v28 offset:13056
  v_mfma_f32_16x16x32_bf16 v[160:163], v[100:103], v[72:75], v[160:163]
  ds_read_b64_tr_b16 v[60:61], v26 offset:18432
  v_mfma_f32_16x16x32_bf16 v[164:167], v[100:103], v[76:79], v[164:167]
  ds_read_b64_tr_b16 v[62:63], v26 offset:19200
  v_mfma_f32_16x16x32_bf16 v[168:171], v[100:103], v[80:83], v[168:171]
  v_mfma_f32_16x16x32_bf16 v[172:175], v[100:103], v[84:87], v[172:175]
  ds_read_b64_tr_b16 v[64:65], v27 offset:18432
  v_mfma_f32_16x16x32_bf16 v[176:179], v[104:107], v[72:75], v[176:179]
  ds_read_b64_tr_b16 v[66:67], v27 offset:19200
  v_mfma_f32_16x16x32_bf16 v[180:183], v[104:107], v[76:79], v[180:183]
  ds_read_b64_tr_b16 v[68:69], v28 offset:18432
  v_mfma_f32_16x16x32_bf16 v[184:187], v[104:107], v[80:83], v[184:187]
  ds_read_b64_tr_b16 v[70:71], v28 offset:19200
  v_mfma_f32_16x16x32_bf16 v[188:191], v[104:107], v[84:87], v[188:191]
  v_mfma_f32_16x16x32_bf16 v[192:195], v[108:111], v[72:75], v[192:195]
  s_add_u32 s4, s20, 163840
  v_mfma_f32_16x16x32_bf16 v[196:199], v[108:111], v[76:79], v[196:199]
  buffer_load_dwordx4 v[232:235], v20, s[48:51], s4 offen offset:1024 sc1
  v_mfma_f32_16x16x32_bf16 v[200:203], v[108:111], v[80:83], v[200:203]
  buffer_load_dwordx4 v[236:239], v20, s[48:51], s4 offen offset:2048 sc1
  v_mfma_f32_16x16x32_bf16 v[204:207], v[108:111], v[84:87], v[204:207]
  s_waitcnt vmcnt(2) lgkmcnt(0)
  v_readfirstlane_b32 s14, v30
  s_nop 0
  s_cmp_eq_u32 s14, 0
  s_cbranch_scc1 INITOK_13o
INITOK_13:
  s_barrier
  v_mfma_f32_16x16x32_bf16 v[112:115], v[48:51], v[32:35], v[112:115]
  ds_read_b128 v[72:75], v18 offset:0
  ds_read_b128 v[76:79], v18 offset:2048
  v_mfma_f32_16x16x32_bf16 v[116:119], v[48:51], v[36:39], v[116:119]
  ds_read_b128 v[80:83], v18 offset:4096
  v_mfma_f32_16x16x32_bf16 v[120:123], v[48:51], v[40:43], v[120:123]
  ds_read_b128 v[84:87], v18 offset:6144
  v_mfma_f32_16x16x32_bf16 v[124:127], v[48:51], v[44:47], v[124:127]
  ds_read_b64_tr_b16 v[88:89], v26 offset:24576
  v_mfma_f32_16x16x32_bf16 v[128:131], v[52:55], v[32:35], v[128:131]
  ds_read_b64_tr_b16 v[90:91], v26 offset:25344
  v_mfma_f32_16x16x32_bf16 v[132:135], v[52:55], v[36:39], v[132:135]
  ds_read_b64_tr_b16 v[92:93], v27 offset:24576
  ds_read_b64_tr_b16 v[94:95], v27 offset:25344
  v_mfma_f32_16x16x32_bf16 v[136:139], v[52:55], v[40:43], v[136:139]
  ds_read_b64_tr_b16 v[96:97], v28 offset:24576
  v_mfma_f32_16x16x32_bf16 v[140:143], v[52:55], v[44:47], v[140:143]
  ds_read_b64_tr_b16 v[98:99], v28 offset:25344
  v_mfma_f32_16x16x32_bf16 v[144:147], v[56:59], v[32:35], v[144:147]
  ds_read_b64_tr_b16 v[100:101], v26 offset:30720
  v_mfma_f32_16x16x32_bf16 v[148:151], v[56:59], v[36:39], v[148:151]
  ds_read_b64_tr_b16 v[102:103], v26 offset:31488
  v_mfma_f32_16x16x32_bf16 v[152:155], v[56:59], v[40:43], v[152:155]
  ds_read_b64_tr_b16 v[104:105], v27 offset:30720
  v_mfma_f32_16x16x32_bf16 v[156:159], v[56:59], v[44:47], v[156:159]
  ds_read_b64_tr_b16 v[106:107], v27 offset:31488
  ds_read_b64_tr_b16 v[108:109], v28 offset:30720
  v_mfma_f32_16x16x32_bf16 v[160:163], v[60:63], v[32:35], v[160:163]
  ds_read_b64_tr_b16 v[110:111], v28 offset:31488
  v_mfma_f32_16x16x32_bf16 v[164:167], v[60:63], v[36:39], v[164:167]
  s_add_u32 s4, s19, 1310720
  v_mfma_f32_16x16x32_bf16 v[168:171], v[60:63], v[40:43], v[168:171]
  s_add_u32 s5, s21, 40960
  v_mfma_f32_16x16x32_bf16 v[172:175], v[60:63], v[44:47], v[172:175]
  s_add_u32 s4, s4, s22
  v_mfma_f32_16x16x32_bf16 v[176:179], v[64:67], v[32:35], v[176:179]
  s_mul_i32 s6, s23, 3
  v_mfma_f32_16x16x32_bf16 v[180:183], v[64:67], v[36:39], v[180:183]
  s_add_u32 s5, s5, s6
  s_mov_b32 m0, s5
  v_mfma_f32_16x16x32_bf16 v[184:187], v[64:67], v[40:43], v[184:187]
  buffer_load_dwordx4 v20, s[48:51], s4 offen offset:0 sc1 lds
  v_mfma_f32_16x16x32_bf16 v[188:191], v[64:67], v[44:47], v[188:191]
  buffer_load_dwordx4 v20, s[48:51], s4 offen offset:1024 sc1 lds
  v_mfma_f32_16x16x32_bf16 v[192:195], v[68:71], v[32:35], v[192:195]
  buffer_load_dwordx4 v20, s[48:51], s4 offen offset:2048 sc1 lds
  v_mfma_f32_16x16x32_bf16 v[196:199], v[68:71], v[36:39], v[196:199]
  buffer_load_dwordx4 v20, s[48:51], s4 offen offset:3072 sc1 lds
  v_mfma_f32_16x16x32_bf16 v[200:203], v[68:71], v[40:43], v[200:203]
  s_add_u32 m0, s5, 4096
  v_mfma_f32_16x16x32_bf16 v[204:207], v[68:71], v[44:47], v[204:207]
  buffer_load_dwordx4 v21, s[48:51], s4 offen sc1 lds
  s_waitcnt vmcnt(7) lgkmcnt(0)
  s_barrier
  v_mfma_f32_16x16x32_bf16 v[112:115], v[88:91], v[72:75], v[112:115]
  ds_read_b128 v[32:35], v15 offset:0
  ds_read_b128 v[36:39], v15 offset:2048
  v_mfma_f32_16x16x32_bf16 v[116:119], v[88:91], v[76:79], v[116:119]
  ds_read_b128 v[40:43], v15 offset:4096
  v_mfma_f32_16x16x32_bf16 v[120:123], v[88:91], v[80:83], v[120:123]
  ds_read_b128 v[44:47], v15 offset:6144
  v_mfma_f32_16x16x32_bf16 v[124:127], v[88:91], v[84:87], v[124:127]
  ds_read_b64_tr_b16 v[48:49], v26 offset:36864
  v_mfma_f32_16x16x32_bf16 v[128:131], v[92:95], v[72:75], v[128:131]
  ds_read_b64_tr_b16 v[50:51], v26 offset:37632
  v_mfma_f32_16x16x32_bf16 v[132:135], v[92:95], v[76:79], v[132:135]
  ds_read_b64_tr_b16 v[52:53], v27 offset:36864
  v_mfma_f32_16x16x32_bf16 v[136:139], v[92:95], v[80:83], v[136:139]
  ds_read_b64_tr_b16 v[54:55], v27 offset:37632
  v_mfma_f32_16x16x32_bf16 v[140:143], v[92:95], v[84:87], v[140:143]
  ds_read_b64_tr_b16 v[56:57], v28 offset:36864
  ds_read_b64_tr_b16 v[58:59], v28 offset:37632
  v_mfma_f32_16x16x32_bf16 v[144:147], v[96:99], v[72:75], v[144:147]
  ds_read_b64_tr_b16 v[60:61], v26 offset:43008
  v_mfma_f32_16x16x32_bf16 v[148:151], v[96:99], v[76:79], v[148:151]
  ds_read_b64_tr_b16 v[62:63], v26 offset:43776
  v_mfma_f32_16x16x32_bf16 v[152:155], v[96:99], v[80:83], v[152:155]
  ds_read_b64_tr_b16 v[64:65], v27 offset:43008
  v_mfma_f32_16x16x32_bf16 v[156:159], v[96:99], v[84:87], v[156:159]
  ds_read_b64_tr_b16 v[66:67], v27 offset:43776
  v_mfma_f32_16x16x32_bf16 v[160:163], v[100:103], v[72:75], v[160:163]
  ds_read_b64_tr_b16 v[68:69], v28 offset:43008
  v_mfma_f32_16x16x32_bf16 v[164:167], v[100:103], v[76:79], v[164:167]
  ds_read_b64_tr_b16 v[70:71], v28 offset:43776
  v_mfma_f32_16x16x32_bf16 v[168:171], v[100:103], v[80:83], v[168:171]
  s_add_u32 s4, s19, 1638400
  v_mfma_f32_16x16x32_bf16 v[172:175], v[100:103], v[84:87], v[172:175]
  s_add_u32 s5, s21, 61440
  s_add_u32 s4, s4, s22
  v_mfma_f32_16x16x32_bf16 v[176:179], v[104:107], v[72:75], v[176:179]
  s_add_u32 s5, s5, s23
  v_mfma_f32_16x16x32_bf16 v[180:183], v[104:107], v[76:79], v[180:183]
  s_mov_b32 m0, s5
  v_mfma_f32_16x16x32_bf16 v[184:187], v[104:107], v[80:83], v[184:187]
  buffer_load_dwordx4 v20, s[48:51], s4 offen offset:0 sc1 lds
  v_mfma_f32_16x16x32_bf16 v[188:191], v[104:107], v[84:87], v[188:191]
  buffer_load_dwordx4 v20, s[48:51], s4 offen offset:1024 sc1 lds
  v_mfma_f32_16x16x32_bf16 v[192:195], v[108:111], v[72:75], v[192:195]
  buffer_load_dwordx4 v20, s[48:51], s4 offen offset:2048 sc1 lds
  v_mfma_f32_16x16x32_bf16 v[196:199], v[108:111], v[76:79], v[196:199]
  buffer_load_dwordx4 v20, s[48:51], s4 offen offset:3072 sc1 lds
  v_mfma_f32_16x16x32_bf16 v[200:203], v[108:111], v[80:83], v[200:203]
  s_add_u32 m0, s5, 4096
  v_mfma_f32_16x16x32_bf16 v[204:207], v[108:111], v[84:87], v[204:207]
  buffer_load_dwordx4 v21, s[48:51], s4 offen sc1 lds
  s_waitcnt lgkmcnt(0)
  v_mfma_f32_16x16x32_bf16 v[112:115], v[48:51], v[32:35], v[112:115]
  ds_read_b128 v[72:75], v16 offset:0
  v_mfma_f32_16x16x32_bf16 v[116:119], v[48:51], v[36:39], v[116:119]
  ds_read_b128 v[76:79], v16 offset:2048
  v_mfma_f32_16x16x32_bf16 v[120:123], v[48:51], v[40:43], v[120:123]
  ds_read_b128 v[80:83], v16 offset:4096
  v_mfma_f32_16x16x32_bf16 v[124:127], v[48:51], v[44:47], v[124:127]
  ds_read_b128 v[84:87], v16 offset:6144
  v_mfma_f32_16x16x32_bf16 v[128:131], v[52:55], v[32:35], v[128:131]
  v_mfma_f32_16x16x32_bf16 v[132:135], v[52:55], v[36:39], v[132:135]
  ds_read_b64_tr_b16 v[88:89], v26 offset:49152
  v_mfma_f32_16x16x32_bf16 v[136:139], v[52:55], v[40:43], v[136:139]
  ds_read_b64_tr_b16 v[90:91], v26 offset:49920
  v_mfma_f32_16x16x32_bf16 v[140:143], v[52:55], v[44:47], v[140:143]
  ds_read_b64_tr_b16 v[92:93], v27 offset:49152
  v_mfma_f32_16x16x32_bf16 v[144:147], v[56:59], v[32:35], v[144:147]
  ds_read_b64_tr_b16 v[94:95], v27 offset:49920
  v_mfma_f32_16x16x32_bf16 v[148:151], v[56:59], v[36:39], v[148:151]
  v_mfma_f32_16x16x32_bf16 v[152:155], v[56:59], v[40:43], v[152:155]
  ds_read_b64_tr_b16 v[96:97], v28 offset:49152
  v_mfma_f32_16x16x32_bf16 v[156:159], v[56:59], v[44:47], v[156:159]
  ds_read_b64_tr_b16 v[98:99], v28 offset:49920
  v_mfma_f32_16x16x32_bf16 v[160:163], v[60:63], v[32:35], v[160:163]
  ds_read_b64_tr_b16 v[100:101], v26 offset:55296
  v_mfma_f32_16x16x32_bf16 v[164:167], v[60:63], v[36:39], v[164:167]
  ds_read_b64_tr_b16 v[102:103], v26 offset:56064
  v_mfma_f32_16x16x32_bf16 v[168:171], v[60:63], v[40:43], v[168:171]
  v_mfma_f32_16x16x32_bf16 v[172:175], v[60:63], v[44:47], v[172:175]
  ds_read_b64_tr_b16 v[104:105], v27 offset:55296
  v_mfma_f32_16x16x32_bf16 v[176:179], v[64:67], v[32:35], v[176:179]
  ds_read_b64_tr_b16 v[106:107], v27 offset:56064
  v_mfma_f32_16x16x32_bf16 v[180:183], v[64:67], v[36:39], v[180:183]
  ds_read_b64_tr_b16 v[108:109], v28 offset:55296
  v_mfma_f32_16x16x32_bf16 v[184:187], v[64:67], v[40:43], v[184:187]
  ds_read_b64_tr_b16 v[110:111], v28 offset:56064
  v_mfma_f32_16x16x32_bf16 v[188:191], v[64:67], v[44:47], v[188:191]
  v_mfma_f32_16x16x32_bf16 v[192:195], v[68:71], v[32:35], v[192:195]
  s_add_u32 s4, s20, 163840
  v_mfma_f32_16x16x32_bf16 v[196:199], v[68:71], v[36:39], v[196:199]
  buffer_load_dwordx4 v[240:243], v20, s[48:51], s4 offen offset:3072 sc1
  v_mfma_f32_16x16x32_bf16 v[200:203], v[68:71], v[40:43], v[200:203]
  buffer_load_dwordx4 v[244:247], v21, s[48:51], s4 offen sc1
  v_mfma_f32_16x16x32_bf16 v[204:207], v[68:71], v[44:47], v[204:207]
  s_waitcnt lgkmcnt(0)
  v_mfma_f32_16x16x32_bf16 v[112:115], v[88:91], v[72:75], v[112:115]
  v_mfma_f32_16x16x32_bf16 v[116:119], v[88:91], v[76:79], v[116:119]
  v_mfma_f32_16x16x32_bf16 v[120:123], v[88:91], v[80:83], v[120:123]
  v_mfma_f32_16x16x32_bf16 v[124:127], v[88:91], v[84:87], v[124:127]
  v_mfma_f32_16x16x32_bf16 v[128:131], v[92:95], v[72:75], v[128:131]
  v_mfma_f32_16x16x32_bf16 v[132:135], v[92:95], v[76:79], v[132:135]
  v_mfma_f32_16x16x32_bf16 v[136:139], v[92:95], v[80:83], v[136:139]
  v_mfma_f32_16x16x32_bf16 v[140:143], v[92:95], v[84:87], v[140:143]
  v_mfma_f32_16x16x32_bf16 v[144:147], v[96:99], v[72:75], v[144:147]
  v_mfma_f32_16x16x32_bf16 v[148:151], v[96:99], v[76:79], v[148:151]
  v_mfma_f32_16x16x32_bf16 v[152:155], v[96:99], v[80:83], v[152:155]
  v_mfma_f32_16x16x32_bf16 v[156:159], v[96:99], v[84:87], v[156:159]
  v_mfma_f32_16x16x32_bf16 v[160:163], v[100:103], v[72:75], v[160:163]
  v_mfma_f32_16x16x32_bf16 v[164:167], v[100:103], v[76:79], v[164:167]
  v_mfma_f32_16x16x32_bf16 v[168:171], v[100:103], v[80:83], v[168:171]
  v_mfma_f32_16x16x32_bf16 v[172:175], v[100:103], v[84:87], v[172:175]
  v_mfma_f32_16x16x32_bf16 v[176:179], v[104:107], v[72:75], v[176:179]
  v_mfma_f32_16x16x32_bf16 v[180:183], v[104:107], v[76:79], v[180:183]
  v_mfma_f32_16x16x32_bf16 v[184:187], v[104:107], v[80:83], v[184:187]
  v_mfma_f32_16x16x32_bf16 v[188:191], v[104:107], v[84:87], v[188:191]
  v_mfma_f32_16x16x32_bf16 v[192:195], v[108:111], v[72:75], v[192:195]
  v_mfma_f32_16x16x32_bf16 v[196:199], v[108:111], v[76:79], v[196:199]
  v_mfma_f32_16x16x32_bf16 v[200:203], v[108:111], v[80:83], v[200:203]
  v_mfma_f32_16x16x32_bf16 v[204:207], v[108:111], v[84:87], v[204:207]
  s_setprio 2
  s_mov_b32 s82, 0xbfb8aa3b
  s_mov_b32 s83, 0xbfb8aa3b
  s_lshl_b32 s70, s63, 2
  s_add_u32 s70, s70, s71
  s_mul_i32 s67, s70, 74
  s_mul_i32 s68, s73, 3
  s_add_u32 s67, s67, s68
  s_lshl_b32 s67, s67, 12
  s_lshl_b32 s68, s72, 13
  s_add_u32 s68, s67, s68
  s_lshl_b32 s69, s72, 9
  s_add_u32 s69, s69, s67
  s_add_u32 s69, s69, 4096
  s_lshl_b32 s88, s70, 7
  s_add_u32 s88, s88, 19070976
  v_lshlrev_b32 v2, 4, v0
  v_and_b32 v3, 31, v0
  v_lshlrev_b32 v3, 4, v3
  v_lshrrev_b32 v4, 5, v0
  v_lshl_add_u32 v3, v4, 10, v3
  v_pk_mul_f32 v[72:73], v[112:113], s[82:83]
  v_pk_mul_f32 v[74:75], v[114:115], s[82:83]
  v_pk_mul_f32 v[76:77], v[128:129], s[82:83]
  v_pk_mul_f32 v[78:79], v[130:131], s[82:83]
  v_exp_f32 v72, v72
  v_exp_f32 v73, v73
  v_exp_f32 v74, v74
  v_exp_f32 v75, v75
  v_exp_f32 v76, v76
  v_exp_f32 v77, v77
  v_exp_f32 v78, v78
  v_exp_f32 v79, v79
  v_pk_mul_f32 v[112:113], v[112:113], v[160:161]
  v_pk_mul_f32 v[114:115], v[114:115], v[162:163]
  v_pk_mul_f32 v[128:129], v[128:129], v[176:177]
  v_pk_mul_f32 v[130:131], v[130:131], v[178:179]
  v_pk_add_f32 v[72:73], v[72:73], 1.0 op_sel_hi:[1,0]
  v_pk_add_f32 v[74:75], v[74:75], 1.0 op_sel_hi:[1,0]
  v_pk_add_f32 v[76:77], v[76:77], 1.0 op_sel_hi:[1,0]
  v_pk_add_f32 v[78:79], v[78:79], 1.0 op_sel_hi:[1,0]
  v_rcp_f32 v72, v72
  v_rcp_f32 v73, v73
  v_rcp_f32 v74, v74
  v_rcp_f32 v75, v75
  v_rcp_f32 v76, v76
  v_rcp_f32 v77, v77
  v_rcp_f32 v78, v78
  v_rcp_f32 v79, v79
  v_pk_mul_f32 v[112:113], v[112:113], v[72:73]
  v_pk_mul_f32 v[114:115], v[114:115], v[74:75]
  v_pk_mul_f32 v[128:129], v[128:129], v[76:77]
  v_pk_mul_f32 v[130:131], v[130:131], v[78:79]
  v_cvt_pk_bf16_f32 v80, v112, v113
  v_cvt_pk_bf16_f32 v81, v114, v115
  v_cvt_pk_bf16_f32 v82, v128, v129
  v_cvt_pk_bf16_f32 v83, v130, v131
  buffer_store_dwordx4 v[80:83], v2, s[48:51], s68 offen offset:0 sc1
  v_pk_mul_f32 v[72:73], v[116:117], s[82:83]
  v_pk_mul_f32 v[74:75], v[118:119], s[82:83]
  v_pk_mul_f32 v[76:77], v[132:133], s[82:83]
  v_pk_mul_f32 v[78:79], v[134:135], s[82:83]
  v_exp_f32 v72, v72
  v_exp_f32 v73, v73
  v_exp_f32 v74, v74
  v_exp_f32 v75, v75
  v_exp_f32 v76, v76
  v_exp_f32 v77, v77
  v_exp_f32 v78, v78
  v_exp_f32 v79, v79
  v_pk_mul_f32 v[116:117], v[116:117], v[164:165]
  v_pk_mul_f32 v[118:119], v[118:119], v[166:167]
  v_pk_mul_f32 v[132:133], v[132:133], v[180:181]
  v_pk_mul_f32 v[134:135], v[134:135], v[182:183]
  v_pk_add_f32 v[72:73], v[72:73], 1.0 op_sel_hi:[1,0]
  v_pk_add_f32 v[74:75], v[74:75], 1.0 op_sel_hi:[1,0]
  v_pk_add_f32 v[76:77], v[76:77], 1.0 op_sel_hi:[1,0]
  v_pk_add_f32 v[78:79], v[78:79], 1.0 op_sel_hi:[1,0]
  v_rcp_f32 v72, v72
  v_rcp_f32 v73, v73
  v_rcp_f32 v74, v74
  v_rcp_f32 v75, v75
  v_rcp_f32 v76, v76
  v_rcp_f32 v77, v77
  v_rcp_f32 v78, v78
  v_rcp_f32 v79, v79
  v_pk_mul_f32 v[116:117], v[116:117], v[72:73]
  v_pk_mul_f32 v[118:119], v[118:119], v[74:75]
  v_pk_mul_f32 v[132:133], v[132:133], v[76:77]
  v_pk_mul_f32 v[134:135], v[134:135], v[78:79]
  v_cvt_pk_bf16_f32 v84, v116, v117
  v_cvt_pk_bf16_f32 v85, v118, v119
  v_cvt_pk_bf16_f32 v86, v132, v133
  v_cvt_pk_bf16_f32 v87, v134, v135
  buffer_store_dwordx4 v[84:87], v2, s[48:51], s68 offen offset:1024 sc1
  v_pk_mul_f32 v[72:73], v[120:121], s[82:83]
  v_pk_mul_f32 v[74:75], v[122:123], s[82:83]
  v_pk_mul_f32 v[76:77], v[136:137], s[82:83]
  v_pk_mul_f32 v[78:79], v[138:139], s[82:83]
  v_exp_f32 v72, v72
  v_exp_f32 v73, v73
  v_exp_f32 v74, v74
  v_exp_f32 v75, v75
  v_exp_f32 v76, v76
  v_exp_f32 v77, v77
  v_exp_f32 v78, v78
  v_exp_f32 v79, v79
  v_pk_mul_f32 v[120:121], v[120:121], v[168:169]
  v_pk_mul_f32 v[122:123], v[122:123], v[170:171]
  v_pk_mul_f32 v[136:137], v[136:137], v[184:185]
  v_pk_mul_f32 v[138:139], v[138:139], v[186:187]
  v_pk_add_f32 v[72:73], v[72:73], 1.0 op_sel_hi:[1,0]
  v_pk_add_f32 v[74:75], v[74:75], 1.0 op_sel_hi:[1,0]
  v_pk_add_f32 v[76:77], v[76:77], 1.0 op_sel_hi:[1,0]
  v_pk_add_f32 v[78:79], v[78:79], 1.0 op_sel_hi:[1,0]
  v_rcp_f32 v72, v72
  v_rcp_f32 v73, v73
  v_rcp_f32 v74, v74
  v_rcp_f32 v75, v75
  v_rcp_f32 v76, v76
  v_rcp_f32 v77, v77
  v_rcp_f32 v78, v78
  v_rcp_f32 v79, v79
  v_pk_mul_f32 v[120:121], v[120:121], v[72:73]
  v_pk_mul_f32 v[122:123], v[122:123], v[74:75]
  v_pk_mul_f32 v[136:137], v[136:137], v[76:77]
  v_pk_mul_f32 v[138:139], v[138:139], v[78:79]
  v_cvt_pk_bf16_f32 v88, v120, v121
  v_cvt_pk_bf16_f32 v89, v122, v123
  v_cvt_pk_bf16_f32 v90, v136, v137
  v_cvt_pk_bf16_f32 v91, v138, v139
  buffer_store_dwordx4 v[88:91], v2, s[48:51], s68 offen offset:2048 sc1
  v_pk_mul_f32 v[72:73], v[124:125], s[82:83]
  v_pk_mul_f32 v[74:75], v[126:127], s[82:83]
  v_pk_mul_f32 v[76:77], v[140:141], s[82:83]
  v_pk_mul_f32 v[78:79], v[142:143], s[82:83]
  v_exp_f32 v72, v72
  v_exp_f32 v73, v73
  v_exp_f32 v74, v74
  v_exp_f32 v75, v75
  v_exp_f32 v76, v76
  v_exp_f32 v77, v77
  v_exp_f32 v78, v78
  v_exp_f32 v79, v79
  v_pk_mul_f32 v[124:125], v[124:125], v[172:173]
  v_pk_mul_f32 v[126:127], v[126:127], v[174:175]
  v_pk_mul_f32 v[140:141], v[140:141], v[188:189]
  v_pk_mul_f32 v[142:143], v[142:143], v[190:191]
  v_pk_add_f32 v[72:73], v[72:73], 1.0 op_sel_hi:[1,0]
  v_pk_add_f32 v[74:75], v[74:75], 1.0 op_sel_hi:[1,0]
  v_pk_add_f32 v[76:77], v[76:77], 1.0 op_sel_hi:[1,0]
  v_pk_add_f32 v[78:79], v[78:79], 1.0 op_sel_hi:[1,0]
  v_rcp_f32 v72, v72
  v_rcp_f32 v73, v73
  v_rcp_f32 v74, v74
  v_rcp_f32 v75, v75
  v_rcp_f32 v76, v76
  v_rcp_f32 v77, v77
  v_rcp_f32 v78, v78
  v_rcp_f32 v79, v79
  v_pk_mul_f32 v[124:125], v[124:125], v[72:73]
  v_pk_mul_f32 v[126:127], v[126:127], v[74:75]
  v_pk_mul_f32 v[140:141], v[140:141], v[76:77]
  v_pk_mul_f32 v[142:143], v[142:143], v[78:79]
  v_cvt_pk_bf16_f32 v92, v124, v125
  v_cvt_pk_bf16_f32 v93, v126, v127
  v_cvt_pk_bf16_f32 v94, v140, v141
  v_cvt_pk_bf16_f32 v95, v142, v143
  buffer_store_dwordx4 v[92:95], v2, s[48:51], s68 offen offset:3072 sc1
  v_mov_b32 v31, 0
  buffer_load_dword v31, v31, s[48:51], s78 offen offset:4 sc1
  v_pk_mul_f32 v[72:73], v[144:145], s[82:83]
  v_pk_mul_f32 v[74:75], v[146:147], s[82:83]
  v_pk_mul_f32 v[76:77], v[148:149], s[82:83]
  v_pk_mul_f32 v[78:79], v[150:151], s[82:83]
  v_exp_f32 v72, v72
  v_exp_f32 v73, v73
  v_exp_f32 v74, v74
  v_exp_f32 v75, v75
  v_exp_f32 v76, v76
  v_exp_f32 v77, v77
  v_exp_f32 v78, v78
  v_exp_f32 v79, v79
  v_pk_mul_f32 v[144:145], v[144:145], v[192:193]
  v_pk_mul_f32 v[146:147], v[146:147], v[194:195]
  v_pk_mul_f32 v[148:149], v[148:149], v[196:197]
  v_pk_mul_f32 v[150:151], v[150:151], v[198:199]
  v_pk_add_f32 v[72:73], v[72:73], 1.0 op_sel_hi:[1,0]
  v_pk_add_f32 v[74:75], v[74:75], 1.0 op_sel_hi:[1,0]
  v_pk_add_f32 v[76:77], v[76:77], 1.0 op_sel_hi:[1,0]
  v_pk_add_f32 v[78:79], v[78:79], 1.0 op_sel_hi:[1,0]
  v_rcp_f32 v72, v72
  v_rcp_f32 v73, v73
  v_rcp_f32 v74, v74
  v_rcp_f32 v75, v75
  v_rcp_f32 v76, v76
  v_rcp_f32 v77, v77
  v_rcp_f32 v78, v78
  v_rcp_f32 v79, v79
  v_pk_mul_f32 v[144:145], v[144:145], v[72:73]
  v_pk_mul_f32 v[146:147], v[146:147], v[74:75]
  v_pk_mul_f32 v[148:149], v[148:149], v[76:77]
  v_pk_mul_f32 v[150:151], v[150:151], v[78:79]
  v_cvt_pk_bf16_f32 v96, v144, v145
  v_cvt_pk_bf16_f32 v97, v146, v147
  v_cvt_pk_bf16_f32 v98, v148, v149
  v_cvt_pk_bf16_f32 v99, v150, v151
  s_nop 0
  v_permlane32_swap_b32 v96, v98
  v_permlane32_swap_b32 v97, v99
  buffer_store_dwordx4 v[96:99], v3, s[48:51], s69 offen offset:0 sc1
  v_pk_mul_f32 v[72:73], v[152:153], s[82:83]
  v_pk_mul_f32 v[74:75], v[154:155], s[82:83]
  v_pk_mul_f32 v[76:77], v[156:157], s[82:83]
  v_pk_mul_f32 v[78:79], v[158:159], s[82:83]
  v_exp_f32 v72, v72
  v_exp_f32 v73, v73
  v_exp_f32 v74, v74
  v_exp_f32 v75, v75
  v_exp_f32 v76, v76
  v_exp_f32 v77, v77
  v_exp_f32 v78, v78
  v_exp_f32 v79, v79
  v_pk_mul_f32 v[152:153], v[152:153], v[200:201]
  v_pk_mul_f32 v[154:155], v[154:155], v[202:203]
  v_pk_mul_f32 v[156:157], v[156:157], v[204:205]
  v_pk_mul_f32 v[158:159], v[158:159], v[206:207]
  v_pk_add_f32 v[72:73], v[72:73], 1.0 op_sel_hi:[1,0]
  v_pk_add_f32 v[74:75], v[74:75], 1.0 op_sel_hi:[1,0]
  v_pk_add_f32 v[76:77], v[76:77], 1.0 op_sel_hi:[1,0]
  v_pk_add_f32 v[78:79], v[78:79], 1.0 op_sel_hi:[1,0]
  v_rcp_f32 v72, v72
  v_rcp_f32 v73, v73
  v_rcp_f32 v74, v74
  v_rcp_f32 v75, v75
  v_rcp_f32 v76, v76
  v_rcp_f32 v77, v77
  v_rcp_f32 v78, v78
  v_rcp_f32 v79, v79
  v_pk_mul_f32 v[152:153], v[152:153], v[72:73]
  v_pk_mul_f32 v[154:155], v[154:155], v[74:75]
  v_pk_mul_f32 v[156:157], v[156:157], v[76:77]
  v_pk_mul_f32 v[158:159], v[158:159], v[78:79]
  v_cvt_pk_bf16_f32 v100, v152, v153
  v_cvt_pk_bf16_f32 v101, v154, v155
  v_cvt_pk_bf16_f32 v102, v156, v157
  v_cvt_pk_bf16_f32 v103, v158, v159
  s_nop 0
  v_permlane32_swap_b32 v100, v102
  v_permlane32_swap_b32 v101, v103
  buffer_store_dwordx4 v[100:103], v3, s[48:51], s69 offen offset:2048 sc1
  s_mov_b32 s7, 35
  s_waitcnt vmcnt(2)
  s_mov_b32 s8, 0
  s_mov_b32 s77, 0
  s_branch P2
T2_1o:
  s_mul_i32 s4, s95, 5
  s_add_u32 s4, s4, s100
  v_add_u32 v3, s4, v22
  s_mov_b32 exec_hi, 0
  buffer_load_dword v19, v3, s[96:99], 0 offen
  s_mov_b64 exec, -1
  s_branch T2_1
T2_2o:
  s_mul_i32 s4, s95, 4
  s_add_u32 s4, s4, s100
  v_add_u32 v3, s4, v22
  s_mov_b32 exec_hi, 0
  buffer_load_dword v19, v3, s[96:99], 0 offen
  s_mov_b64 exec, -1
  s_branch T2_2
T2_3o:
  s_mul_i32 s4, s95, 7
  s_add_u32 s4, s4, s100
  v_add_u32 v3, s4, v22
  s_mov_b32 exec_hi, 0
  buffer_load_dword v19, v3, s[96:99], 0 offen
  s_mov_b64 exec, -1
  s_branch T2_3
T2_4o:
  s_mul_i32 s4, s95, 6
  s_add_u32 s4, s4, s100
  v_add_u32 v3, s4, v22
  s_mov_b32 exec_hi, 0
  buffer_load_dword v19, v3, s[96:99], 0 offen
  s_mov_b64 exec, -1
  s_branch T2_4
T2_5o:
  s_mul_i32 s4, s95, 9
  s_add_u32 s4, s4, s100
  v_add_u32 v3, s4, v22
  s_mov_b32 exec_hi, 0
  buffer_load_dword v19, v3, s[96:99], 0 offen
  s_mov_b64 exec, -1
  s_branch T2_5
T2_6o:
  s_mul_i32 s4, s95, 8
  s_add_u32 s4, s4, s100
  v_add_u32 v3, s4, v22
  s_mov_b32 exec_hi, 0
  buffer_load_dword v19, v3, s[96:99], 0 offen
  s_mov_b64 exec, -1
  s_branch T2_6
INITOK_7o:
  s_mov_b32 s89, 0x80000
POLL_1008:
  v_mov_b32 v29, 0
  buffer_load_dword v29, v29, s[84:87], 0 offen offset:128 sc1
  s_waitcnt vmcnt(0)
  v_readfirstlane_b32 s14, v29
  s_nop 0
  s_cmp_lg_u32 s14, 0
  s_cbranch_scc1 POLLD_1009
  s_sleep 2
  s_sub_u32 s89, s89, 1
  s_cbranch_scc0 POLL_1008
POLLD_1009:
  s_branch INITOK_7
INITOK_13o:
  s_mov_b32 s89, 0x80000
POLL_1014:
  v_mov_b32 v30, 0
  buffer_load_dword v30, v30, s[84:87], 0 offen offset:136 sc1
  s_waitcnt vmcnt(0)
  v_readfirstlane_b32 s14, v30
  s_nop 0
  s_cmp_lg_u32 s14, 0
  s_cbranch_scc1 POLLD_1015
  s_sleep 2
  s_sub_u32 s89, s89, 1
  s_cbranch_scc0 POLL_1014
POLLD_1015:
  s_branch INITOK_13
R_QKV:
  s_mov_b32 s44, s18
  s_and_b32 s45, s19, 0xffff
  s_mov_b32 s46, 2457600
  s_mov_b32 s47, 0x20000
  s_mov_b32 s52, s20
  s_and_b32 s53, s21, 0xffff
  s_mov_b32 s54, 25600
  s_mov_b32 s55, 0x20000
  s_lshl_b32 s73, s67, 1
  s_add_u32 s73, s73, s75
  s_mul_i32 s77, s73, 160
  s_add_u32 s78, s77, 2560
  s_add_u32 s77, s77, 1280
  s_lshl_b32 s82, s73, 2
  s_mul_i32 s68, s67, 320
  s_add_u32 s69, s68, 160
  s_lshl_b32 s70, s67, 3
  s_cmp_eq_u32 s75, 2
  s_cselect_b32 s77, s68, s77
  s_cselect_b32 s78, s69, s78
  s_cselect_b32 s82, s70, s82
  s_cselect_b32 s81, 1, 0
  s_bitcmp1_b32 s3, 0
  s_cselect_b32 s79, s78, s77
  s_cselect_b32 s80, s77, s78
  s_sub_u32 s80, s80, 160
  v_add_u32 v2, 0, v0
  v_mul_u32_u24 v3, 205, v2
  v_lshrrev_b32 v3, 12, v3
  v_mul_u32_u24 v4, 20, v3
  v_sub_u32 v4, v2, v4
  v_cmp_le_u32 vcc, 10, v4
  v_mov_b32 v5, s79
  v_mov_b32 v6, s80
  v_cndmask_b32 v5, v5, v6, vcc
  v_mul_u32_u24 v3, 3840, v3
  v_lshl_add_u32 v3, v4, 4, v3
  v_add_u32 v24, v3, v5
  v_add_u32 v2, 64, v0
  v_mul_u32_u24 v3, 205, v2
  v_lshrrev_b32 v3, 12, v3
  v_mul_u32_u24 v4, 20, v3
  v_sub_u32 v4, v2, v4
  v_cmp_le_u32 vcc, 10, v4
  v_mov_b32 v5, s79
  v_mov_b32 v6, s80
  v_cndmask_b32 v5, v5, v6, vcc
  v_mul_u32_u24 v3, 3840, v3
  v_lshl_add_u32 v3, v4, 4, v3
  v_add_u32 v25, v3, v5
  v_subrev_u32 v25, 1024, v25
  v_add_u32 v2, 128, v0
  v_mul_u32_u24 v3, 205, v2
  v_lshrrev_b32 v3, 12, v3
  v_mul_u32_u24 v4, 20, v3
  v_sub_u32 v4, v2, v4
  v_cmp_le_u32 vcc, 10, v4
  v_mov_b32 v5, s79
  v_mov_b32 v6, s80
  v_cndmask_b32 v5, v5, v6, vcc
  v_mul_u32_u24 v3, 3840, v3
  v_lshl_add_u32 v3, v4, 4, v3
  v_add_u32 v26, v3, v5
  v_subrev_u32 v26, 2048, v26
  s_mul_i32 s65, s3, 30720
  s_mul_i32 s74, s3, 2560
  s_mul_i32 s68, s62, 245760
  s_add_u32 s65, s65, s68
  s_lshl_b32 s68, s68, 1
  s_sub_u32 s83, 245760, s68
  s_add_u32 s9, s68, 245760
  v_lshlrev_b32 v2, 4, v1
  s_mul_i32 s67, s82, 800
  v_add_u32 v2, s67, v2
  buffer_load_dwordx4 v[184:187], v2, s[52:55], 0 offen
  s_add_u32 m0, s74, 98304
  s_nop 0
  buffer_load_dwordx4 v24, s[44:47], s65 offen  lds
  buffer_load_dwordx4 v25, s[44:47], s65 offen offset:1024  lds
  s_mov_b32 exec_hi, 0
  buffer_load_dwordx4 v26, s[44:47], s65 offen offset:2048  lds
  s_mov_b32 exec_hi, -1
  v_lshrrev_b32 v2, 1, v10
  v_xor_b32 v2, v2, v7
  v_lshlrev_b32 v2, 4, v2
  v_lshl_add_u32 v2, v10, 7, v2
  s_lshl_b32 s67, s71, 13
  v_add_u32 v15, s67, v2
  v_xor_b32 v16, 64, v15
  v_add_u32 v17, 0x10000, v15
  v_add_u32 v18, 0x10000, v16
  v_lshl_add_u32 v2, v7, 3, v8
  v_mul_u32_u24 v2, 320, v2
  v_and_b32 v3, 1, v7
  v_xor_b32 v3, s72, v3
  v_mul_u32_u24 v3, 160, v3
  v_mul_u32_u24 v4, 40, v9
  v_add3_u32 v2, v2, v3, v4
  v_add_u32 v27, 98304, v2
  s_and_b32 s67, s72, s81
  s_mul_i32 s67, s67, 3200
  s_add_u32 s67, s67, 135168
  v_mul_u32_u24 v2, 800, v7
  v_add_u32 v2, s67, v2
  v_mov_b32 v3, 161280
  v_cmp_eq_u32 vcc, v9, v7
  s_nop 1
  v_cndmask_b32 v2, v3, v2, vcc
  v_mul_u32_u24 v3, 40, v8
  v_add_u32 v28, v2, v3
  s_barrier
  s_mul_i32 s4, s95, 2
  s_add_u32 s4, s4, s101
  v_add_u32 v21, s4, v23
  s_mov_b64 exec, 0xff
  buffer_load_dword v19, v21, s[96:99], 0 offen
  s_mov_b64 exec, -1
  s_bfe_u32 s16, s2, 0x20001
  s_lshr_b32 s4, s2, 5
  s_lshl3_add_u32 s16, s16, s4
  s_lshr_b32 s17, s2, 3
  s_lshr_b32 s4, s2, 6
  s_add_u32 s17, s17, s4
  s_and_b32 s17, s17, 3
  s_and_b32 s4, s2, 1
  s_lshl2_add_u32 s17, s4, s17
  v_lshlrev_b32 v20, 4, v0
  v_add_u32 v21, 4096, v20
  s_lshl3_add_u32 s19, s71, s17
  s_mul_i32 s19, s19, 5120
  s_add_u32 s19, s19, 10485760
  s_mov_b32 s56, s38
  s_and_b32 s57, s39, 0xffff
  s_mul_i32 s58, s72, 23068672
  s_mov_b32 s59, 0x20000
  s_mul_i32 s21, s71, 5120
  s_mul_i32 s22, s72, 163840
  s_mul_i32 s23, s72, 20480
  s_xor_b32 s4, s72, 1
  s_mul_i32 s20, s4, 655360
  s_add_u32 s20, s20, s19
  s_mul_i32 s18, s16, 74
  s_mul_i32 s4, s4, 16
  s_add_u32 s18, s18, s4
  s_add_u32 s18, s18, s71
  s_lshl_b32 s18, s18, 12
  s_lshr_b32 s4, s17, 1
  s_mul_i32 s4, s4, 5
  s_mul_i32 s80, s16, 74
  s_add_u32 s80, s80, s4
  s_add_u32 s80, s80, 54
  s_lshl2_add_u32 s80, s80, s71
  s_lshl_b32 s80, s80, 10
  s_and_b32 s4, s17, 1
  s_mul_i32 s79, s4, 12288
  s_add_u32 s79, s79, s80
  s_lshl_b32 s4, s4, 9
  s_add_u32 s80, s80, s4
  s_add_u32 s80, s80, 8192
  s_lshl_b32 s78, s16, 7
  s_add_u32 s78, s78, 19075072
  s_waitcnt vmcnt(1)
  s_barrier
  ds_read_b128 v[32:35], v15 offset:0
  ds_read_b128 v[36:39], v15 offset:2048
  ds_read_b128 v[40:43], v15 offset:4096
  ds_read_b128 v[44:47], v15 offset:6144
  ds_read_b64_tr_b16 v[48:49], v27 offset:0
  ds_read_b64_tr_b16 v[50:51], v27 offset:1280
  ds_read_b64_tr_b16 v[52:53], v27 offset:8
  ds_read_b64_tr_b16 v[54:55], v27 offset:1288
  ds_read_b64_tr_b16 v[56:57], v27 offset:16
  ds_read_b64_tr_b16 v[58:59], v27 offset:1296
  ds_read_b64_tr_b16 v[60:61], v27 offset:24
  ds_read_b64_tr_b16 v[62:63], v27 offset:1304
  ds_read_b64_tr_b16 v[64:65], v27 offset:32
  ds_read_b64_tr_b16 v[66:67], v27 offset:1312
  s_add_u32 m0, s66, 32768
  s_add_u32 s64, s64, s6
  buffer_load_dwordx4 v11, s[40:43], s64 offen offset:0  lds
  buffer_load_dwordx4 v12, s[40:43], s64 offen offset:1024  lds
  s_add_u32 m0, s66, 32768
  s_nop 0
  buffer_load_dwordx4 v13, s[40:43], s64 offen offset:2048  lds
  buffer_load_dwordx4 v14, s[40:43], s64 offen offset:3072  lds
  s_add_u32 m0, s74, 118784
  s_add_u32 s65, s65, s83
  buffer_load_dwordx4 v24, s[44:47], s65 offen  lds
  buffer_load_dwordx4 v25, s[44:47], s65 offen offset:1024  lds
  s_mov_b32 exec_hi, 0
  buffer_load_dwordx4 v26, s[44:47], s65 offen offset:2048  lds
  s_mov_b32 exec_hi, -1
  s_waitcnt lgkmcnt(0)
  v_mfma_f32_16x16x32_bf16 v[104:107], v[48:51], v[32:35], 0
  ds_read_b128 v[68:71], v16 offset:0
  ds_read_b128 v[72:75], v16 offset:2048
  v_mfma_f32_16x16x32_bf16 v[124:127], v[48:51], v[36:39], 0
  ds_read_b128 v[76:79], v16 offset:4096
  v_mfma_f32_16x16x32_bf16 v[144:147], v[48:51], v[40:43], 0
  ds_read_b128 v[80:83], v16 offset:6144
  v_mfma_f32_16x16x32_bf16 v[164:167], v[48:51], v[44:47], 0
  ds_read_b64_tr_b16 v[84:85], v27 offset:10240
  ds_read_b64_tr_b16 v[86:87], v27 offset:11520
  v_mfma_f32_16x16x32_bf16 v[108:111], v[52:55], v[32:35], 0
  ds_read_b64_tr_b16 v[88:89], v27 offset:10248
  v_mfma_f32_16x16x32_bf16 v[128:131], v[52:55], v[36:39], 0
  ds_read_b64_tr_b16 v[90:91], v27 offset:11528
  v_mfma_f32_16x16x32_bf16 v[148:151], v[52:55], v[40:43], 0
  ds_read_b64_tr_b16 v[92:93], v27 offset:10256
  ds_read_b64_tr_b16 v[94:95], v27 offset:11536
  v_mfma_f32_16x16x32_bf16 v[168:171], v[52:55], v[44:47], 0
  ds_read_b64_tr_b16 v[96:97], v27 offset:10264
  v_mfma_f32_16x16x32_bf16 v[112:115], v[56:59], v[32:35], 0
  ds_read_b64_tr_b16 v[98:99], v27 offset:11544
  v_mfma_f32_16x16x32_bf16 v[132:135], v[56:59], v[36:39], 0
  ds_read_b64_tr_b16 v[100:101], v27 offset:10272
  ds_read_b64_tr_b16 v[102:103], v27 offset:11552
  v_mfma_f32_16x16x32_bf16 v[152:155], v[56:59], v[40:43], 0
  s_add_u32 m0, s66, 65536
  v_mfma_f32_16x16x32_bf16 v[172:175], v[56:59], v[44:47], 0
  s_add_u32 s64, s64, s7
  v_mfma_f32_16x16x32_bf16 v[116:119], v[60:63], v[32:35], 0
  buffer_load_dwordx4 v11, s[40:43], s64 offen offset:0  lds
  v_mfma_f32_16x16x32_bf16 v[136:139], v[60:63], v[36:39], 0
  buffer_load_dwordx4 v12, s[40:43], s64 offen offset:1024  lds
  s_add_u32 m0, s66, 65536
  v_mfma_f32_16x16x32_bf16 v[156:159], v[60:63], v[40:43], 0
  buffer_load_dwordx4 v13, s[40:43], s64 offen offset:2048  lds
  v_mfma_f32_16x16x32_bf16 v[176:179], v[60:63], v[44:47], 0
  buffer_load_dwordx4 v14, s[40:43], s64 offen offset:3072  lds
  v_mfma_f32_16x16x32_bf16 v[120:123], v[64:67], v[32:35], 0
  s_add_u32 m0, s74, 139264
  s_add_u32 s65, s65, s9
  v_mfma_f32_16x16x32_bf16 v[140:143], v[64:67], v[36:39], 0
  buffer_load_dwordx4 v24, s[44:47], s65 offen  lds
  v_mfma_f32_16x16x32_bf16 v[160:163], v[64:67], v[40:43], 0
  buffer_load_dwordx4 v25, s[44:47], s65 offen offset:1024  lds
  v_mfma_f32_16x16x32_bf16 v[180:183], v[64:67], v[44:47], 0
  s_mov_b32 exec_hi, 0
  buffer_load_dwordx4 v26, s[44:47], s65 offen offset:2048  lds
  s_mov_b32 exec_hi, -1
  s_waitcnt vmcnt(7) lgkmcnt(0)
  s_barrier
  v_mfma_f32_16x16x32_bf16 v[104:107], v[84:87], v[68:71], v[104:107]
  ds_read_b128 v[32:35], v15 offset:32768
  ds_read_b128 v[36:39], v15 offset:34816
  v_mfma_f32_16x16x32_bf16 v[124:127], v[84:87], v[72:75], v[124:127]
  ds_read_b128 v[40:43], v15 offset:36864
  v_mfma_f32_16x16x32_bf16 v[144:147], v[84:87], v[76:79], v[144:147]
  ds_read_b128 v[44:47], v15 offset:38912
  v_mfma_f32_16x16x32_bf16 v[164:167], v[84:87], v[80:83], v[164:167]
  ds_read_b64_tr_b16 v[48:49], v27 offset:20480
  v_mfma_f32_16x16x32_bf16 v[108:111], v[88:91], v[68:71], v[108:111]
  ds_read_b64_tr_b16 v[50:51], v27 offset:21760
  v_mfma_f32_16x16x32_bf16 v[128:131], v[88:91], v[72:75], v[128:131]
  ds_read_b64_tr_b16 v[52:53], v27 offset:20488
  v_mfma_f32_16x16x32_bf16 v[148:151], v[88:91], v[76:79], v[148:151]
  ds_read_b64_tr_b16 v[54:55], v27 offset:21768
  v_mfma_f32_16x16x32_bf16 v[168:171], v[88:91], v[80:83], v[168:171]
  ds_read_b64_tr_b16 v[56:57], v27 offset:20496
  v_mfma_f32_16x16x32_bf16 v[112:115], v[92:95], v[68:71], v[112:115]
  ds_read_b64_tr_b16 v[58:59], v27 offset:21776
  v_mfma_f32_16x16x32_bf16 v[132:135], v[92:95], v[72:75], v[132:135]
  ds_read_b64_tr_b16 v[60:61], v27 offset:20504
  v_mfma_f32_16x16x32_bf16 v[152:155], v[92:95], v[76:79], v[152:155]
  ds_read_b64_tr_b16 v[62:63], v27 offset:21784
  v_mfma_f32_16x16x32_bf16 v[172:175], v[92:95], v[80:83], v[172:175]
  ds_read_b64_tr_b16 v[64:65], v27 offset:20512
  v_mfma_f32_16x16x32_bf16 v[116:119], v[96:99], v[68:71], v[116:119]
  ds_read_b64_tr_b16 v[66:67], v27 offset:21792
  v_mfma_f32_16x16x32_bf16 v[136:139], v[96:99], v[72:75], v[136:139]
  s_add_u32 m0, s66, 0
  v_mfma_f32_16x16x32_bf16 v[156:159], v[96:99], v[76:79], v[156:159]
  s_add_u32 s64, s64, s6
  v_mfma_f32_16x16x32_bf16 v[176:179], v[96:99], v[80:83], v[176:179]
  buffer_load_dwordx4 v11, s[40:43], s64 offen offset:0  lds
  v_mfma_f32_16x16x32_bf16 v[120:123], v[100:103], v[68:71], v[120:123]
  buffer_load_dwordx4 v12, s[40:43], s64 offen offset:1024  lds
  v_mfma_f32_16x16x32_bf16 v[140:143], v[100:103], v[72:75], v[140:143]
  s_add_u32 m0, s66, 0
  v_mfma_f32_16x16x32_bf16 v[160:163], v[100:103], v[76:79], v[160:163]
  buffer_load_dwordx4 v13, s[40:43], s64 offen offset:2048  lds
  v_mfma_f32_16x16x32_bf16 v[180:183], v[100:103], v[80:83], v[180:183]
  buffer_load_dwordx4 v14, s[40:43], s64 offen offset:3072  lds
  s_waitcnt lgkmcnt(0)
  v_mfma_f32_16x16x32_bf16 v[104:107], v[48:51], v[32:35], v[104:107]
  ds_read_b128 v[68:71], v16 offset:32768
  v_mfma_f32_16x16x32_bf16 v[124:127], v[48:51], v[36:39], v[124:127]
  ds_read_b128 v[72:75], v16 offset:34816
  v_mfma_f32_16x16x32_bf16 v[144:147], v[48:51], v[40:43], v[144:147]
  ds_read_b128 v[76:79], v16 offset:36864
  v_mfma_f32_16x16x32_bf16 v[164:167], v[48:51], v[44:47], v[164:167]
  ds_read_b128 v[80:83], v16 offset:38912
  v_mfma_f32_16x16x32_bf16 v[108:111], v[52:55], v[32:35], v[108:111]
  ds_read_b64_tr_b16 v[84:85], v27 offset:30720
  v_mfma_f32_16x16x32_bf16 v[128:131], v[52:55], v[36:39], v[128:131]
  ds_read_b64_tr_b16 v[86:87], v27 offset:32000
  v_mfma_f32_16x16x32_bf16 v[148:151], v[52:55], v[40:43], v[148:151]
  ds_read_b64_tr_b16 v[88:89], v27 offset:30728
  v_mfma_f32_16x16x32_bf16 v[168:171], v[52:55], v[44:47], v[168:171]
  ds_read_b64_tr_b16 v[90:91], v27 offset:32008
  v_mfma_f32_16x16x32_bf16 v[112:115], v[56:59], v[32:35], v[112:115]
  ds_read_b64_tr_b16 v[92:93], v27 offset:30736
  v_mfma_f32_16x16x32_bf16 v[132:135], v[56:59], v[36:39], v[132:135]
  ds_read_b64_tr_b16 v[94:95], v27 offset:32016
  v_mfma_f32_16x16x32_bf16 v[152:155], v[56:59], v[40:43], v[152:155]
  ds_read_b64_tr_b16 v[96:97], v27 offset:30744
  v_mfma_f32_16x16x32_bf16 v[172:175], v[56:59], v[44:47], v[172:175]
  ds_read_b64_tr_b16 v[98:99], v27 offset:32024
  v_mfma_f32_16x16x32_bf16 v[116:119], v[60:63], v[32:35], v[116:119]
  ds_read_b64_tr_b16 v[100:101], v27 offset:30752
  v_mfma_f32_16x16x32_bf16 v[136:139], v[60:63], v[36:39], v[136:139]
  ds_read_b64_tr_b16 v[102:103], v27 offset:32032
  v_mfma_f32_16x16x32_bf16 v[156:159], v[60:63], v[40:43], v[156:159]
  s_add_u32 m0, s74, 98304
  v_mfma_f32_16x16x32_bf16 v[176:179], v[60:63], v[44:47], v[176:179]
  s_add_u32 s65, s65, s83
  v_mfma_f32_16x16x32_bf16 v[120:123], v[64:67], v[32:35], v[120:123]
  buffer_load_dwordx4 v24, s[44:47], s65 offen  lds
  v_mfma_f32_16x16x32_bf16 v[140:143], v[64:67], v[36:39], v[140:143]
  buffer_load_dwordx4 v25, s[44:47], s65 offen offset:1024  lds
  v_mfma_f32_16x16x32_bf16 v[160:163], v[64:67], v[40:43], v[160:163]
  s_mov_b32 exec_hi, 0
  buffer_load_dwordx4 v26, s[44:47], s65 offen offset:2048  lds
  s_mov_b32 exec_hi, -1
  v_mfma_f32_16x16x32_bf16 v[180:183], v[64:67], v[44:47], v[180:183]
  s_waitcnt vmcnt(7) lgkmcnt(0)
  s_barrier
  v_mfma_f32_16x16x32_bf16 v[104:107], v[84:87], v[68:71], v[104:107]
  ds_read_b128 v[32:35], v17 offset:0
  ds_read_b128 v[36:39], v17 offset:2048
  v_mfma_f32_16x16x32_bf16 v[124:127], v[84:87], v[72:75], v[124:127]
  ds_read_b128 v[40:43], v17 offset:4096
  v_mfma_f32_16x16x32_bf16 v[144:147], v[84:87], v[76:79], v[144:147]
  ds_read_b128 v[44:47], v17 offset:6144
  v_mfma_f32_16x16x32_bf16 v[164:167], v[84:87], v[80:83], v[164:167]
  ds_read_b64_tr_b16 v[48:49], v27 offset:40960
  v_mfma_f32_16x16x32_bf16 v[108:111], v[88:91], v[68:71], v[108:111]
  ds_read_b64_tr_b16 v[50:51], v27 offset:42240
  v_mfma_f32_16x16x32_bf16 v[128:131], v[88:91], v[72:75], v[128:131]
  ds_read_b64_tr_b16 v[52:53], v27 offset:40968
  v_mfma_f32_16x16x32_bf16 v[148:151], v[88:91], v[76:79], v[148:151]
  ds_read_b64_tr_b16 v[54:55], v27 offset:42248
  v_mfma_f32_16x16x32_bf16 v[168:171], v[88:91], v[80:83], v[168:171]
  ds_read_b64_tr_b16 v[56:57], v27 offset:40976
  v_mfma_f32_16x16x32_bf16 v[112:115], v[92:95], v[68:71], v[112:115]
  ds_read_b64_tr_b16 v[58:59], v27 offset:42256
  v_mfma_f32_16x16x32_bf16 v[132:135], v[92:95], v[72:75], v[132:135]
  ds_read_b64_tr_b16 v[60:61], v27 offset:40984
  v_mfma_f32_16x16x32_bf16 v[152:155], v[92:95], v[76:79], v[152:155]
  ds_read_b64_tr_b16 v[62:63], v27 offset:42264
  v_mfma_f32_16x16x32_bf16 v[172:175], v[92:95], v[80:83], v[172:175]
  ds_read_b64_tr_b16 v[64:65], v27 offset:40992
  v_mfma_f32_16x16x32_bf16 v[116:119], v[96:99], v[68:71], v[116:119]
  ds_read_b64_tr_b16 v[66:67], v27 offset:42272
  v_mfma_f32_16x16x32_bf16 v[136:139], v[96:99], v[72:75], v[136:139]
  s_add_u32 m0, s66, 32768
  v_mfma_f32_16x16x32_bf16 v[156:159], v[96:99], v[76:79], v[156:159]
  s_add_u32 s64, s64, s7
  v_mfma_f32_16x16x32_bf16 v[176:179], v[96:99], v[80:83], v[176:179]
  buffer_load_dwordx4 v11, s[40:43], s64 offen offset:0  lds
  v_mfma_f32_16x16x32_bf16 v[120:123], v[100:103], v[68:71], v[120:123]
  buffer_load_dwordx4 v12, s[40:43], s64 offen offset:1024  lds
  v_mfma_f32_16x16x32_bf16 v[140:143], v[100:103], v[72:75], v[140:143]
  s_add_u32 m0, s66, 32768
  v_mfma_f32_16x16x32_bf16 v[160:163], v[100:103], v[76:79], v[160:163]
  buffer_load_dwordx4 v13, s[40:43], s64 offen offset:2048  lds
  v_mfma_f32_16x16x32_bf16 v[180:183], v[100:103], v[80:83], v[180:183]
  buffer_load_dwordx4 v14, s[40:43], s64 offen offset:3072  lds
  s_waitcnt lgkmcnt(0)
  v_mfma_f32_16x16x32_bf16 v[104:107], v[48:51], v[32:35], v[104:107]
  ds_read_b128 v[68:71], v18 offset:0
  v_mfma_f32_16x16x32_bf16 v[124:127], v[48:51], v[36:39], v[124:127]
  ds_read_b128 v[72:75], v18 offset:2048
  v_mfma_f32_16x16x32_bf16 v[144:147], v[48:51], v[40:43], v[144:147]
  ds_read_b128 v[76:79], v18 offset:4096
  v_mfma_f32_16x16x32_bf16 v[164:167], v[48:51], v[44:47], v[164:167]
  ds_read_b128 v[80:83], v18 offset:6144
  v_mfma_f32_16x16x32_bf16 v[108:111], v[52:55], v[32:35], v[108:111]
  ds_read_b64_tr_b16 v[84:85], v27 offset:51200
  v_mfma_f32_16x16x32_bf16 v[128:131], v[52:55], v[36:39], v[128:131]
  ds_read_b64_tr_b16 v[86:87], v27 offset:52480
  v_mfma_f32_16x16x32_bf16 v[148:151], v[52:55], v[40:43], v[148:151]
  ds_read_b64_tr_b16 v[88:89], v27 offset:51208
  v_mfma_f32_16x16x32_bf16 v[168:171], v[52:55], v[44:47], v[168:171]
  ds_read_b64_tr_b16 v[90:91], v27 offset:52488
  v_mfma_f32_16x16x32_bf16 v[112:115], v[56:59], v[32:35], v[112:115]
  ds_read_b64_tr_b16 v[92:93], v27 offset:51216
  v_mfma_f32_16x16x32_bf16 v[132:135], v[56:59], v[36:39], v[132:135]
  ds_read_b64_tr_b16 v[94:95], v27 offset:52496
  v_mfma_f32_16x16x32_bf16 v[152:155], v[56:59], v[40:43], v[152:155]
  ds_read_b64_tr_b16 v[96:97], v27 offset:51224
  v_mfma_f32_16x16x32_bf16 v[172:175], v[56:59], v[44:47], v[172:175]
  ds_read_b64_tr_b16 v[98:99], v27 offset:52504
  v_mfma_f32_16x16x32_bf16 v[116:119], v[60:63], v[32:35], v[116:119]
  ds_read_b64_tr_b16 v[100:101], v27 offset:51232
  v_mfma_f32_16x16x32_bf16 v[136:139], v[60:63], v[36:39], v[136:139]
  ds_read_b64_tr_b16 v[102:103], v27 offset:52512
  v_mfma_f32_16x16x32_bf16 v[156:159], v[60:63], v[40:43], v[156:159]
  s_add_u32 m0, s74, 118784
  v_mfma_f32_16x16x32_bf16 v[176:179], v[60:63], v[44:47], v[176:179]
  s_add_u32 s65, s65, s9
  v_mfma_f32_16x16x32_bf16 v[120:123], v[64:67], v[32:35], v[120:123]
  buffer_load_dwordx4 v24, s[44:47], s65 offen  lds
  v_mfma_f32_16x16x32_bf16 v[140:143], v[64:67], v[36:39], v[140:143]
  buffer_load_dwordx4 v25, s[44:47], s65 offen offset:1024  lds
  v_mfma_f32_16x16x32_bf16 v[160:163], v[64:67], v[40:43], v[160:163]
  s_mov_b32 exec_hi, 0
  buffer_load_dwordx4 v26, s[44:47], s65 offen offset:2048  lds
  s_mov_b32 exec_hi, -1
  v_mfma_f32_16x16x32_bf16 v[180:183], v[64:67], v[44:47], v[180:183]
  s_waitcnt vmcnt(7) lgkmcnt(0)
  s_barrier
  v_mfma_f32_16x16x32_bf16 v[104:107], v[84:87], v[68:71], v[104:107]
  ds_read_b128 v[32:35], v15 offset:0
  ds_read_b128 v[36:39], v15 offset:2048
  v_mfma_f32_16x16x32_bf16 v[124:127], v[84:87], v[72:75], v[124:127]
  ds_read_b128 v[40:43], v15 offset:4096
  v_mfma_f32_16x16x32_bf16 v[144:147], v[84:87], v[76:79], v[144:147]
  ds_read_b128 v[44:47], v15 offset:6144
  v_mfma_f32_16x16x32_bf16 v[164:167], v[84:87], v[80:83], v[164:167]
  ds_read_b64_tr_b16 v[48:49], v27 offset:0
  v_mfma_f32_16x16x32_bf16 v[108:111], v[88:91], v[68:71], v[108:111]
  ds_read_b64_tr_b16 v[50:51], v27 offset:1280
  v_mfma_f32_16x16x32_bf16 v[128:131], v[88:91], v[72:75], v[128:131]
  ds_read_b64_tr_b16 v[52:53], v27 offset:8
  v_mfma_f32_16x16x32_bf16 v[148:151], v[88:91], v[76:79], v[148:151]
  ds_read_b64_tr_b16 v[54:55], v27 offset:1288
  v_mfma_f32_16x16x32_bf16 v[168:171], v[88:91], v[80:83], v[168:171]
  ds_read_b64_tr_b16 v[56:57], v27 offset:16
  v_mfma_f32_16x16x32_bf16 v[112:115], v[92:95], v[68:71], v[112:115]
  ds_read_b64_tr_b16 v[58:59], v27 offset:1296
  v_mfma_f32_16x16x32_bf16 v[132:135], v[92:95], v[72:75], v[132:135]
  ds_read_b64_tr_b16 v[60:61], v27 offset:24
  v_mfma_f32_16x16x32_bf16 v[152:155], v[92:95], v[76:79], v[152:155]
  ds_read_b64_tr_b16 v[62:63], v27 offset:1304
  v_mfma_f32_16x16x32_bf16 v[172:175], v[92:95], v[80:83], v[172:175]
  ds_read_b64_tr_b16 v[64:65], v27 offset:32
  v_mfma_f32_16x16x32_bf16 v[116:119], v[96:99], v[68:71], v[116:119]
  ds_read_b64_tr_b16 v[66:67], v27 offset:1312
  v_mfma_f32_16x16x32_bf16 v[136:139], v[96:99], v[72:75], v[136:139]
  s_add_u32 m0, s66, 65536
  v_mfma_f32_16x16x32_bf16 v[156:159], v[96:99], v[76:79], v[156:159]
  s_add_u32 s64, s64, s6
  v_mfma_f32_16x16x32_bf16 v[176:179], v[96:99], v[80:83], v[176:179]
  buffer_load_dwordx4 v11, s[40:43], s64 offen offset:0  lds
  v_mfma_f32_16x16x32_bf16 v[120:123], v[100:103], v[68:71], v[120:123]
  buffer_load_dwordx4 v12, s[40:43], s64 offen offset:1024  lds
  v_mfma_f32_16x16x32_bf16 v[140:143], v[100:103], v[72:75], v[140:143]
  s_add_u32 m0, s66, 65536
  v_mfma_f32_16x16x32_bf16 v[160:163], v[100:103], v[76:79], v[160:163]
  buffer_load_dwordx4 v13, s[40:43], s64 offen offset:2048  lds
  v_mfma_f32_16x16x32_bf16 v[180:183], v[100:103], v[80:83], v[180:183]
  buffer_load_dwordx4 v14, s[40:43], s64 offen offset:3072  lds
  s_waitcnt lgkmcnt(0)
  v_mfma_f32_16x16x32_bf16 v[104:107], v[48:51], v[32:35], v[104:107]
  ds_read_b128 v[68:71], v16 offset:0
  v_mfma_f32_16x16x32_bf16 v[124:127], v[48:51], v[36:39], v[124:127]
  ds_read_b128 v[72:75], v16 offset:2048
  v_mfma_f32_16x16x32_bf16 v[144:147], v[48:51], v[40:43], v[144:147]
  ds_read_b128 v[76:79], v16 offset:4096
  v_mfma_f32_16x16x32_bf16 v[164:167], v[48:51], v[44:47], v[164:167]
  ds_read_b128 v[80:83], v16 offset:6144
  v_mfma_f32_16x16x32_bf16 v[108:111], v[52:55], v[32:35], v[108:111]
  ds_read_b64_tr_b16 v[84:85], v27 offset:10240
  v_mfma_f32_16x16x32_bf16 v[128:131], v[52:55], v[36:39], v[128:131]
  ds_read_b64_tr_b16 v[86:87], v27 offset:11520
  v_mfma_f32_16x16x32_bf16 v[148:151], v[52:55], v[40:43], v[148:151]
  ds_read_b64_tr_b16 v[88:89], v27 offset:10248
  v_mfma_f32_16x16x32_bf16 v[168:171], v[52:55], v[44:47], v[168:171]
  ds_read_b64_tr_b16 v[90:91], v27 offset:11528
  v_mfma_f32_16x16x32_bf16 v[112:115], v[56:59], v[32:35], v[112:115]
  ds_read_b64_tr_b16 v[92:93], v27 offset:10256
  v_mfma_f32_16x16x32_bf16 v[132:135], v[56:59], v[36:39], v[132:135]
  ds_read_b64_tr_b16 v[94:95], v27 offset:11536
  v_mfma_f32_16x16x32_bf16 v[152:155], v[56:59], v[40:43], v[152:155]
  ds_read_b64_tr_b16 v[96:97], v27 offset:10264
  v_mfma_f32_16x16x32_bf16 v[172:175], v[56:59], v[44:47], v[172:175]
  ds_read_b64_tr_b16 v[98:99], v27 offset:11544
  v_mfma_f32_16x16x32_bf16 v[116:119], v[60:63], v[32:35], v[116:119]
  ds_read_b64_tr_b16 v[100:101], v27 offset:10272
  v_mfma_f32_16x16x32_bf16 v[136:139], v[60:63], v[36:39], v[136:139]
  ds_read_b64_tr_b16 v[102:103], v27 offset:11552
  v_mfma_f32_16x16x32_bf16 v[156:159], v[60:63], v[40:43], v[156:159]
  s_add_u32 m0, s74, 139264
  v_mfma_f32_16x16x32_bf16 v[176:179], v[60:63], v[44:47], v[176:179]
  s_add_u32 s65, s65, s83
  v_mfma_f32_16x16x32_bf16 v[120:123], v[64:67], v[32:35], v[120:123]
  buffer_load_dwordx4 v24, s[44:47], s65 offen  lds
  v_mfma_f32_16x16x32_bf16 v[140:143], v[64:67], v[36:39], v[140:143]
  buffer_load_dwordx4 v25, s[44:47], s65 offen offset:1024  lds
  v_mfma_f32_16x16x32_bf16 v[160:163], v[64:67], v[40:43], v[160:163]
  s_mov_b32 exec_hi, 0
  buffer_load_dwordx4 v26, s[44:47], s65 offen offset:2048  lds
  s_mov_b32 exec_hi, -1
  v_mfma_f32_16x16x32_bf16 v[180:183], v[64:67], v[44:47], v[180:183]
  s_waitcnt vmcnt(7) lgkmcnt(0)
  s_barrier
  v_mfma_f32_16x16x32_bf16 v[104:107], v[84:87], v[68:71], v[104:107]
  ds_read_b128 v[32:35], v15 offset:32768
  ds_read_b128 v[36:39], v15 offset:34816
  v_mfma_f32_16x16x32_bf16 v[124:127], v[84:87], v[72:75], v[124:127]
  ds_read_b128 v[40:43], v15 offset:36864
  v_mfma_f32_16x16x32_bf16 v[144:147], v[84:87], v[76:79], v[144:147]
  ds_read_b128 v[44:47], v15 offset:38912
  v_mfma_f32_16x16x32_bf16 v[164:167], v[84:87], v[80:83], v[164:167]
  ds_read_b64_tr_b16 v[48:49], v27 offset:20480
  v_mfma_f32_16x16x32_bf16 v[108:111], v[88:91], v[68:71], v[108:111]
  ds_read_b64_tr_b16 v[50:51], v27 offset:21760
  v_mfma_f32_16x16x32_bf16 v[128:131], v[88:91], v[72:75], v[128:131]
  ds_read_b64_tr_b16 v[52:53], v27 offset:20488
  v_mfma_f32_16x16x32_bf16 v[148:151], v[88:91], v[76:79], v[148:151]
  ds_read_b64_tr_b16 v[54:55], v27 offset:21768
  v_mfma_f32_16x16x32_bf16 v[168:171], v[88:91], v[80:83], v[168:171]
  ds_read_b64_tr_b16 v[56:57], v27 offset:20496
  v_mfma_f32_16x16x32_bf16 v[112:115], v[92:95], v[68:71], v[112:115]
  ds_read_b64_tr_b16 v[58:59], v27 offset:21776
  v_mfma_f32_16x16x32_bf16 v[132:135], v[92:95], v[72:75], v[132:135]
  ds_read_b64_tr_b16 v[60:61], v27 offset:20504
  v_mfma_f32_16x16x32_bf16 v[152:155], v[92:95], v[76:79], v[152:155]
  ds_read_b64_tr_b16 v[62:63], v27 offset:21784
  v_mfma_f32_16x16x32_bf16 v[172:175], v[92:95], v[80:83], v[172:175]
  ds_read_b64_tr_b16 v[64:65], v27 offset:20512
  v_mfma_f32_16x16x32_bf16 v[116:119], v[96:99], v[68:71], v[116:119]
  ds_read_b64_tr_b16 v[66:67], v27 offset:21792
  v_mfma_f32_16x16x32_bf16 v[136:139], v[96:99], v[72:75], v[136:139]
  s_add_u32 m0, s66, 0
  v_mfma_f32_16x16x32_bf16 v[156:159], v[96:99], v[76:79], v[156:159]
  s_add_u32 s64, s64, s7
  v_mfma_f32_16x16x32_bf16 v[176:179], v[96:99], v[80:83], v[176:179]
  buffer_load_dwordx4 v11, s[40:43], s64 offen offset:0  lds
  v_mfma_f32_16x16x32_bf16 v[120:123], v[100:103], v[68:71], v[120:123]
  buffer_load_dwordx4 v12, s[40:43], s64 offen offset:1024  lds
  v_mfma_f32_16x16x32_bf16 v[140:143], v[100:103], v[72:75], v[140:143]
  s_add_u32 m0, s66, 0
  v_mfma_f32_16x16x32_bf16 v[160:163], v[100:103], v[76:79], v[160:163]
  buffer_load_dwordx4 v13, s[40:43], s64 offen offset:2048  lds
  v_mfma_f32_16x16x32_bf16 v[180:183], v[100:103], v[80:83], v[180:183]
  buffer_load_dwordx4 v14, s[40:43], s64 offen offset:3072  lds
  s_waitcnt lgkmcnt(0)
  v_mfma_f32_16x16x32_bf16 v[104:107], v[48:51], v[32:35], v[104:107]
  ds_read_b128 v[68:71], v16 offset:32768
  v_mfma_f32_16x16x32_bf16 v[124:127], v[48:51], v[36:39], v[124:127]
  ds_read_b128 v[72:75], v16 offset:34816
  v_mfma_f32_16x16x32_bf16 v[144:147], v[48:51], v[40:43], v[144:147]
  ds_read_b128 v[76:79], v16 offset:36864
  v_mfma_f32_16x16x32_bf16 v[164:167], v[48:51], v[44:47], v[164:167]
  ds_read_b128 v[80:83], v16 offset:38912
  v_mfma_f32_16x16x32_bf16 v[108:111], v[52:55], v[32:35], v[108:111]
  ds_read_b64_tr_b16 v[84:85], v27 offset:30720
  v_mfma_f32_16x16x32_bf16 v[128:131], v[52:55], v[36:39], v[128:131]
  ds_read_b64_tr_b16 v[86:87], v27 offset:32000
  v_mfma_f32_16x16x32_bf16 v[148:151], v[52:55], v[40:43], v[148:151]
  ds_read_b64_tr_b16 v[88:89], v27 offset:30728
  v_mfma_f32_16x16x32_bf16 v[168:171], v[52:55], v[44:47], v[168:171]
  ds_read_b64_tr_b16 v[90:91], v27 offset:32008
  v_mfma_f32_16x16x32_bf16 v[112:115], v[56:59], v[32:35], v[112:115]
  ds_read_b64_tr_b16 v[92:93], v27 offset:30736
  v_mfma_f32_16x16x32_bf16 v[132:135], v[56:59], v[36:39], v[132:135]
  ds_read_b64_tr_b16 v[94:95], v27 offset:32016
  v_mfma_f32_16x16x32_bf16 v[152:155], v[56:59], v[40:43], v[152:155]
  ds_read_b64_tr_b16 v[96:97], v27 offset:30744
  v_mfma_f32_16x16x32_bf16 v[172:175], v[56:59], v[44:47], v[172:175]
  ds_read_b64_tr_b16 v[98:99], v27 offset:32024
  v_mfma_f32_16x16x32_bf16 v[116:119], v[60:63], v[32:35], v[116:119]
  ds_read_b64_tr_b16 v[100:101], v27 offset:30752
  v_mfma_f32_16x16x32_bf16 v[136:139], v[60:63], v[36:39], v[136:139]
  ds_read_b64_tr_b16 v[102:103], v27 offset:32032
  v_mfma_f32_16x16x32_bf16 v[156:159], v[60:63], v[40:43], v[156:159]
  s_add_u32 m0, s74, 98304
  v_mfma_f32_16x16x32_bf16 v[176:179], v[60:63], v[44:47], v[176:179]
  s_add_u32 s65, s65, s9
  v_mfma_f32_16x16x32_bf16 v[120:123], v[64:67], v[32:35], v[120:123]
  buffer_load_dwordx4 v24, s[44:47], s65 offen  lds
  v_mfma_f32_16x16x32_bf16 v[140:143], v[64:67], v[36:39], v[140:143]
  buffer_load_dwordx4 v25, s[44:47], s65 offen offset:1024  lds
  v_mfma_f32_16x16x32_bf16 v[160:163], v[64:67], v[40:43], v[160:163]
  s_mov_b32 exec_hi, 0
  buffer_load_dwordx4 v26, s[44:47], s65 offen offset:2048  lds
  s_mov_b32 exec_hi, -1
  v_mfma_f32_16x16x32_bf16 v[180:183], v[64:67], v[44:47], v[180:183]
  s_waitcnt vmcnt(7) lgkmcnt(0)
  s_barrier
  v_mfma_f32_16x16x32_bf16 v[104:107], v[84:87], v[68:71], v[104:107]
  ds_read_b128 v[32:35], v17 offset:0
  ds_read_b128 v[36:39], v17 offset:2048
  v_mfma_f32_16x16x32_bf16 v[124:127], v[84:87], v[72:75], v[124:127]
  ds_read_b128 v[40:43], v17 offset:4096
  v_mfma_f32_16x16x32_bf16 v[144:147], v[84:87], v[76:79], v[144:147]
  ds_read_b128 v[44:47], v17 offset:6144
  v_mfma_f32_16x16x32_bf16 v[164:167], v[84:87], v[80:83], v[164:167]
  ds_read_b64_tr_b16 v[48:49], v27 offset:40960
  v_mfma_f32_16x16x32_bf16 v[108:111], v[88:91], v[68:71], v[108:111]
  ds_read_b64_tr_b16 v[50:51], v27 offset:42240
  v_mfma_f32_16x16x32_bf16 v[128:131], v[88:91], v[72:75], v[128:131]
  ds_read_b64_tr_b16 v[52:53], v27 offset:40968
  v_mfma_f32_16x16x32_bf16 v[148:151], v[88:91], v[76:79], v[148:151]
  ds_read_b64_tr_b16 v[54:55], v27 offset:42248
  v_mfma_f32_16x16x32_bf16 v[168:171], v[88:91], v[80:83], v[168:171]
  ds_read_b64_tr_b16 v[56:57], v27 offset:40976
  v_mfma_f32_16x16x32_bf16 v[112:115], v[92:95], v[68:71], v[112:115]
  ds_read_b64_tr_b16 v[58:59], v27 offset:42256
  v_mfma_f32_16x16x32_bf16 v[132:135], v[92:95], v[72:75], v[132:135]
  ds_read_b64_tr_b16 v[60:61], v27 offset:40984
  v_mfma_f32_16x16x32_bf16 v[152:155], v[92:95], v[76:79], v[152:155]
  ds_read_b64_tr_b16 v[62:63], v27 offset:42264
  v_mfma_f32_16x16x32_bf16 v[172:175], v[92:95], v[80:83], v[172:175]
  ds_read_b64_tr_b16 v[64:65], v27 offset:40992
  v_mfma_f32_16x16x32_bf16 v[116:119], v[96:99], v[68:71], v[116:119]
  ds_read_b64_tr_b16 v[66:67], v27 offset:42272
  v_mfma_f32_16x16x32_bf16 v[136:139], v[96:99], v[72:75], v[136:139]
  s_add_u32 m0, s66, 32768
  v_mfma_f32_16x16x32_bf16 v[156:159], v[96:99], v[76:79], v[156:159]
  s_add_u32 s64, s64, s6
  v_mfma_f32_16x16x32_bf16 v[176:179], v[96:99], v[80:83], v[176:179]
  buffer_load_dwordx4 v11, s[40:43], s64 offen offset:0  lds
  v_mfma_f32_16x16x32_bf16 v[120:123], v[100:103], v[68:71], v[120:123]
  buffer_load_dwordx4 v12, s[40:43], s64 offen offset:1024  lds
  v_mfma_f32_16x16x32_bf16 v[140:143], v[100:103], v[72:75], v[140:143]
  s_add_u32 m0, s66, 32768
  v_mfma_f32_16x16x32_bf16 v[160:163], v[100:103], v[76:79], v[160:163]
  buffer_load_dwordx4 v13, s[40:43], s64 offen offset:2048  lds
  v_mfma_f32_16x16x32_bf16 v[180:183], v[100:103], v[80:83], v[180:183]
  buffer_load_dwordx4 v14, s[40:43], s64 offen offset:3072  lds
  s_waitcnt lgkmcnt(0)
  v_mfma_f32_16x16x32_bf16 v[104:107], v[48:51], v[32:35], v[104:107]
  ds_read_b128 v[68:71], v18 offset:0
  v_mfma_f32_16x16x32_bf16 v[124:127], v[48:51], v[36:39], v[124:127]
  ds_read_b128 v[72:75], v18 offset:2048
  v_mfma_f32_16x16x32_bf16 v[144:147], v[48:51], v[40:43], v[144:147]
  ds_read_b128 v[76:79], v18 offset:4096
  v_mfma_f32_16x16x32_bf16 v[164:167], v[48:51], v[44:47], v[164:167]
  ds_read_b128 v[80:83], v18 offset:6144
  v_mfma_f32_16x16x32_bf16 v[108:111], v[52:55], v[32:35], v[108:111]
  ds_read_b64_tr_b16 v[84:85], v27 offset:51200
  v_mfma_f32_16x16x32_bf16 v[128:131], v[52:55], v[36:39], v[128:131]
  ds_read_b64_tr_b16 v[86:87], v27 offset:52480
  v_mfma_f32_16x16x32_bf16 v[148:151], v[52:55], v[40:43], v[148:151]
  ds_read_b64_tr_b16 v[88:89], v27 offset:51208
  v_mfma_f32_16x16x32_bf16 v[168:171], v[52:55], v[44:47], v[168:171]
  ds_read_b64_tr_b16 v[90:91], v27 offset:52488
  v_mfma_f32_16x16x32_bf16 v[112:115], v[56:59], v[32:35], v[112:115]
  ds_read_b64_tr_b16 v[92:93], v27 offset:51216
  v_mfma_f32_16x16x32_bf16 v[132:135], v[56:59], v[36:39], v[132:135]
  ds_read_b64_tr_b16 v[94:95], v27 offset:52496
  v_mfma_f32_16x16x32_bf16 v[152:155], v[56:59], v[40:43], v[152:155]
  ds_read_b64_tr_b16 v[96:97], v27 offset:51224
  v_mfma_f32_16x16x32_bf16 v[172:175], v[56:59], v[44:47], v[172:175]
  ds_read_b64_tr_b16 v[98:99], v27 offset:52504
  v_mfma_f32_16x16x32_bf16 v[116:119], v[60:63], v[32:35], v[116:119]
  ds_read_b64_tr_b16 v[100:101], v27 offset:51232
  v_mfma_f32_16x16x32_bf16 v[136:139], v[60:63], v[36:39], v[136:139]
  ds_read_b64_tr_b16 v[102:103], v27 offset:52512
  v_mfma_f32_16x16x32_bf16 v[156:159], v[60:63], v[40:43], v[156:159]
  s_add_u32 m0, s74, 118784
  v_mfma_f32_16x16x32_bf16 v[176:179], v[60:63], v[44:47], v[176:179]
  s_add_u32 s65, s65, s83
  v_mfma_f32_16x16x32_bf16 v[120:123], v[64:67], v[32:35], v[120:123]
  buffer_load_dwordx4 v24, s[44:47], s65 offen  lds
  v_mfma_f32_16x16x32_bf16 v[140:143], v[64:67], v[36:39], v[140:143]
  buffer_load_dwordx4 v25, s[44:47], s65 offen offset:1024  lds
  v_mfma_f32_16x16x32_bf16 v[160:163], v[64:67], v[40:43], v[160:163]
  s_mov_b32 exec_hi, 0
  buffer_load_dwordx4 v26, s[44:47], s65 offen offset:2048  lds
  s_mov_b32 exec_hi, -1
  v_mfma_f32_16x16x32_bf16 v[180:183], v[64:67], v[44:47], v[180:183]
  s_waitcnt vmcnt(7) lgkmcnt(0)
  s_barrier
  v_mfma_f32_16x16x32_bf16 v[104:107], v[84:87], v[68:71], v[104:107]
  ds_read_b128 v[32:35], v15 offset:0
  ds_read_b128 v[36:39], v15 offset:2048
  v_mfma_f32_16x16x32_bf16 v[124:127], v[84:87], v[72:75], v[124:127]
  ds_read_b128 v[40:43], v15 offset:4096
  v_mfma_f32_16x16x32_bf16 v[144:147], v[84:87], v[76:79], v[144:147]
  ds_read_b128 v[44:47], v15 offset:6144
  v_mfma_f32_16x16x32_bf16 v[164:167], v[84:87], v[80:83], v[164:167]
  ds_read_b64_tr_b16 v[48:49], v27 offset:0
  v_mfma_f32_16x16x32_bf16 v[108:111], v[88:91], v[68:71], v[108:111]
  ds_read_b64_tr_b16 v[50:51], v27 offset:1280
  v_mfma_f32_16x16x32_bf16 v[128:131], v[88:91], v[72:75], v[128:131]
  ds_read_b64_tr_b16 v[52:53], v27 offset:8
  v_mfma_f32_16x16x32_bf16 v[148:151], v[88:91], v[76:79], v[148:151]
  ds_read_b64_tr_b16 v[54:55], v27 offset:1288
  v_mfma_f32_16x16x32_bf16 v[168:171], v[88:91], v[80:83], v[168:171]
  ds_read_b64_tr_b16 v[56:57], v27 offset:16
  v_mfma_f32_16x16x32_bf16 v[112:115], v[92:95], v[68:71], v[112:115]
  ds_read_b64_tr_b16 v[58:59], v27 offset:1296
  v_mfma_f32_16x16x32_bf16 v[132:135], v[92:95], v[72:75], v[132:135]
  ds_read_b64_tr_b16 v[60:61], v27 offset:24
  v_mfma_f32_16x16x32_bf16 v[152:155], v[92:95], v[76:79], v[152:155]
  ds_read_b64_tr_b16 v[62:63], v27 offset:1304
  v_mfma_f32_16x16x32_bf16 v[172:175], v[92:95], v[80:83], v[172:175]
  ds_read_b64_tr_b16 v[64:65], v27 offset:32
  v_mfma_f32_16x16x32_bf16 v[116:119], v[96:99], v[68:71], v[116:119]
  ds_read_b64_tr_b16 v[66:67], v27 offset:1312
  v_mfma_f32_16x16x32_bf16 v[136:139], v[96:99], v[72:75], v[136:139]
  s_add_u32 m0, s66, 65536
  v_mfma_f32_16x16x32_bf16 v[156:159], v[96:99], v[76:79], v[156:159]
  s_add_u32 s64, s64, s7
  v_mfma_f32_16x16x32_bf16 v[176:179], v[96:99], v[80:83], v[176:179]
  buffer_load_dwordx4 v11, s[40:43], s64 offen offset:0  lds
  v_mfma_f32_16x16x32_bf16 v[120:123], v[100:103], v[68:71], v[120:123]
  buffer_load_dwordx4 v12, s[40:43], s64 offen offset:1024  lds
  v_mfma_f32_16x16x32_bf16 v[140:143], v[100:103], v[72:75], v[140:143]
  s_add_u32 m0, s66, 65536
  v_mfma_f32_16x16x32_bf16 v[160:163], v[100:103], v[76:79], v[160:163]
  buffer_load_dwordx4 v13, s[40:43], s64 offen offset:2048  lds
  v_mfma_f32_16x16x32_bf16 v[180:183], v[100:103], v[80:83], v[180:183]
  buffer_load_dwordx4 v14, s[40:43], s64 offen offset:3072  lds
  s_waitcnt lgkmcnt(0)
  v_mfma_f32_16x16x32_bf16 v[104:107], v[48:51], v[32:35], v[104:107]
  ds_read_b128 v[68:71], v16 offset:0
  v_mfma_f32_16x16x32_bf16 v[124:127], v[48:51], v[36:39], v[124:127]
  ds_read_b128 v[72:75], v16 offset:2048
  v_mfma_f32_16x16x32_bf16 v[144:147], v[48:51], v[40:43], v[144:147]
  ds_read_b128 v[76:79], v16 offset:4096
  v_mfma_f32_16x16x32_bf16 v[164:167], v[48:51], v[44:47], v[164:167]
  ds_read_b128 v[80:83], v16 offset:6144
  v_mfma_f32_16x16x32_bf16 v[108:111], v[52:55], v[32:35], v[108:111]
  ds_read_b64_tr_b16 v[84:85], v27 offset:10240
  v_mfma_f32_16x16x32_bf16 v[128:131], v[52:55], v[36:39], v[128:131]
  ds_read_b64_tr_b16 v[86:87], v27 offset:11520
  v_mfma_f32_16x16x32_bf16 v[148:151], v[52:55], v[40:43], v[148:151]
  ds_read_b64_tr_b16 v[88:89], v27 offset:10248
  v_mfma_f32_16x16x32_bf16 v[168:171], v[52:55], v[44:47], v[168:171]
  ds_read_b64_tr_b16 v[90:91], v27 offset:11528
  v_mfma_f32_16x16x32_bf16 v[112:115], v[56:59], v[32:35], v[112:115]
  ds_read_b64_tr_b16 v[92:93], v27 offset:10256
  v_mfma_f32_16x16x32_bf16 v[132:135], v[56:59], v[36:39], v[132:135]
  ds_read_b64_tr_b16 v[94:95], v27 offset:11536
  v_mfma_f32_16x16x32_bf16 v[152:155], v[56:59], v[40:43], v[152:155]
  ds_read_b64_tr_b16 v[96:97], v27 offset:10264
  v_mfma_f32_16x16x32_bf16 v[172:175], v[56:59], v[44:47], v[172:175]
  ds_read_b64_tr_b16 v[98:99], v27 offset:11544
  v_mfma_f32_16x16x32_bf16 v[116:119], v[60:63], v[32:35], v[116:119]
  ds_read_b64_tr_b16 v[100:101], v27 offset:10272
  v_mfma_f32_16x16x32_bf16 v[136:139], v[60:63], v[36:39], v[136:139]
  ds_read_b64_tr_b16 v[102:103], v27 offset:11552
  v_mfma_f32_16x16x32_bf16 v[156:159], v[60:63], v[40:43], v[156:159]
  s_add_u32 m0, s74, 139264
  v_mfma_f32_16x16x32_bf16 v[176:179], v[60:63], v[44:47], v[176:179]
  s_add_u32 s65, s65, s9
  v_mfma_f32_16x16x32_bf16 v[120:123], v[64:67], v[32:35], v[120:123]
  buffer_load_dwordx4 v24, s[44:47], s65 offen  lds
  v_mfma_f32_16x16x32_bf16 v[140:143], v[64:67], v[36:39], v[140:143]
  buffer_load_dwordx4 v25, s[44:47], s65 offen offset:1024  lds
  v_mfma_f32_16x16x32_bf16 v[160:163], v[64:67], v[40:43], v[160:163]
  s_mov_b32 exec_hi, 0
  buffer_load_dwordx4 v26, s[44:47], s65 offen offset:2048  lds
  s_mov_b32 exec_hi, -1
  v_mfma_f32_16x16x32_bf16 v[180:183], v[64:67], v[44:47], v[180:183]
  s_waitcnt vmcnt(7) lgkmcnt(0)
  s_barrier
  v_mfma_f32_16x16x32_bf16 v[104:107], v[84:87], v[68:71], v[104:107]
  ds_read_b128 v[32:35], v15 offset:32768
  ds_read_b128 v[36:39], v15 offset:34816
  v_mfma_f32_16x16x32_bf16 v[124:127], v[84:87], v[72:75], v[124:127]
  ds_read_b128 v[40:43], v15 offset:36864
  v_mfma_f32_16x16x32_bf16 v[144:147], v[84:87], v[76:79], v[144:147]
  ds_read_b128 v[44:47], v15 offset:38912
  v_mfma_f32_16x16x32_bf16 v[164:167], v[84:87], v[80:83], v[164:167]
  ds_read_b64_tr_b16 v[48:49], v27 offset:20480
  v_mfma_f32_16x16x32_bf16 v[108:111], v[88:91], v[68:71], v[108:111]
  ds_read_b64_tr_b16 v[50:51], v27 offset:21760
  v_mfma_f32_16x16x32_bf16 v[128:131], v[88:91], v[72:75], v[128:131]
  ds_read_b64_tr_b16 v[52:53], v27 offset:20488
  v_mfma_f32_16x16x32_bf16 v[148:151], v[88:91], v[76:79], v[148:151]
  ds_read_b64_tr_b16 v[54:55], v27 offset:21768
  v_mfma_f32_16x16x32_bf16 v[168:171], v[88:91], v[80:83], v[168:171]
  ds_read_b64_tr_b16 v[56:57], v27 offset:20496
  v_mfma_f32_16x16x32_bf16 v[112:115], v[92:95], v[68:71], v[112:115]
  ds_read_b64_tr_b16 v[58:59], v27 offset:21776
  v_mfma_f32_16x16x32_bf16 v[132:135], v[92:95], v[72:75], v[132:135]
  ds_read_b64_tr_b16 v[60:61], v27 offset:20504
  v_mfma_f32_16x16x32_bf16 v[152:155], v[92:95], v[76:79], v[152:155]
  ds_read_b64_tr_b16 v[62:63], v27 offset:21784
  v_mfma_f32_16x16x32_bf16 v[172:175], v[92:95], v[80:83], v[172:175]
  ds_read_b64_tr_b16 v[64:65], v27 offset:20512
  v_mfma_f32_16x16x32_bf16 v[116:119], v[96:99], v[68:71], v[116:119]
  ds_read_b64_tr_b16 v[66:67], v27 offset:21792
  v_mfma_f32_16x16x32_bf16 v[136:139], v[96:99], v[72:75], v[136:139]
  s_add_u32 m0, s66, 0
  v_mfma_f32_16x16x32_bf16 v[156:159], v[96:99], v[76:79], v[156:159]
  s_add_u32 s64, s64, s6
  v_mfma_f32_16x16x32_bf16 v[176:179], v[96:99], v[80:83], v[176:179]
  buffer_load_dwordx4 v11, s[40:43], s64 offen offset:0  lds
  v_mfma_f32_16x16x32_bf16 v[120:123], v[100:103], v[68:71], v[120:123]
  buffer_load_dwordx4 v12, s[40:43], s64 offen offset:1024  lds
  v_mfma_f32_16x16x32_bf16 v[140:143], v[100:103], v[72:75], v[140:143]
  s_add_u32 m0, s66, 0
  v_mfma_f32_16x16x32_bf16 v[160:163], v[100:103], v[76:79], v[160:163]
  buffer_load_dwordx4 v13, s[40:43], s64 offen offset:2048  lds
  v_mfma_f32_16x16x32_bf16 v[180:183], v[100:103], v[80:83], v[180:183]
  buffer_load_dwordx4 v14, s[40:43], s64 offen offset:3072  lds
  s_waitcnt lgkmcnt(0)
  v_mfma_f32_16x16x32_bf16 v[104:107], v[48:51], v[32:35], v[104:107]
  ds_read_b128 v[68:71], v16 offset:32768
  v_mfma_f32_16x16x32_bf16 v[124:127], v[48:51], v[36:39], v[124:127]
  ds_read_b128 v[72:75], v16 offset:34816
  v_mfma_f32_16x16x32_bf16 v[144:147], v[48:51], v[40:43], v[144:147]
  ds_read_b128 v[76:79], v16 offset:36864
  v_mfma_f32_16x16x32_bf16 v[164:167], v[48:51], v[44:47], v[164:167]
  ds_read_b128 v[80:83], v16 offset:38912
  v_mfma_f32_16x16x32_bf16 v[108:111], v[52:55], v[32:35], v[108:111]
  ds_read_b64_tr_b16 v[84:85], v27 offset:30720
  v_mfma_f32_16x16x32_bf16 v[128:131], v[52:55], v[36:39], v[128:131]
  ds_read_b64_tr_b16 v[86:87], v27 offset:32000
  v_mfma_f32_16x16x32_bf16 v[148:151], v[52:55], v[40:43], v[148:151]
  ds_read_b64_tr_b16 v[88:89], v27 offset:30728
  v_mfma_f32_16x16x32_bf16 v[168:171], v[52:55], v[44:47], v[168:171]
  ds_read_b64_tr_b16 v[90:91], v27 offset:32008
  v_mfma_f32_16x16x32_bf16 v[112:115], v[56:59], v[32:35], v[112:115]
  ds_read_b64_tr_b16 v[92:93], v27 offset:30736
  v_mfma_f32_16x16x32_bf16 v[132:135], v[56:59], v[36:39], v[132:135]
  ds_read_b64_tr_b16 v[94:95], v27 offset:32016
  v_mfma_f32_16x16x32_bf16 v[152:155], v[56:59], v[40:43], v[152:155]
  ds_read_b64_tr_b16 v[96:97], v27 offset:30744
  v_mfma_f32_16x16x32_bf16 v[172:175], v[56:59], v[44:47], v[172:175]
  ds_read_b64_tr_b16 v[98:99], v27 offset:32024
  v_mfma_f32_16x16x32_bf16 v[116:119], v[60:63], v[32:35], v[116:119]
  ds_read_b64_tr_b16 v[100:101], v27 offset:30752
  v_mfma_f32_16x16x32_bf16 v[136:139], v[60:63], v[36:39], v[136:139]
  ds_read_b64_tr_b16 v[102:103], v27 offset:32032
  v_mfma_f32_16x16x32_bf16 v[156:159], v[60:63], v[40:43], v[156:159]
  s_add_u32 m0, s74, 98304
  v_mfma_f32_16x16x32_bf16 v[176:179], v[60:63], v[44:47], v[176:179]
  s_add_u32 s65, s65, s83
  v_mfma_f32_16x16x32_bf16 v[120:123], v[64:67], v[32:35], v[120:123]
  buffer_load_dwordx4 v24, s[44:47], s65 offen  lds
  v_mfma_f32_16x16x32_bf16 v[140:143], v[64:67], v[36:39], v[140:143]
  buffer_load_dwordx4 v25, s[44:47], s65 offen offset:1024  lds
  v_mfma_f32_16x16x32_bf16 v[160:163], v[64:67], v[40:43], v[160:163]
  s_mov_b32 exec_hi, 0
  buffer_load_dwordx4 v26, s[44:47], s65 offen offset:2048  lds
  s_mov_b32 exec_hi, -1
  v_mfma_f32_16x16x32_bf16 v[180:183], v[64:67], v[44:47], v[180:183]
  s_waitcnt vmcnt(7) lgkmcnt(0)
  s_barrier
  v_mfma_f32_16x16x32_bf16 v[104:107], v[84:87], v[68:71], v[104:107]
  ds_read_b128 v[32:35], v17 offset:0
  v_mfma_f32_16x16x32_bf16 v[124:127], v[84:87], v[72:75], v[124:127]
  ds_read_b128 v[36:39], v17 offset:2048
  v_mfma_f32_16x16x32_bf16 v[144:147], v[84:87], v[76:79], v[144:147]
  ds_read_b128 v[40:43], v17 offset:4096
  v_mfma_f32_16x16x32_bf16 v[164:167], v[84:87], v[80:83], v[164:167]
  ds_read_b128 v[44:47], v17 offset:6144
  v_mfma_f32_16x16x32_bf16 v[108:111], v[88:91], v[68:71], v[108:111]
  ds_read_b64_tr_b16 v[48:49], v27 offset:40960
  v_mfma_f32_16x16x32_bf16 v[128:131], v[88:91], v[72:75], v[128:131]
  v_mfma_f32_16x16x32_bf16 v[148:151], v[88:91], v[76:79], v[148:151]
  ds_read_b64_tr_b16 v[50:51], v27 offset:42240
  v_mfma_f32_16x16x32_bf16 v[168:171], v[88:91], v[80:83], v[168:171]
  ds_read_b64_tr_b16 v[52:53], v27 offset:40968
  v_mfma_f32_16x16x32_bf16 v[112:115], v[92:95], v[68:71], v[112:115]
  ds_read_b64_tr_b16 v[54:55], v27 offset:42248
  v_mfma_f32_16x16x32_bf16 v[132:135], v[92:95], v[72:75], v[132:135]
  ds_read_b64_tr_b16 v[56:57], v27 offset:40976
  v_mfma_f32_16x16x32_bf16 v[152:155], v[92:95], v[76:79], v[152:155]
  v_mfma_f32_16x16x32_bf16 v[172:175], v[92:95], v[80:83], v[172:175]
  ds_read_b64_tr_b16 v[58:59], v27 offset:42256
  v_mfma_f32_16x16x32_bf16 v[116:119], v[96:99], v[68:71], v[116:119]
  ds_read_b64_tr_b16 v[60:61], v27 offset:40984
  v_mfma_f32_16x16x32_bf16 v[136:139], v[96:99], v[72:75], v[136:139]
  ds_read_b64_tr_b16 v[62:63], v27 offset:42264
  v_mfma_f32_16x16x32_bf16 v[156:159], v[96:99], v[76:79], v[156:159]
  ds_read_b64_tr_b16 v[64:65], v27 offset:40992
  v_mfma_f32_16x16x32_bf16 v[176:179], v[96:99], v[80:83], v[176:179]
  v_mfma_f32_16x16x32_bf16 v[120:123], v[100:103], v[68:71], v[120:123]
  ds_read_b64_tr_b16 v[66:67], v27 offset:42272
  v_mfma_f32_16x16x32_bf16 v[140:143], v[100:103], v[72:75], v[140:143]
  v_mov_b32 v29, 0
  v_mfma_f32_16x16x32_bf16 v[160:163], v[100:103], v[76:79], v[160:163]
  buffer_load_dword v29, v29, s[84:87], 0 offen offset:128 sc1
  v_mfma_f32_16x16x32_bf16 v[180:183], v[100:103], v[80:83], v[180:183]
  s_waitcnt lgkmcnt(0)
  v_mfma_f32_16x16x32_bf16 v[104:107], v[48:51], v[32:35], v[104:107]
  ds_read_b128 v[68:71], v18 offset:0
  v_mfma_f32_16x16x32_bf16 v[124:127], v[48:51], v[36:39], v[124:127]
  ds_read_b128 v[72:75], v18 offset:2048
  v_mfma_f32_16x16x32_bf16 v[144:147], v[48:51], v[40:43], v[144:147]
  ds_read_b128 v[76:79], v18 offset:4096
  v_mfma_f32_16x16x32_bf16 v[164:167], v[48:51], v[44:47], v[164:167]
  v_mfma_f32_16x16x32_bf16 v[108:111], v[52:55], v[32:35], v[108:111]
  ds_read_b128 v[80:83], v18 offset:6144
  v_mfma_f32_16x16x32_bf16 v[128:131], v[52:55], v[36:39], v[128:131]
  ds_read_b64_tr_b16 v[84:85], v27 offset:51200
  v_mfma_f32_16x16x32_bf16 v[148:151], v[52:55], v[40:43], v[148:151]
  v_mfma_f32_16x16x32_bf16 v[168:171], v[52:55], v[44:47], v[168:171]
  ds_read_b64_tr_b16 v[86:87], v27 offset:52480
  v_mfma_f32_16x16x32_bf16 v[112:115], v[56:59], v[32:35], v[112:115]
  ds_read_b64_tr_b16 v[88:89], v27 offset:51208
  v_mfma_f32_16x16x32_bf16 v[132:135], v[56:59], v[36:39], v[132:135]
  ds_read_b64_tr_b16 v[90:91], v27 offset:52488
  v_mfma_f32_16x16x32_bf16 v[152:155], v[56:59], v[40:43], v[152:155]
  v_mfma_f32_16x16x32_bf16 v[172:175], v[56:59], v[44:47], v[172:175]
  ds_read_b64_tr_b16 v[92:93], v27 offset:51216
  v_mfma_f32_16x16x32_bf16 v[116:119], v[60:63], v[32:35], v[116:119]
  ds_read_b64_tr_b16 v[94:95], v27 offset:52496
  v_mfma_f32_16x16x32_bf16 v[136:139], v[60:63], v[36:39], v[136:139]
  v_mfma_f32_16x16x32_bf16 v[156:159], v[60:63], v[40:43], v[156:159]
  ds_read_b64_tr_b16 v[96:97], v27 offset:51224
  v_mfma_f32_16x16x32_bf16 v[176:179], v[60:63], v[44:47], v[176:179]
  ds_read_b64_tr_b16 v[98:99], v27 offset:52504
  v_mfma_f32_16x16x32_bf16 v[120:123], v[64:67], v[32:35], v[120:123]
  v_mfma_f32_16x16x32_bf16 v[140:143], v[64:67], v[36:39], v[140:143]
  ds_read_b64_tr_b16 v[100:101], v27 offset:51232
  v_mfma_f32_16x16x32_bf16 v[160:163], v[64:67], v[40:43], v[160:163]
  ds_read_b64_tr_b16 v[102:103], v27 offset:52512
  v_mfma_f32_16x16x32_bf16 v[180:183], v[64:67], v[44:47], v[180:183]
  s_waitcnt vmcnt(0) lgkmcnt(0)
  v_readfirstlane_b32 s14, v29
  s_nop 0
  s_cmp_eq_u32 s14, 0
  s_cbranch_scc1 INITOK_19o
INITOK_19:
  s_barrier
  v_mfma_f32_16x16x32_bf16 v[104:107], v[84:87], v[68:71], v[104:107]
  ds_read_b128 v[32:35], v15 offset:0
  v_mfma_f32_16x16x32_bf16 v[124:127], v[84:87], v[72:75], v[124:127]
  ds_read_b128 v[36:39], v15 offset:2048
  v_mfma_f32_16x16x32_bf16 v[144:147], v[84:87], v[76:79], v[144:147]
  ds_read_b128 v[40:43], v15 offset:4096
  v_mfma_f32_16x16x32_bf16 v[164:167], v[84:87], v[80:83], v[164:167]
  ds_read_b128 v[44:47], v15 offset:6144
  v_mfma_f32_16x16x32_bf16 v[108:111], v[88:91], v[68:71], v[108:111]
  ds_read_b64_tr_b16 v[48:49], v27 offset:0
  v_mfma_f32_16x16x32_bf16 v[128:131], v[88:91], v[72:75], v[128:131]
  ds_read_b64_tr_b16 v[50:51], v27 offset:1280
  v_mfma_f32_16x16x32_bf16 v[148:151], v[88:91], v[76:79], v[148:151]
  v_mfma_f32_16x16x32_bf16 v[168:171], v[88:91], v[80:83], v[168:171]
  ds_read_b64_tr_b16 v[52:53], v27 offset:8
  v_mfma_f32_16x16x32_bf16 v[112:115], v[92:95], v[68:71], v[112:115]
  ds_read_b64_tr_b16 v[54:55], v27 offset:1288
  v_mfma_f32_16x16x32_bf16 v[132:135], v[92:95], v[72:75], v[132:135]
  ds_read_b64_tr_b16 v[56:57], v27 offset:16
  v_mfma_f32_16x16x32_bf16 v[152:155], v[92:95], v[76:79], v[152:155]
  ds_read_b64_tr_b16 v[58:59], v27 offset:1296
  v_mfma_f32_16x16x32_bf16 v[172:175], v[92:95], v[80:83], v[172:175]
  ds_read_b64_tr_b16 v[60:61], v27 offset:24
  v_mfma_f32_16x16x32_bf16 v[116:119], v[96:99], v[68:71], v[116:119]
  ds_read_b64_tr_b16 v[62:63], v27 offset:1304
  v_mfma_f32_16x16x32_bf16 v[136:139], v[96:99], v[72:75], v[136:139]
  v_mfma_f32_16x16x32_bf16 v[156:159], v[96:99], v[76:79], v[156:159]
  ds_read_b64_tr_b16 v[64:65], v27 offset:32
  v_mfma_f32_16x16x32_bf16 v[176:179], v[96:99], v[80:83], v[176:179]
  ds_read_b64_tr_b16 v[66:67], v27 offset:1312
  v_mfma_f32_16x16x32_bf16 v[120:123], v[100:103], v[68:71], v[120:123]
  v_lshlrev_b32 v2, 4, v1
  v_mfma_f32_16x16x32_bf16 v[140:143], v[100:103], v[72:75], v[140:143]
  v_add_u32 v2, 135168, v2
  v_mfma_f32_16x16x32_bf16 v[160:163], v[100:103], v[76:79], v[160:163]
  ds_write_b128 v2, v[184:187]
  v_mfma_f32_16x16x32_bf16 v[180:183], v[100:103], v[80:83], v[180:183]
  s_waitcnt lgkmcnt(0)
  v_mfma_f32_16x16x32_bf16 v[104:107], v[48:51], v[32:35], v[104:107]
  ds_read_b128 v[68:71], v16 offset:0
  v_mfma_f32_16x16x32_bf16 v[124:127], v[48:51], v[36:39], v[124:127]
  ds_read_b128 v[72:75], v16 offset:2048
  v_mfma_f32_16x16x32_bf16 v[144:147], v[48:51], v[40:43], v[144:147]
  ds_read_b128 v[76:79], v16 offset:4096
  v_mfma_f32_16x16x32_bf16 v[164:167], v[48:51], v[44:47], v[164:167]
  v_mfma_f32_16x16x32_bf16 v[108:111], v[52:55], v[32:35], v[108:111]
  ds_read_b128 v[80:83], v16 offset:6144
  v_mfma_f32_16x16x32_bf16 v[128:131], v[52:55], v[36:39], v[128:131]
  ds_read_b64_tr_b16 v[84:85], v27 offset:10240
  v_mfma_f32_16x16x32_bf16 v[148:151], v[52:55], v[40:43], v[148:151]
  v_mfma_f32_16x16x32_bf16 v[168:171], v[52:55], v[44:47], v[168:171]
  ds_read_b64_tr_b16 v[86:87], v27 offset:11520
  v_mfma_f32_16x16x32_bf16 v[112:115], v[56:59], v[32:35], v[112:115]
  ds_read_b64_tr_b16 v[88:89], v27 offset:10248
  v_mfma_f32_16x16x32_bf16 v[132:135], v[56:59], v[36:39], v[132:135]
  ds_read_b64_tr_b16 v[90:91], v27 offset:11528
  v_mfma_f32_16x16x32_bf16 v[152:155], v[56:59], v[40:43], v[152:155]
  v_mfma_f32_16x16x32_bf16 v[172:175], v[56:59], v[44:47], v[172:175]
  ds_read_b64_tr_b16 v[92:93], v27 offset:10256
  v_mfma_f32_16x16x32_bf16 v[116:119], v[60:63], v[32:35], v[116:119]
  ds_read_b64_tr_b16 v[94:95], v27 offset:11536
  v_mfma_f32_16x16x32_bf16 v[136:139], v[60:63], v[36:39], v[136:139]
  v_mfma_f32_16x16x32_bf16 v[156:159], v[60:63], v[40:43], v[156:159]
  ds_read_b64_tr_b16 v[96:97], v27 offset:10264
  v_mfma_f32_16x16x32_bf16 v[176:179], v[60:63], v[44:47], v[176:179]
  ds_read_b64_tr_b16 v[98:99], v27 offset:11544
  v_mfma_f32_16x16x32_bf16 v[120:123], v[64:67], v[32:35], v[120:123]
  v_mfma_f32_16x16x32_bf16 v[140:143], v[64:67], v[36:39], v[140:143]
  ds_read_b64_tr_b16 v[100:101], v27 offset:10272
  v_mfma_f32_16x16x32_bf16 v[160:163], v[64:67], v[40:43], v[160:163]
  ds_read_b64_tr_b16 v[102:103], v27 offset:11552
  v_mfma_f32_16x16x32_bf16 v[180:183], v[64:67], v[44:47], v[180:183]
  s_waitcnt lgkmcnt(0)
  s_barrier
  v_mfma_f32_16x16x32_bf16 v[104:107], v[84:87], v[68:71], v[104:107]
  ds_read_b64_tr_b16 v[32:33], v28 offset:0
  ds_read_b64_tr_b16 v[34:35], v28 offset:160
  v_mfma_f32_16x16x32_bf16 v[124:127], v[84:87], v[72:75], v[124:127]
  ds_read_b64_tr_b16 v[36:37], v28 offset:320
  v_mfma_f32_16x16x32_bf16 v[144:147], v[84:87], v[76:79], v[144:147]
  ds_read_b64_tr_b16 v[38:39], v28 offset:480
  v_mfma_f32_16x16x32_bf16 v[164:167], v[84:87], v[80:83], v[164:167]
  ds_read_b64_tr_b16 v[200:201], v28 offset:640
  ds_read_b64_tr_b16 v[40:41], v28 offset:8
  v_mfma_f32_16x16x32_bf16 v[108:111], v[88:91], v[68:71], v[108:111]
  ds_read_b64_tr_b16 v[42:43], v28 offset:168
  v_mfma_f32_16x16x32_bf16 v[128:131], v[88:91], v[72:75], v[128:131]
  ds_read_b64_tr_b16 v[44:45], v28 offset:328
  v_mfma_f32_16x16x32_bf16 v[148:151], v[88:91], v[76:79], v[148:151]
  ds_read_b64_tr_b16 v[46:47], v28 offset:488
  v_mfma_f32_16x16x32_bf16 v[168:171], v[88:91], v[80:83], v[168:171]
  ds_read_b64_tr_b16 v[202:203], v28 offset:648
  ds_read_b64_tr_b16 v[48:49], v28 offset:16
  v_mfma_f32_16x16x32_bf16 v[112:115], v[92:95], v[68:71], v[112:115]
  ds_read_b64_tr_b16 v[50:51], v28 offset:176
  v_mfma_f32_16x16x32_bf16 v[132:135], v[92:95], v[72:75], v[132:135]
  ds_read_b64_tr_b16 v[52:53], v28 offset:336
  v_mfma_f32_16x16x32_bf16 v[152:155], v[92:95], v[76:79], v[152:155]
  ds_read_b64_tr_b16 v[54:55], v28 offset:496
  v_mfma_f32_16x16x32_bf16 v[172:175], v[92:95], v[80:83], v[172:175]
  ds_read_b64_tr_b16 v[204:205], v28 offset:656
  ds_read_b64_tr_b16 v[56:57], v28 offset:24
  v_mfma_f32_16x16x32_bf16 v[116:119], v[96:99], v[68:71], v[116:119]
  ds_read_b64_tr_b16 v[58:59], v28 offset:184
  v_mfma_f32_16x16x32_bf16 v[136:139], v[96:99], v[72:75], v[136:139]
  ds_read_b64_tr_b16 v[60:61], v28 offset:344
  v_mfma_f32_16x16x32_bf16 v[156:159], v[96:99], v[76:79], v[156:159]
  ds_read_b64_tr_b16 v[62:63], v28 offset:504
  v_mfma_f32_16x16x32_bf16 v[176:179], v[96:99], v[80:83], v[176:179]
  ds_read_b64_tr_b16 v[206:207], v28 offset:664
  ds_read_b64_tr_b16 v[64:65], v28 offset:32
  v_mfma_f32_16x16x32_bf16 v[120:123], v[100:103], v[68:71], v[120:123]
  ds_read_b64_tr_b16 v[66:67], v28 offset:192
  v_mfma_f32_16x16x32_bf16 v[140:143], v[100:103], v[72:75], v[140:143]
  ds_read_b64_tr_b16 v[196:197], v28 offset:352
  v_mfma_f32_16x16x32_bf16 v[160:163], v[100:103], v[76:79], v[160:163]
  ds_read_b64_tr_b16 v[198:199], v28 offset:512
  v_mfma_f32_16x16x32_bf16 v[180:183], v[100:103], v[80:83], v[180:183]
  ds_read_b64_tr_b16 v[248:249], v28 offset:672
  s_setprio 2
  s_lshl_b32 s70, s63, 2
  s_add_u32 s70, s70, s71
  s_cmp_eq_u32 s81, 0
  s_cbranch_scc1 R_KV
  v_cvt_pk_bf16_f32 v68, v104, v105
  v_cvt_pk_bf16_f32 v69, v106, v107
  v_cvt_pk_bf16_f32 v70, v108, v109
  v_cvt_pk_bf16_f32 v71, v110, v111
  v_cvt_pk_bf16_f32 v72, v112, v113
  v_cvt_pk_bf16_f32 v73, v114, v115
  v_cvt_pk_bf16_f32 v74, v116, v117
  v_cvt_pk_bf16_f32 v75, v118, v119
  v_cvt_pk_bf16_f32 v76, v120, v121
  v_cvt_pk_bf16_f32 v77, v122, v123
  v_cvt_pk_bf16_f32 v78, v124, v125
  v_cvt_pk_bf16_f32 v79, v126, v127
  v_cvt_pk_bf16_f32 v80, v128, v129
  v_cvt_pk_bf16_f32 v81, v130, v131
  v_cvt_pk_bf16_f32 v82, v132, v133
  v_cvt_pk_bf16_f32 v83, v134, v135
  v_cvt_pk_bf16_f32 v84, v136, v137
  v_cvt_pk_bf16_f32 v85, v138, v139
  v_cvt_pk_bf16_f32 v86, v140, v141
  v_cvt_pk_bf16_f32 v87, v142, v143
  v_cvt_pk_bf16_f32 v88, v144, v145
  v_cvt_pk_bf16_f32 v89, v146, v147
  v_cvt_pk_bf16_f32 v90, v148, v149
  v_cvt_pk_bf16_f32 v91, v150, v151
  v_cvt_pk_bf16_f32 v92, v152, v153
  v_cvt_pk_bf16_f32 v93, v154, v155
  v_cvt_pk_bf16_f32 v94, v156, v157
  v_cvt_pk_bf16_f32 v95, v158, v159
  v_cvt_pk_bf16_f32 v96, v160, v161
  v_cvt_pk_bf16_f32 v97, v162, v163
  v_cvt_pk_bf16_f32 v98, v164, v165
  v_cvt_pk_bf16_f32 v99, v166, v167
  v_cvt_pk_bf16_f32 v100, v168, v169
  v_cvt_pk_bf16_f32 v101, v170, v171
  v_cvt_pk_bf16_f32 v102, v172, v173
  v_cvt_pk_bf16_f32 v103, v174, v175
  v_cvt_pk_bf16_f32 v104, v176, v177
  v_cvt_pk_bf16_f32 v105, v178, v179
  v_cvt_pk_bf16_f32 v106, v180, v181
  v_cvt_pk_bf16_f32 v107, v182, v183
  s_waitcnt lgkmcnt(0)
  s_lshr_b32 s68, s82, 2
  s_add_u32 s68, s68, s72
  s_lshl_b32 s9, s70, 3
  s_add_u32 s9, s9, s68
  s_mul_i32 s9, s9, 10240
  s_add_u32 s9, s9, 13631488
  s_add_u32 s67, s9, 8192
  s_lshl_b32 s88, s70, 7
  s_add_u32 s88, s88, 19070980
  v_mfma_f32_16x16x32_bf16 v[108:111], v[32:35], v[68:71], 0
  v_mfma_f32_16x16x32_bf16 v[112:115], v[40:43], v[68:71], 0
  v_mfma_f32_16x16x32_bf16 v[116:119], v[48:51], v[68:71], 0
  v_mfma_f32_16x16x32_bf16 v[120:123], v[56:59], v[68:71], 0
  v_mfma_f32_16x16x32_bf16 v[124:127], v[64:67], v[68:71], 0
  v_mfma_f32_16x16x32_bf16 v[108:111], v[36:39], v[72:75], v[108:111]
  v_mfma_f32_16x16x32_bf16 v[112:115], v[44:47], v[72:75], v[112:115]
  v_mfma_f32_16x16x32_bf16 v[116:119], v[52:55], v[72:75], v[116:119]
  v_mfma_f32_16x16x32_bf16 v[120:123], v[60:63], v[72:75], v[120:123]
  v_mfma_f32_16x16x32_bf16 v[124:127], v[196:199], v[72:75], v[124:127]
  v_mfma_f32_16x16x16_bf16 v[108:111], v[200:201], v[76:77], v[108:111]
  v_mfma_f32_16x16x16_bf16 v[112:115], v[202:203], v[76:77], v[112:115]
  v_mfma_f32_16x16x16_bf16 v[116:119], v[204:205], v[76:77], v[116:119]
  v_mfma_f32_16x16x16_bf16 v[120:123], v[206:207], v[76:77], v[120:123]
  v_mfma_f32_16x16x16_bf16 v[124:127], v[248:249], v[76:77], v[124:127]
  v_mfma_f32_16x16x32_bf16 v[128:131], v[32:35], v[78:81], 0
  v_mfma_f32_16x16x32_bf16 v[132:135], v[40:43], v[78:81], 0
  v_mfma_f32_16x16x32_bf16 v[136:139], v[48:51], v[78:81], 0
  s_nop 0
  v_cvt_pk_bf16_f32 v208, v108, v109
  v_mfma_f32_16x16x32_bf16 v[140:143], v[56:59], v[78:81], 0
  v_cvt_pk_bf16_f32 v209, v110, v111
  v_mfma_f32_16x16x32_bf16 v[144:147], v[64:67], v[78:81], 0
  v_cvt_pk_bf16_f32 v210, v112, v113
  v_mfma_f32_16x16x32_bf16 v[128:131], v[36:39], v[82:85], v[128:131]
  v_cvt_pk_bf16_f32 v211, v114, v115
  v_mfma_f32_16x16x32_bf16 v[132:135], v[44:47], v[82:85], v[132:135]
  v_cvt_pk_bf16_f32 v212, v116, v117
  v_mfma_f32_16x16x32_bf16 v[136:139], v[52:55], v[82:85], v[136:139]
  v_cvt_pk_bf16_f32 v213, v118, v119
  v_mfma_f32_16x16x32_bf16 v[140:143], v[60:63], v[82:85], v[140:143]
  v_cvt_pk_bf16_f32 v214, v120, v121
  v_mfma_f32_16x16x32_bf16 v[144:147], v[196:199], v[82:85], v[144:147]
  v_cvt_pk_bf16_f32 v215, v122, v123
  v_mfma_f32_16x16x16_bf16 v[128:131], v[200:201], v[86:87], v[128:131]
  v_cvt_pk_bf16_f32 v240, v124, v125
  v_mfma_f32_16x16x16_bf16 v[132:135], v[202:203], v[86:87], v[132:135]
  v_cvt_pk_bf16_f32 v241, v126, v127
  v_mfma_f32_16x16x16_bf16 v[136:139], v[204:205], v[86:87], v[136:139]
  buffer_store_dwordx4 v[208:211], v20, s[48:51], s9 offen offset:0 sc1
  v_mfma_f32_16x16x16_bf16 v[140:143], v[206:207], v[86:87], v[140:143]
  buffer_store_dwordx4 v[212:215], v20, s[48:51], s9 offen offset:1024 sc1
  v_mfma_f32_16x16x16_bf16 v[144:147], v[248:249], v[86:87], v[144:147]
  v_mfma_f32_16x16x32_bf16 v[148:151], v[32:35], v[88:91], 0
  v_mfma_f32_16x16x32_bf16 v[152:155], v[40:43], v[88:91], 0
  v_mfma_f32_16x16x32_bf16 v[156:159], v[48:51], v[88:91], 0
  v_cvt_pk_bf16_f32 v216, v128, v129
  v_mfma_f32_16x16x32_bf16 v[160:163], v[56:59], v[88:91], 0
  v_cvt_pk_bf16_f32 v217, v130, v131
  v_mfma_f32_16x16x32_bf16 v[164:167], v[64:67], v[88:91], 0
  v_cvt_pk_bf16_f32 v218, v132, v133
  v_mfma_f32_16x16x32_bf16 v[148:151], v[36:39], v[92:95], v[148:151]
  v_cvt_pk_bf16_f32 v219, v134, v135
  v_mfma_f32_16x16x32_bf16 v[152:155], v[44:47], v[92:95], v[152:155]
  v_cvt_pk_bf16_f32 v220, v136, v137
  v_mfma_f32_16x16x32_bf16 v[156:159], v[52:55], v[92:95], v[156:159]
  v_cvt_pk_bf16_f32 v221, v138, v139
  v_mfma_f32_16x16x32_bf16 v[160:163], v[60:63], v[92:95], v[160:163]
  v_cvt_pk_bf16_f32 v222, v140, v141
  v_mfma_f32_16x16x32_bf16 v[164:167], v[196:199], v[92:95], v[164:167]
  v_cvt_pk_bf16_f32 v223, v142, v143
  v_mfma_f32_16x16x16_bf16 v[148:151], v[200:201], v[96:97], v[148:151]
  v_cvt_pk_bf16_f32 v242, v144, v145
  v_mfma_f32_16x16x16_bf16 v[152:155], v[202:203], v[96:97], v[152:155]
  v_cvt_pk_bf16_f32 v243, v146, v147
  v_mfma_f32_16x16x16_bf16 v[156:159], v[204:205], v[96:97], v[156:159]
  buffer_store_dwordx4 v[216:219], v20, s[48:51], s9 offen offset:2048 sc1
  v_mfma_f32_16x16x16_bf16 v[160:163], v[206:207], v[96:97], v[160:163]
  buffer_store_dwordx4 v[220:223], v20, s[48:51], s9 offen offset:3072 sc1
  v_mfma_f32_16x16x16_bf16 v[164:167], v[248:249], v[96:97], v[164:167]
  buffer_store_dwordx4 v[240:243], v20, s[48:51], s67 offen offset:0 sc1
  v_mfma_f32_16x16x32_bf16 v[168:171], v[32:35], v[98:101], 0
  v_mfma_f32_16x16x32_bf16 v[172:175], v[40:43], v[98:101], 0
  v_mfma_f32_16x16x32_bf16 v[176:179], v[48:51], v[98:101], 0
  v_cvt_pk_bf16_f32 v224, v148, v149
  v_mfma_f32_16x16x32_bf16 v[180:183], v[56:59], v[98:101], 0
  v_cvt_pk_bf16_f32 v225, v150, v151
  v_mfma_f32_16x16x32_bf16 v[184:187], v[64:67], v[98:101], 0
  v_cvt_pk_bf16_f32 v226, v152, v153
  v_mfma_f32_16x16x32_bf16 v[168:171], v[36:39], v[102:105], v[168:171]
  v_cvt_pk_bf16_f32 v227, v154, v155
  v_mfma_f32_16x16x32_bf16 v[172:175], v[44:47], v[102:105], v[172:175]
  v_cvt_pk_bf16_f32 v228, v156, v157
  v_mfma_f32_16x16x32_bf16 v[176:179], v[52:55], v[102:105], v[176:179]
  v_cvt_pk_bf16_f32 v229, v158, v159
  v_mfma_f32_16x16x32_bf16 v[180:183], v[60:63], v[102:105], v[180:183]
  v_cvt_pk_bf16_f32 v230, v160, v161
  v_mfma_f32_16x16x32_bf16 v[184:187], v[196:199], v[102:105], v[184:187]
  v_cvt_pk_bf16_f32 v231, v162, v163
  v_mfma_f32_16x16x16_bf16 v[168:171], v[200:201], v[106:107], v[168:171]
  v_cvt_pk_bf16_f32 v244, v164, v165
  v_mfma_f32_16x16x16_bf16 v[172:175], v[202:203], v[106:107], v[172:175]
  v_cvt_pk_bf16_f32 v245, v166, v167
  v_mfma_f32_16x16x16_bf16 v[176:179], v[204:205], v[106:107], v[176:179]
  buffer_store_dwordx4 v[224:227], v21, s[48:51], s9 offen offset:0 sc1
  v_mfma_f32_16x16x16_bf16 v[180:183], v[206:207], v[106:107], v[180:183]
  buffer_store_dwordx4 v[228:231], v21, s[48:51], s9 offen offset:1024 sc1
  v_mfma_f32_16x16x16_bf16 v[184:187], v[248:249], v[106:107], v[184:187]
  v_cvt_pk_bf16_f32 v232, v168, v169
  v_cvt_pk_bf16_f32 v233, v170, v171
  v_cvt_pk_bf16_f32 v234, v172, v173
  v_cvt_pk_bf16_f32 v235, v174, v175
  v_cvt_pk_bf16_f32 v236, v176, v177
  v_cvt_pk_bf16_f32 v237, v178, v179
  v_cvt_pk_bf16_f32 v238, v180, v181
  v_cvt_pk_bf16_f32 v239, v182, v183
  v_cvt_pk_bf16_f32 v246, v184, v185
  v_cvt_pk_bf16_f32 v247, v186, v187
  buffer_store_dwordx4 v[232:235], v21, s[48:51], s9 offen offset:2048 sc1
  buffer_store_dwordx4 v[236:239], v21, s[48:51], s9 offen offset:3072 sc1
  buffer_store_dwordx4 v[244:247], v20, s[48:51], s67 offen offset:1024 sc1
  s_mov_b32 s7, 7
  v_mov_b32 v31, 0
  s_mov_b32 s8, 6
  s_mov_b32 s77, 0
  s_branch P2
R_KV:
  s_lshl_b32 s68, s71, 1
  s_add_u32 s67, s68, 1
  s_mul_i32 s67, s67, 11264
  v_add_u32 v2, s67, v20
  s_mov_b32 s8, 2
  s_cmp_eq_u32 s72, 1
  s_cbranch_scc1 R_V
  v_cvt_pk_bf16_f32 v68, v104, v105
  v_cvt_pk_bf16_f32 v69, v106, v107
  v_cvt_pk_bf16_f32 v70, v108, v109
  v_cvt_pk_bf16_f32 v71, v110, v111
  v_cvt_pk_bf16_f32 v72, v112, v113
  v_cvt_pk_bf16_f32 v73, v114, v115
  v_cvt_pk_bf16_f32 v74, v116, v117
  v_cvt_pk_bf16_f32 v75, v118, v119
  v_cvt_pk_bf16_f32 v76, v120, v121
  v_cvt_pk_bf16_f32 v77, v122, v123
  v_cvt_pk_bf16_f32 v88, v144, v145
  v_cvt_pk_bf16_f32 v89, v146, v147
  v_cvt_pk_bf16_f32 v90, v148, v149
  v_cvt_pk_bf16_f32 v91, v150, v151
  v_cvt_pk_bf16_f32 v92, v152, v153
  v_cvt_pk_bf16_f32 v93, v154, v155
  v_cvt_pk_bf16_f32 v94, v156, v157
  v_cvt_pk_bf16_f32 v95, v158, v159
  v_cvt_pk_bf16_f32 v96, v160, v161
  v_cvt_pk_bf16_f32 v97, v162, v163
  v_cvt_pk_bf16_f32 v98, v164, v165
  v_cvt_pk_bf16_f32 v99, v166, v167
  v_cvt_pk_bf16_f32 v100, v168, v169
  v_cvt_pk_bf16_f32 v101, v170, v171
  v_cvt_pk_bf16_f32 v102, v172, v173
  v_cvt_pk_bf16_f32 v103, v174, v175
  v_cvt_pk_bf16_f32 v104, v176, v177
  v_cvt_pk_bf16_f32 v105, v178, v179
  v_cvt_pk_bf16_f32 v106, v180, v181
  v_cvt_pk_bf16_f32 v107, v182, v183
  s_waitcnt lgkmcnt(0)
  ds_write_b128 v2, v[88:91] offset:0
  ds_write_b128 v2, v[92:95] offset:1024
  ds_write_b128 v2, v[96:99] offset:2048
  ds_write_b128 v2, v[100:103] offset:3072
  ds_write_b128 v2, v[104:107] offset:4096
  v_cvt_pk_bf16_f32 v78, v124, v125
  v_cvt_pk_bf16_f32 v79, v126, v127
  v_mfma_f32_16x16x32_bf16 v[108:111], v[32:35], v[68:71], 0
  v_cvt_pk_bf16_f32 v80, v128, v129
  v_mfma_f32_16x16x32_bf16 v[112:115], v[40:43], v[68:71], 0
  v_cvt_pk_bf16_f32 v81, v130, v131
  v_mfma_f32_16x16x32_bf16 v[116:119], v[48:51], v[68:71], 0
  v_cvt_pk_bf16_f32 v82, v132, v133
  v_mfma_f32_16x16x32_bf16 v[120:123], v[56:59], v[68:71], 0
  v_cvt_pk_bf16_f32 v83, v134, v135
  v_mfma_f32_16x16x32_bf16 v[124:127], v[64:67], v[68:71], 0
  v_cvt_pk_bf16_f32 v84, v136, v137
  v_mfma_f32_16x16x32_bf16 v[108:111], v[36:39], v[72:75], v[108:111]
  v_cvt_pk_bf16_f32 v85, v138, v139
  v_mfma_f32_16x16x32_bf16 v[112:115], v[44:47], v[72:75], v[112:115]
  v_cvt_pk_bf16_f32 v86, v140, v141
  v_mfma_f32_16x16x32_bf16 v[116:119], v[52:55], v[72:75], v[116:119]
  v_cvt_pk_bf16_f32 v87, v142, v143
  v_mfma_f32_16x16x32_bf16 v[120:123], v[60:63], v[72:75], v[120:123]
  s_waitcnt lgkmcnt(0)
  s_barrier
  v_mfma_f32_16x16x32_bf16 v[124:127], v[196:199], v[72:75], v[124:127]
  v_mfma_f32_16x16x16_bf16 v[108:111], v[200:201], v[76:77], v[108:111]
  v_mfma_f32_16x16x16_bf16 v[112:115], v[202:203], v[76:77], v[112:115]
  v_mfma_f32_16x16x16_bf16 v[116:119], v[204:205], v[76:77], v[116:119]
  v_mfma_f32_16x16x16_bf16 v[120:123], v[206:207], v[76:77], v[120:123]
  v_mfma_f32_16x16x16_bf16 v[124:127], v[248:249], v[76:77], v[124:127]
  s_branch R_KV2
R_V:
  v_cvt_pk_bf16_f32 v88, v164, v165
  v_cvt_pk_bf16_f32 v89, v166, v167
  v_cvt_pk_bf16_f32 v90, v168, v169
  v_cvt_pk_bf16_f32 v91, v170, v171
  v_cvt_pk_bf16_f32 v92, v172, v173
  v_cvt_pk_bf16_f32 v93, v174, v175
  v_cvt_pk_bf16_f32 v94, v176, v177
  v_cvt_pk_bf16_f32 v95, v178, v179
  v_cvt_pk_bf16_f32 v96, v180, v181
  v_cvt_pk_bf16_f32 v97, v182, v183
  v_cvt_pk_bf16_f32 v98, v104, v105
  v_cvt_pk_bf16_f32 v99, v106, v107
  v_cvt_pk_bf16_f32 v100, v108, v109
  v_cvt_pk_bf16_f32 v101, v110, v111
  v_cvt_pk_bf16_f32 v102, v112, v113
  v_cvt_pk_bf16_f32 v103, v114, v115
  v_cvt_pk_bf16_f32 v104, v116, v117
  v_cvt_pk_bf16_f32 v105, v118, v119
  v_cvt_pk_bf16_f32 v106, v120, v121
  v_cvt_pk_bf16_f32 v107, v122, v123
  v_cvt_pk_bf16_f32 v168, v124, v125
  v_cvt_pk_bf16_f32 v169, v126, v127
  v_cvt_pk_bf16_f32 v170, v128, v129
  v_cvt_pk_bf16_f32 v171, v130, v131
  v_cvt_pk_bf16_f32 v172, v132, v133
  v_cvt_pk_bf16_f32 v173, v134, v135
  v_cvt_pk_bf16_f32 v174, v136, v137
  v_cvt_pk_bf16_f32 v175, v138, v139
  v_cvt_pk_bf16_f32 v176, v140, v141
  v_cvt_pk_bf16_f32 v177, v142, v143
  v_cvt_pk_bf16_f32 v178, v144, v145
  v_cvt_pk_bf16_f32 v179, v146, v147
  v_cvt_pk_bf16_f32 v180, v148, v149
  v_cvt_pk_bf16_f32 v181, v150, v151
  v_cvt_pk_bf16_f32 v182, v152, v153
  v_cvt_pk_bf16_f32 v183, v154, v155
  v_cvt_pk_bf16_f32 v184, v156, v157
  v_cvt_pk_bf16_f32 v185, v158, v159
  v_cvt_pk_bf16_f32 v186, v160, v161
  v_cvt_pk_bf16_f32 v187, v162, v163
  s_mul_i32 s69, s71, 11264
  s_add_u32 s69, s69, 90112
  v_mul_u32_u24 v4, 176, v10
  v_add_u32 v3, s69, v4
  v_mul_u32_u24 v5, 40, v7
  v_add_u32 v4, v3, v5
  v_mov_b32 v192, 0x3f80
  v_mov_b32 v193, 0
  s_barrier
  ds_read_b128 v[68:71], v2 offset:0
  ds_read_b128 v[72:75], v2 offset:1024
  ds_read_b128 v[76:79], v2 offset:2048
  ds_read_b128 v[80:83], v2 offset:3072
  ds_read_b128 v[84:87], v2 offset:4096
  ds_write_b64 v4, v[88:89] offset:8448
  ds_write_b64 v4, v[90:91] offset:8456
  ds_write_b64 v4, v[92:93] offset:8464
  ds_write_b64 v4, v[94:95] offset:8472
  ds_write_b64 v4, v[96:97] offset:8480
  ds_write_b64 v3, v[192:193] offset:8608
  ds_write_b64 v4, v[98:99] offset:0
  ds_write_b64 v4, v[100:101] offset:8
  ds_write_b64 v4, v[102:103] offset:16
  s_waitcnt lgkmcnt(9)
  v_mfma_f32_16x16x32_bf16 v[108:111], v[32:35], v[68:71], 0
  ds_write_b64 v4, v[104:105] offset:24
  v_mfma_f32_16x16x32_bf16 v[112:115], v[40:43], v[68:71], 0
  ds_write_b64 v4, v[106:107] offset:32
  v_mfma_f32_16x16x32_bf16 v[116:119], v[48:51], v[68:71], 0
  ds_write_b64 v3, v[192:193] offset:160
  v_mfma_f32_16x16x32_bf16 v[120:123], v[56:59], v[68:71], 0
  ds_write_b64 v4, v[168:169] offset:2816
  v_mfma_f32_16x16x32_bf16 v[124:127], v[64:67], v[68:71], 0
  ds_write_b64 v4, v[170:171] offset:2824
  v_mfma_f32_16x16x32_bf16 v[108:111], v[36:39], v[72:75], v[108:111]
  ds_write_b64 v4, v[172:173] offset:2832
  v_mfma_f32_16x16x32_bf16 v[112:115], v[44:47], v[72:75], v[112:115]
  ds_write_b64 v4, v[174:175] offset:2840
  v_mfma_f32_16x16x32_bf16 v[116:119], v[52:55], v[72:75], v[116:119]
  ds_write_b64 v4, v[176:177] offset:2848
  v_mfma_f32_16x16x32_bf16 v[120:123], v[60:63], v[72:75], v[120:123]
  ds_write_b64 v3, v[192:193] offset:2976
  v_mfma_f32_16x16x32_bf16 v[124:127], v[196:199], v[72:75], v[124:127]
  ds_write_b64 v4, v[178:179] offset:5632
  v_mfma_f32_16x16x16_bf16 v[108:111], v[200:201], v[76:77], v[108:111]
  ds_write_b64 v4, v[180:181] offset:5640
  v_mfma_f32_16x16x16_bf16 v[112:115], v[202:203], v[76:77], v[112:115]
  ds_write_b64 v4, v[182:183] offset:5648
  v_mfma_f32_16x16x16_bf16 v[116:119], v[204:205], v[76:77], v[116:119]
  ds_write_b64 v4, v[184:185] offset:5656
  v_mfma_f32_16x16x16_bf16 v[120:123], v[206:207], v[76:77], v[120:123]
  ds_write_b64 v4, v[186:187] offset:5664
  v_mfma_f32_16x16x16_bf16 v[124:127], v[248:249], v[76:77], v[124:127]
  ds_write_b64 v3, v[192:193] offset:5792
R_KV2:
  s_add_u32 s68, s68, s72
  s_mul_i32 s68, s68, 11264
  v_mul_u32_u24 v6, 352, v10
  v_mul_u32_u24 v5, 80, v7
  v_add3_u32 v6, v6, v5, s68
  v_max3_f32 v250, v108, v109, v110
  v_min3_f32 v252, v108, v109, v110
  v_max3_f32 v250, v250, v111, v112
  v_min3_f32 v252, v252, v111, v112
  v_max3_f32 v250, v250, v113, v114
  v_min3_f32 v252, v252, v113, v114
  v_max3_f32 v250, v250, v115, v116
  v_min3_f32 v252, v252, v115, v116
  v_max3_f32 v250, v250, v117, v118
  v_min3_f32 v252, v252, v117, v118
  v_max3_f32 v250, v250, v119, v120
  v_min3_f32 v252, v252, v119, v120
  v_max3_f32 v250, v250, v121, v122
  v_min3_f32 v252, v252, v121, v122
  v_max3_f32 v250, v250, v123, v124
  v_min3_f32 v252, v252, v123, v124
  v_max3_f32 v250, v250, v125, v126
  v_min3_f32 v252, v252, v125, v126
  v_max_f32 v250, v250, v127
  v_min_f32 v252, v252, v127
  v_mul_f32 v250, s60, v250
  v_mul_f32 v252, s60, v252
  v_pk_fma_f32 v[128:129], v[108:109], s[60:61], v[250:251] op_sel_hi:[1,1,0] neg_lo:[0,0,1] neg_hi:[0,0,1]
  v_pk_fma_f32 v[148:149], v[108:109], s[60:61], v[252:253] op_sel_hi:[1,1,0] neg_lo:[1,0,0] neg_hi:[1,0,0]
  v_pk_fma_f32 v[130:131], v[110:111], s[60:61], v[250:251] op_sel_hi:[1,1,0] neg_lo:[0,0,1] neg_hi:[0,0,1]
  v_pk_fma_f32 v[150:151], v[110:111], s[60:61], v[252:253] op_sel_hi:[1,1,0] neg_lo:[1,0,0] neg_hi:[1,0,0]
  v_pk_fma_f32 v[132:133], v[112:113], s[60:61], v[250:251] op_sel_hi:[1,1,0] neg_lo:[0,0,1] neg_hi:[0,0,1]
  v_pk_fma_f32 v[152:153], v[112:113], s[60:61], v[252:253] op_sel_hi:[1,1,0] neg_lo:[1,0,0] neg_hi:[1,0,0]
  v_pk_fma_f32 v[134:135], v[114:115], s[60:61], v[250:251] op_sel_hi:[1,1,0] neg_lo:[0,0,1] neg_hi:[0,0,1]
  v_pk_fma_f32 v[154:155], v[114:115], s[60:61], v[252:253] op_sel_hi:[1,1,0] neg_lo:[1,0,0] neg_hi:[1,0,0]
  v_pk_fma_f32 v[136:137], v[116:117], s[60:61], v[250:251] op_sel_hi:[1,1,0] neg_lo:[0,0,1] neg_hi:[0,0,1]
  v_pk_fma_f32 v[156:157], v[116:117], s[60:61], v[252:253] op_sel_hi:[1,1,0] neg_lo:[1,0,0] neg_hi:[1,0,0]
  v_pk_fma_f32 v[138:139], v[118:119], s[60:61], v[250:251] op_sel_hi:[1,1,0] neg_lo:[0,0,1] neg_hi:[0,0,1]
  v_pk_fma_f32 v[158:159], v[118:119], s[60:61], v[252:253] op_sel_hi:[1,1,0] neg_lo:[1,0,0] neg_hi:[1,0,0]
  v_pk_fma_f32 v[140:141], v[120:121], s[60:61], v[250:251] op_sel_hi:[1,1,0] neg_lo:[0,0,1] neg_hi:[0,0,1]
  v_pk_fma_f32 v[160:161], v[120:121], s[60:61], v[252:253] op_sel_hi:[1,1,0] neg_lo:[1,0,0] neg_hi:[1,0,0]
  v_pk_fma_f32 v[142:143], v[122:123], s[60:61], v[250:251] op_sel_hi:[1,1,0] neg_lo:[0,0,1] neg_hi:[0,0,1]
  v_pk_fma_f32 v[162:163], v[122:123], s[60:61], v[252:253] op_sel_hi:[1,1,0] neg_lo:[1,0,0] neg_hi:[1,0,0]
  v_pk_fma_f32 v[144:145], v[124:125], s[60:61], v[250:251] op_sel_hi:[1,1,0] neg_lo:[0,0,1] neg_hi:[0,0,1]
  v_pk_fma_f32 v[164:165], v[124:125], s[60:61], v[252:253] op_sel_hi:[1,1,0] neg_lo:[1,0,0] neg_hi:[1,0,0]
  v_pk_fma_f32 v[146:147], v[126:127], s[60:61], v[250:251] op_sel_hi:[1,1,0] neg_lo:[0,0,1] neg_hi:[0,0,1]
  v_pk_fma_f32 v[166:167], v[126:127], s[60:61], v[252:253] op_sel_hi:[1,1,0] neg_lo:[1,0,0] neg_hi:[1,0,0]
  v_exp_f32 v128, v128
  v_exp_f32 v129, v129
  v_mfma_f32_16x16x32_bf16 v[108:111], v[32:35], v[78:81], 0
  s_add_u32 s4, s20, 0
  v_exp_f32 v130, v130
  v_exp_f32 v131, v131
  v_mfma_f32_16x16x32_bf16 v[112:115], v[40:43], v[78:81], 0
  buffer_load_dwordx4 v[208:211], v20, s[48:51], s4 offen offset:0 sc1
  v_exp_f32 v132, v132
  v_exp_f32 v133, v133
  v_mfma_f32_16x16x32_bf16 v[116:119], v[48:51], v[78:81], 0
  buffer_load_dwordx4 v[212:215], v20, s[48:51], s4 offen offset:1024 sc1
  v_exp_f32 v134, v134
  v_exp_f32 v135, v135
  v_mfma_f32_16x16x32_bf16 v[120:123], v[56:59], v[78:81], 0
  buffer_load_dwordx4 v[216:219], v20, s[48:51], s4 offen offset:2048 sc1
  v_exp_f32 v136, v136
  v_exp_f32 v137, v137
  v_mfma_f32_16x16x32_bf16 v[124:127], v[64:67], v[78:81], 0
  buffer_load_dwordx4 v[220:223], v20, s[48:51], s4 offen offset:3072 sc1
  v_exp_f32 v138, v138
  v_exp_f32 v139, v139
  v_mfma_f32_16x16x32_bf16 v[108:111], v[36:39], v[82:85], v[108:111]
  buffer_load_dwordx4 v[224:227], v21, s[48:51], s4 offen sc1
  v_exp_f32 v140, v140
  v_exp_f32 v141, v141
  v_mfma_f32_16x16x32_bf16 v[112:115], v[44:47], v[82:85], v[112:115]
  s_add_u32 s4, s20, 163840
  v_exp_f32 v142, v142
  v_exp_f32 v143, v143
  v_mfma_f32_16x16x32_bf16 v[116:119], v[52:55], v[82:85], v[116:119]
  buffer_load_dwordx4 v[228:231], v20, s[48:51], s4 offen offset:0 sc1
  v_exp_f32 v144, v144
  v_exp_f32 v145, v145
  v_mfma_f32_16x16x32_bf16 v[120:123], v[60:63], v[82:85], v[120:123]
  buffer_load_dwordx4 v[232:235], v20, s[48:51], s4 offen offset:1024 sc1
  v_exp_f32 v146, v146
  v_exp_f32 v147, v147
  v_mfma_f32_16x16x32_bf16 v[124:127], v[196:199], v[82:85], v[124:127]
  buffer_load_dwordx4 v[236:239], v20, s[48:51], s4 offen offset:2048 sc1
  v_exp_f32 v148, v148
  v_exp_f32 v149, v149
  v_mfma_f32_16x16x16_bf16 v[108:111], v[200:201], v[86:87], v[108:111]
  buffer_load_dwordx4 v[240:243], v20, s[48:51], s4 offen offset:3072 sc1
  v_exp_f32 v150, v150
  v_exp_f32 v151, v151
  v_mfma_f32_16x16x16_bf16 v[112:115], v[202:203], v[86:87], v[112:115]
  buffer_load_dwordx4 v[244:247], v21, s[48:51], s4 offen sc1
  v_exp_f32 v152, v152
  v_exp_f32 v153, v153
  v_mfma_f32_16x16x16_bf16 v[116:119], v[204:205], v[86:87], v[116:119]
  v_exp_f32 v154, v154
  v_exp_f32 v155, v155
  v_mfma_f32_16x16x16_bf16 v[120:123], v[206:207], v[86:87], v[120:123]
  v_exp_f32 v156, v156
  v_exp_f32 v157, v157
  v_mfma_f32_16x16x16_bf16 v[124:127], v[248:249], v[86:87], v[124:127]
  v_exp_f32 v158, v158
  v_exp_f32 v159, v159
  s_waitcnt lgkmcnt(0)
  v_exp_f32 v160, v160
  v_exp_f32 v161, v161
  v_exp_f32 v162, v162
  v_exp_f32 v163, v163
  v_exp_f32 v164, v164
  v_exp_f32 v165, v165
  v_exp_f32 v166, v166
  v_exp_f32 v167, v167
  v_pk_add_f32 v[188:189], v[128:129], v[130:131]
  v_pk_add_f32 v[190:191], v[148:149], v[150:151]
  v_pk_add_f32 v[188:189], v[188:189], v[132:133]
  v_pk_add_f32 v[190:191], v[190:191], v[152:153]
  v_pk_add_f32 v[188:189], v[188:189], v[134:135]
  v_pk_add_f32 v[190:191], v[190:191], v[154:155]
  v_pk_add_f32 v[188:189], v[188:189], v[136:137]
  v_pk_add_f32 v[190:191], v[190:191], v[156:157]
  v_pk_add_f32 v[188:189], v[188:189], v[138:139]
  v_pk_add_f32 v[190:191], v[190:191], v[158:159]
  v_pk_add_f32 v[188:189], v[188:189], v[140:141]
  v_pk_add_f32 v[190:191], v[190:191], v[160:161]
  v_pk_add_f32 v[188:189], v[188:189], v[142:143]
  v_pk_add_f32 v[190:191], v[190:191], v[162:163]
  v_pk_add_f32 v[188:189], v[188:189], v[144:145]
  v_pk_add_f32 v[190:191], v[190:191], v[164:165]
  v_pk_add_f32 v[188:189], v[188:189], v[146:147]
  v_pk_add_f32 v[190:191], v[190:191], v[166:167]
  v_add_f32 v188, v188, v189
  v_add_f32 v190, v190, v191
  v_rcp_f32 v188, v188
  v_rcp_f32 v190, v190
  v_pk_mul_f32 v[128:129], v[128:129], v[188:189] op_sel_hi:[1,0]
  v_pk_mul_f32 v[148:149], v[148:149], v[190:191] op_sel_hi:[1,0]
  v_pk_mul_f32 v[130:131], v[130:131], v[188:189] op_sel_hi:[1,0]
  v_pk_mul_f32 v[150:151], v[150:151], v[190:191] op_sel_hi:[1,0]
  v_pk_mul_f32 v[132:133], v[132:133], v[188:189] op_sel_hi:[1,0]
  v_pk_mul_f32 v[152:153], v[152:153], v[190:191] op_sel_hi:[1,0]
  v_pk_mul_f32 v[134:135], v[134:135], v[188:189] op_sel_hi:[1,0]
  v_pk_mul_f32 v[154:155], v[154:155], v[190:191] op_sel_hi:[1,0]
  v_pk_mul_f32 v[136:137], v[136:137], v[188:189] op_sel_hi:[1,0]
  v_pk_mul_f32 v[156:157], v[156:157], v[190:191] op_sel_hi:[1,0]
  v_pk_mul_f32 v[138:139], v[138:139], v[188:189] op_sel_hi:[1,0]
  v_pk_mul_f32 v[158:159], v[158:159], v[190:191] op_sel_hi:[1,0]
  v_pk_mul_f32 v[140:141], v[140:141], v[188:189] op_sel_hi:[1,0]
  v_pk_mul_f32 v[160:161], v[160:161], v[190:191] op_sel_hi:[1,0]
  v_pk_mul_f32 v[142:143], v[142:143], v[188:189] op_sel_hi:[1,0]
  v_pk_mul_f32 v[162:163], v[162:163], v[190:191] op_sel_hi:[1,0]
  v_pk_mul_f32 v[144:145], v[144:145], v[188:189] op_sel_hi:[1,0]
  v_pk_mul_f32 v[164:165], v[164:165], v[190:191] op_sel_hi:[1,0]
  v_pk_mul_f32 v[146:147], v[146:147], v[188:189] op_sel_hi:[1,0]
  v_pk_mul_f32 v[166:167], v[166:167], v[190:191] op_sel_hi:[1,0]
  v_cvt_pk_bf16_f32 v168, v128, v129
  v_cvt_pk_bf16_f32 v169, v130, v131
  v_cvt_pk_bf16_f32 v170, v132, v133
  v_cvt_pk_bf16_f32 v171, v134, v135
  v_cvt_pk_bf16_f32 v172, v136, v137
  v_cvt_pk_bf16_f32 v173, v138, v139
  v_cvt_pk_bf16_f32 v174, v140, v141
  v_cvt_pk_bf16_f32 v175, v142, v143
  v_cvt_pk_bf16_f32 v176, v144, v145
  v_cvt_pk_bf16_f32 v177, v146, v147
  v_cvt_pk_bf16_f32 v178, v148, v149
  v_cvt_pk_bf16_f32 v179, v150, v151
  v_cvt_pk_bf16_f32 v180, v152, v153
  v_cvt_pk_bf16_f32 v181, v154, v155
  v_cvt_pk_bf16_f32 v182, v156, v157
  v_cvt_pk_bf16_f32 v183, v158, v159
  v_cvt_pk_bf16_f32 v184, v160, v161
  v_cvt_pk_bf16_f32 v185, v162, v163
  v_cvt_pk_bf16_f32 v186, v164, v165
  v_cvt_pk_bf16_f32 v187, v166, v167
  ds_write_b128 v6, v[168:171] offset:0
  ds_write_b128 v6, v[172:175] offset:16
  ds_write_b128 v6, v[176:179] offset:32
  ds_write_b128 v6, v[180:183] offset:48
  ds_write_b128 v6, v[184:187] offset:64
  v_max3_f32 v250, v108, v109, v110
  v_min3_f32 v252, v108, v109, v110
  v_max3_f32 v250, v250, v111, v112
  v_min3_f32 v252, v252, v111, v112
  v_max3_f32 v250, v250, v113, v114
  v_min3_f32 v252, v252, v113, v114
  v_max3_f32 v250, v250, v115, v116
  v_min3_f32 v252, v252, v115, v116
  v_max3_f32 v250, v250, v117, v118
  v_min3_f32 v252, v252, v117, v118
  v_max3_f32 v250, v250, v119, v120
  v_min3_f32 v252, v252, v119, v120
  v_max3_f32 v250, v250, v121, v122
  v_min3_f32 v252, v252, v121, v122
  v_max3_f32 v250, v250, v123, v124
  v_min3_f32 v252, v252, v123, v124
  v_max3_f32 v250, v250, v125, v126
  v_min3_f32 v252, v252, v125, v126
  v_max_f32 v250, v250, v127
  v_min_f32 v252, v252, v127
  v_mul_f32 v250, s60, v250
  v_mul_f32 v252, s60, v252
  v_pk_fma_f32 v[128:129], v[108:109], s[60:61], v[250:251] op_sel_hi:[1,1,0] neg_lo:[0,0,1] neg_hi:[0,0,1]
  v_pk_fma_f32 v[148:149], v[108:109], s[60:61], v[252:253] op_sel_hi:[1,1,0] neg_lo:[1,0,0] neg_hi:[1,0,0]
  v_pk_fma_f32 v[130:131], v[110:111], s[60:61], v[250:251] op_sel_hi:[1,1,0] neg_lo:[0,0,1] neg_hi:[0,0,1]
  v_pk_fma_f32 v[150:151], v[110:111], s[60:61], v[252:253] op_sel_hi:[1,1,0] neg_lo:[1,0,0] neg_hi:[1,0,0]
  v_pk_fma_f32 v[132:133], v[112:113], s[60:61], v[250:251] op_sel_hi:[1,1,0] neg_lo:[0,0,1] neg_hi:[0,0,1]
  v_pk_fma_f32 v[152:153], v[112:113], s[60:61], v[252:253] op_sel_hi:[1,1,0] neg_lo:[1,0,0] neg_hi:[1,0,0]
  v_pk_fma_f32 v[134:135], v[114:115], s[60:61], v[250:251] op_sel_hi:[1,1,0] neg_lo:[0,0,1] neg_hi:[0,0,1]
  v_pk_fma_f32 v[154:155], v[114:115], s[60:61], v[252:253] op_sel_hi:[1,1,0] neg_lo:[1,0,0] neg_hi:[1,0,0]
  v_pk_fma_f32 v[136:137], v[116:117], s[60:61], v[250:251] op_sel_hi:[1,1,0] neg_lo:[0,0,1] neg_hi:[0,0,1]
  v_pk_fma_f32 v[156:157], v[116:117], s[60:61], v[252:253] op_sel_hi:[1,1,0] neg_lo:[1,0,0] neg_hi:[1,0,0]
  v_pk_fma_f32 v[138:139], v[118:119], s[60:61], v[250:251] op_sel_hi:[1,1,0] neg_lo:[0,0,1] neg_hi:[0,0,1]
  v_pk_fma_f32 v[158:159], v[118:119], s[60:61], v[252:253] op_sel_hi:[1,1,0] neg_lo:[1,0,0] neg_hi:[1,0,0]
  v_pk_fma_f32 v[140:141], v[120:121], s[60:61], v[250:251] op_sel_hi:[1,1,0] neg_lo:[0,0,1] neg_hi:[0,0,1]
  v_pk_fma_f32 v[160:161], v[120:121], s[60:61], v[252:253] op_sel_hi:[1,1,0] neg_lo:[1,0,0] neg_hi:[1,0,0]
  v_pk_fma_f32 v[142:143], v[122:123], s[60:61], v[250:251] op_sel_hi:[1,1,0] neg_lo:[0,0,1] neg_hi:[0,0,1]
  v_pk_fma_f32 v[162:163], v[122:123], s[60:61], v[252:253] op_sel_hi:[1,1,0] neg_lo:[1,0,0] neg_hi:[1,0,0]
  v_pk_fma_f32 v[144:145], v[124:125], s[60:61], v[250:251] op_sel_hi:[1,1,0] neg_lo:[0,0,1] neg_hi:[0,0,1]
  v_pk_fma_f32 v[164:165], v[124:125], s[60:61], v[252:253] op_sel_hi:[1,1,0] neg_lo:[1,0,0] neg_hi:[1,0,0]
  v_pk_fma_f32 v[146:147], v[126:127], s[60:61], v[250:251] op_sel_hi:[1,1,0] neg_lo:[0,0,1] neg_hi:[0,0,1]
  v_pk_fma_f32 v[166:167], v[126:127], s[60:61], v[252:253] op_sel_hi:[1,1,0] neg_lo:[1,0,0] neg_hi:[1,0,0]
  v_exp_f32 v128, v128
  v_exp_f32 v129, v129
  s_add_u32 s4, s20, 327680
  v_exp_f32 v130, v130
  v_exp_f32 v131, v131
  buffer_load_dwordx4 v[32:35], v20, s[48:51], s4 offen offset:0 sc1
  v_exp_f32 v132, v132
  v_exp_f32 v133, v133
  buffer_load_dwordx4 v[36:39], v20, s[48:51], s4 offen offset:1024 sc1
  v_exp_f32 v134, v134
  v_exp_f32 v135, v135
  buffer_load_dwordx4 v[40:43], v20, s[48:51], s4 offen offset:2048 sc1
  v_exp_f32 v136, v136
  v_exp_f32 v137, v137
  buffer_load_dwordx4 v[44:47], v20, s[48:51], s4 offen offset:3072 sc1
  v_exp_f32 v138, v138
  v_exp_f32 v139, v139
  buffer_load_dwordx4 v[48:51], v21, s[48:51], s4 offen sc1
  v_exp_f32 v140, v140
  v_exp_f32 v141, v141
  s_add_u32 s4, s20, 491520
  v_exp_f32 v142, v142
  v_exp_f32 v143, v143
  buffer_load_dwordx4 v[52:55], v20, s[48:51], s4 offen offset:0 sc1
  v_exp_f32 v144, v144
  v_exp_f32 v145, v145
  buffer_load_dwordx4 v[56:59], v20, s[48:51], s4 offen offset:1024 sc1
  v_exp_f32 v146, v146
  v_exp_f32 v147, v147
  buffer_load_dwordx4 v[60:63], v20, s[48:51], s4 offen offset:2048 sc1
  v_exp_f32 v148, v148
  v_exp_f32 v149, v149
  buffer_load_dwordx4 v[64:67], v20, s[48:51], s4 offen offset:3072 sc1
  v_exp_f32 v150, v150
  v_exp_f32 v151, v151
  buffer_load_dwordx4 v[68:71], v21, s[48:51], s4 offen sc1
  v_exp_f32 v152, v152
  v_exp_f32 v153, v153
  s_waitcnt lgkmcnt(0)
  v_exp_f32 v154, v154
  v_exp_f32 v155, v155
  v_exp_f32 v156, v156
  v_exp_f32 v157, v157
  v_exp_f32 v158, v158
  v_exp_f32 v159, v159
  v_exp_f32 v160, v160
  v_exp_f32 v161, v161
  v_exp_f32 v162, v162
  v_exp_f32 v163, v163
  v_exp_f32 v164, v164
  v_exp_f32 v165, v165
  v_exp_f32 v166, v166
  v_exp_f32 v167, v167
  v_pk_add_f32 v[188:189], v[128:129], v[130:131]
  v_pk_add_f32 v[190:191], v[148:149], v[150:151]
  v_pk_add_f32 v[188:189], v[188:189], v[132:133]
  v_pk_add_f32 v[190:191], v[190:191], v[152:153]
  v_pk_add_f32 v[188:189], v[188:189], v[134:135]
  v_pk_add_f32 v[190:191], v[190:191], v[154:155]
  v_pk_add_f32 v[188:189], v[188:189], v[136:137]
  v_pk_add_f32 v[190:191], v[190:191], v[156:157]
  v_pk_add_f32 v[188:189], v[188:189], v[138:139]
  v_pk_add_f32 v[190:191], v[190:191], v[158:159]
  v_pk_add_f32 v[188:189], v[188:189], v[140:141]
  v_pk_add_f32 v[190:191], v[190:191], v[160:161]
  v_pk_add_f32 v[188:189], v[188:189], v[142:143]
  v_pk_add_f32 v[190:191], v[190:191], v[162:163]
  v_pk_add_f32 v[188:189], v[188:189], v[144:145]
  v_pk_add_f32 v[190:191], v[190:191], v[164:165]
  v_pk_add_f32 v[188:189], v[188:189], v[146:147]
  v_pk_add_f32 v[190:191], v[190:191], v[166:167]
  v_add_f32 v188, v188, v189
  v_add_f32 v190, v190, v191
  v_rcp_f32 v188, v188
  v_rcp_f32 v190, v190
  v_pk_mul_f32 v[128:129], v[128:129], v[188:189] op_sel_hi:[1,0]
  v_pk_mul_f32 v[148:149], v[148:149], v[190:191] op_sel_hi:[1,0]
  v_pk_mul_f32 v[130:131], v[130:131], v[188:189] op_sel_hi:[1,0]
  v_pk_mul_f32 v[150:151], v[150:151], v[190:191] op_sel_hi:[1,0]
  v_pk_mul_f32 v[132:133], v[132:133], v[188:189] op_sel_hi:[1,0]
  v_pk_mul_f32 v[152:153], v[152:153], v[190:191] op_sel_hi:[1,0]
  v_pk_mul_f32 v[134:135], v[134:135], v[188:189] op_sel_hi:[1,0]
  v_pk_mul_f32 v[154:155], v[154:155], v[190:191] op_sel_hi:[1,0]
  v_pk_mul_f32 v[136:137], v[136:137], v[188:189] op_sel_hi:[1,0]
  v_pk_mul_f32 v[156:157], v[156:157], v[190:191] op_sel_hi:[1,0]
  v_pk_mul_f32 v[138:139], v[138:139], v[188:189] op_sel_hi:[1,0]
  v_pk_mul_f32 v[158:159], v[158:159], v[190:191] op_sel_hi:[1,0]
  v_pk_mul_f32 v[140:141], v[140:141], v[188:189] op_sel_hi:[1,0]
  v_pk_mul_f32 v[160:161], v[160:161], v[190:191] op_sel_hi:[1,0]
  v_pk_mul_f32 v[142:143], v[142:143], v[188:189] op_sel_hi:[1,0]
  v_pk_mul_f32 v[162:163], v[162:163], v[190:191] op_sel_hi:[1,0]
  v_pk_mul_f32 v[144:145], v[144:145], v[188:189] op_sel_hi:[1,0]
  v_pk_mul_f32 v[164:165], v[164:165], v[190:191] op_sel_hi:[1,0]
  v_pk_mul_f32 v[146:147], v[146:147], v[188:189] op_sel_hi:[1,0]
  v_pk_mul_f32 v[166:167], v[166:167], v[190:191] op_sel_hi:[1,0]
  v_cvt_pk_bf16_f32 v168, v128, v129
  v_cvt_pk_bf16_f32 v169, v130, v131
  v_cvt_pk_bf16_f32 v170, v132, v133
  v_cvt_pk_bf16_f32 v171, v134, v135
  v_cvt_pk_bf16_f32 v172, v136, v137
  v_cvt_pk_bf16_f32 v173, v138, v139
  v_cvt_pk_bf16_f32 v174, v140, v141
  v_cvt_pk_bf16_f32 v175, v142, v143
  v_cvt_pk_bf16_f32 v176, v144, v145
  v_cvt_pk_bf16_f32 v177, v146, v147
  v_cvt_pk_bf16_f32 v178, v148, v149
  v_cvt_pk_bf16_f32 v179, v150, v151
  v_cvt_pk_bf16_f32 v180, v152, v153
  v_cvt_pk_bf16_f32 v181, v154, v155
  v_cvt_pk_bf16_f32 v182, v156, v157
  v_cvt_pk_bf16_f32 v183, v158, v159
  v_cvt_pk_bf16_f32 v184, v160, v161
  v_cvt_pk_bf16_f32 v185, v162, v163
  v_cvt_pk_bf16_f32 v186, v164, v165
  v_cvt_pk_bf16_f32 v187, v166, v167
  ds_write_b128 v6, v[168:171] offset:5632
  ds_write_b128 v6, v[172:175] offset:5648
  ds_write_b128 v6, v[176:179] offset:5664
  ds_write_b128 v6, v[180:183] offset:5680
  ds_write_b128 v6, v[184:187] offset:5696
  v_lshl_add_u32 v2, v7, 2, v8
  v_mul_u32_u24 v3, 352, v2
  s_mul_i32 s67, s71, 80
  v_lshl_add_u32 v3, v9, 3, v3
  v_add_u32 v3, s67, v3
  v_add_u32 v4, 45056, v3
  v_mul_u32_u24 v2, 176, v2
  s_mul_i32 s67, s71, 40
  s_mul_i32 s68, s72, 24
  s_add_u32 s67, s67, s68
  v_lshl_add_u32 v5, v9, 3, s67
  v_mul_u32_u24 v6, s72, v9
  v_cmp_lt_u32 vcc, 1, v6
  v_mov_b32 v6, 160
  s_nop 0
  v_cndmask_b32 v5, v5, v6, vcc
  v_add_u32 v5, 90112, v5
  v_add_u32 v5, v2, v5
  s_waitcnt lgkmcnt(0)
  s_barrier
  s_lshl_b32 s88, s73, 7
  s_add_u32 s88, s88, 19079168
  v_mov_b32 v29, 1
  v_mov_b32 v11, 0
  s_cmp_lg_u32 s3, 7
  s_cbranch_scc1 KH1
  s_mov_b64 exec, 1
  buffer_atomic_add v29, v11, s[48:51], s88 offen sc0 sc1
  s_mov_b64 exec, -1
KH1:
  v_mov_b32 v31, 0
  buffer_load_dword v31, v31, s[48:51], s78 offen offset:4 sc1
  ds_read_b64_tr_b16 v[84:85], v5 offset:0
  ds_read_b64_tr_b16 v[86:87], v5 offset:2816
  ds_read_b64_tr_b16 v[72:73], v3 offset:0
  ds_read_b64_tr_b16 v[74:75], v3 offset:5632
  ds_read_b64_tr_b16 v[76:77], v3 offset:32
  ds_read_b64_tr_b16 v[78:79], v3 offset:5664
  ds_read_b64_tr_b16 v[80:81], v3 offset:64
  ds_read_b64_tr_b16 v[82:83], v3 offset:5696
  ds_read_b64_tr_b16 v[100:101], v5 offset:5632
  ds_read_b64_tr_b16 v[102:103], v5 offset:8448
  ds_read_b64_tr_b16 v[88:89], v3 offset:11264
  ds_read_b64_tr_b16 v[90:91], v3 offset:16896
  ds_read_b64_tr_b16 v[92:93], v3 offset:11296
  ds_read_b64_tr_b16 v[94:95], v3 offset:16928
  ds_read_b64_tr_b16 v[96:97], v3 offset:11328
  ds_read_b64_tr_b16 v[98:99], v3 offset:16960
  s_waitcnt lgkmcnt(12)
  v_mfma_f32_16x16x32_bf16 v[128:131], v[72:75], v[84:87], 0
  ds_read_b64_tr_b16 v[116:117], v5 offset:11264
  ds_read_b64_tr_b16 v[118:119], v5 offset:14080
  s_waitcnt lgkmcnt(12)
  v_mfma_f32_16x16x32_bf16 v[132:135], v[76:79], v[84:87], 0
  ds_read_b64_tr_b16 v[104:105], v3 offset:22528
  ds_read_b64_tr_b16 v[106:107], v3 offset:28160
  s_waitcnt lgkmcnt(12)
  v_mfma_f32_16x16x32_bf16 v[136:139], v[80:83], v[84:87], 0
  ds_read_b64_tr_b16 v[108:109], v3 offset:22560
  ds_read_b64_tr_b16 v[110:111], v3 offset:28192
  ds_read_b64_tr_b16 v[112:113], v3 offset:22592
  ds_read_b64_tr_b16 v[114:115], v3 offset:28224
  s_waitcnt lgkmcnt(12)
  v_mfma_f32_16x16x32_bf16 v[128:131], v[88:91], v[100:103], v[128:131]
  ds_read_b64_tr_b16 v[84:85], v5 offset:16896
  ds_read_b64_tr_b16 v[86:87], v5 offset:19712
  s_waitcnt lgkmcnt(12)
  v_mfma_f32_16x16x32_bf16 v[132:135], v[92:95], v[100:103], v[132:135]
  ds_read_b64_tr_b16 v[72:73], v3 offset:33792
  ds_read_b64_tr_b16 v[74:75], v3 offset:39424
  s_waitcnt lgkmcnt(12)
  v_mfma_f32_16x16x32_bf16 v[136:139], v[96:99], v[100:103], v[136:139]
  ds_read_b64_tr_b16 v[76:77], v3 offset:33824
  ds_read_b64_tr_b16 v[78:79], v3 offset:39456
  ds_read_b64_tr_b16 v[80:81], v3 offset:33856
  ds_read_b64_tr_b16 v[82:83], v3 offset:39488
  s_waitcnt lgkmcnt(12)
  v_mfma_f32_16x16x32_bf16 v[128:131], v[104:107], v[116:119], v[128:131]
  ds_read_b64_tr_b16 v[100:101], v5 offset:22528
  ds_read_b64_tr_b16 v[102:103], v5 offset:25344
  s_waitcnt lgkmcnt(12)
  v_mfma_f32_16x16x32_bf16 v[132:135], v[108:111], v[116:119], v[132:135]
  ds_read_b64_tr_b16 v[88:89], v4 offset:0
  ds_read_b64_tr_b16 v[90:91], v4 offset:5632
  s_waitcnt lgkmcnt(12)
  v_mfma_f32_16x16x32_bf16 v[136:139], v[112:115], v[116:119], v[136:139]
  ds_read_b64_tr_b16 v[92:93], v4 offset:32
  ds_read_b64_tr_b16 v[94:95], v4 offset:5664
  ds_read_b64_tr_b16 v[96:97], v4 offset:64
  ds_read_b64_tr_b16 v[98:99], v4 offset:5696
  s_waitcnt lgkmcnt(12)
  v_mfma_f32_16x16x32_bf16 v[128:131], v[72:75], v[84:87], v[128:131]
  ds_read_b64_tr_b16 v[116:117], v5 offset:28160
  ds_read_b64_tr_b16 v[118:119], v5 offset:30976
  s_waitcnt lgkmcnt(12)
  v_mfma_f32_16x16x32_bf16 v[132:135], v[76:79], v[84:87], v[132:135]
  ds_read_b64_tr_b16 v[104:105], v4 offset:11264
  ds_read_b64_tr_b16 v[106:107], v4 offset:16896
  s_waitcnt lgkmcnt(12)
  v_mfma_f32_16x16x32_bf16 v[136:139], v[80:83], v[84:87], v[136:139]
  ds_read_b64_tr_b16 v[108:109], v4 offset:11296
  ds_read_b64_tr_b16 v[110:111], v4 offset:16928
  ds_read_b64_tr_b16 v[112:113], v4 offset:11328
  ds_read_b64_tr_b16 v[114:115], v4 offset:16960
  s_waitcnt lgkmcnt(12)
  v_mfma_f32_16x16x32_bf16 v[128:131], v[88:91], v[100:103], v[128:131]
  ds_read_b64_tr_b16 v[84:85], v5 offset:33792
  ds_read_b64_tr_b16 v[86:87], v5 offset:36608
  s_waitcnt lgkmcnt(12)
  v_mfma_f32_16x16x32_bf16 v[132:135], v[92:95], v[100:103], v[132:135]
  ds_read_b64_tr_b16 v[72:73], v4 offset:22528
  ds_read_b64_tr_b16 v[74:75], v4 offset:28160
  s_waitcnt lgkmcnt(12)
  v_mfma_f32_16x16x32_bf16 v[136:139], v[96:99], v[100:103], v[136:139]
  ds_read_b64_tr_b16 v[76:77], v4 offset:22560
  ds_read_b64_tr_b16 v[78:79], v4 offset:28192
  ds_read_b64_tr_b16 v[80:81], v4 offset:22592
  ds_read_b64_tr_b16 v[82:83], v4 offset:28224
  s_waitcnt lgkmcnt(12)
  v_mfma_f32_16x16x32_bf16 v[128:131], v[104:107], v[116:119], v[128:131]
  ds_read_b64_tr_b16 v[100:101], v5 offset:39424
  ds_read_b64_tr_b16 v[102:103], v5 offset:42240
  s_waitcnt lgkmcnt(12)
  v_mfma_f32_16x16x32_bf16 v[132:135], v[108:111], v[116:119], v[132:135]
  ds_read_b64_tr_b16 v[88:89], v4 offset:33792
  ds_read_b64_tr_b16 v[90:91], v4 offset:39424
  s_waitcnt lgkmcnt(12)
  v_mfma_f32_16x16x32_bf16 v[136:139], v[112:115], v[116:119], v[136:139]
  ds_read_b64_tr_b16 v[92:93], v4 offset:33824
  ds_read_b64_tr_b16 v[94:95], v4 offset:39456
  ds_read_b64_tr_b16 v[96:97], v4 offset:33856
  ds_read_b64_tr_b16 v[98:99], v4 offset:39488
  s_waitcnt lgkmcnt(12)
  v_mfma_f32_16x16x32_bf16 v[128:131], v[72:75], v[84:87], v[128:131]
  s_waitcnt lgkmcnt(10)
  v_mfma_f32_16x16x32_bf16 v[132:135], v[76:79], v[84:87], v[132:135]
  s_waitcnt lgkmcnt(8)
  v_mfma_f32_16x16x32_bf16 v[136:139], v[80:83], v[84:87], v[136:139]
  s_waitcnt lgkmcnt(4)
  v_mfma_f32_16x16x32_bf16 v[128:131], v[88:91], v[100:103], v[128:131]
  s_waitcnt lgkmcnt(2)
  v_mfma_f32_16x16x32_bf16 v[132:135], v[92:95], v[100:103], v[132:135]
  s_waitcnt lgkmcnt(0)
  v_mfma_f32_16x16x32_bf16 v[136:139], v[96:99], v[100:103], v[136:139]
  s_add_u32 s67, s82, s71
  s_lshl_b32 s67, s67, 1
  s_add_u32 s67, s67, s72
  s_mul_i32 s67, s67, 3072
  s_add_u32 s67, s67, 18874368
  s_cmp_lg_u32 s3, 7
  s_cbranch_scc1 KH2
  s_waitcnt vmcnt(0)
  v_cmp_eq_u32 vcc, 7, v29
  s_add_u32 s4, s88, 4096
  s_and_b64 exec, vcc, 1
  buffer_store_dword v29, v11, s[48:51], s4 offen sc1
  s_mov_b64 exec, -1
KH2:
  v_lshlrev_b32 v4, 2, v0
  v_cmp_eq_u32 vcc, 15, v10
  s_nop 1
  v_cndmask_b32 v128, v128, 1.0, vcc
  v_cndmask_b32 v129, v129, 1.0, vcc
  v_cndmask_b32 v130, v130, 1.0, vcc
  v_cndmask_b32 v131, v131, 1.0, vcc
  v_cndmask_b32 v132, v132, 1.0, vcc
  v_cndmask_b32 v133, v133, 1.0, vcc
  v_cndmask_b32 v134, v134, 1.0, vcc
  v_cndmask_b32 v135, v135, 1.0, vcc
  v_cndmask_b32 v136, v136, 1.0, vcc
  v_cndmask_b32 v137, v137, 1.0, vcc
  v_cndmask_b32 v138, v138, 1.0, vcc
  v_cndmask_b32 v139, v139, 1.0, vcc
  buffer_atomic_add_f32 v128, v4, s[48:51], s67 offen offset:0 sc1
  buffer_atomic_add_f32 v129, v4, s[48:51], s67 offen offset:256 sc1
  buffer_atomic_add_f32 v130, v4, s[48:51], s67 offen offset:512 sc1
  buffer_atomic_add_f32 v131, v4, s[48:51], s67 offen offset:768 sc1
  buffer_atomic_add_f32 v132, v4, s[48:51], s67 offen offset:1024 sc1
  buffer_atomic_add_f32 v133, v4, s[48:51], s67 offen offset:1280 sc1
  buffer_atomic_add_f32 v134, v4, s[48:51], s67 offen offset:1536 sc1
  buffer_atomic_add_f32 v135, v4, s[48:51], s67 offen offset:1792 sc1
  s_mov_b32 exec_hi, 0
  buffer_atomic_add_f32 v136, v4, s[48:51], s67 offen offset:2048 sc1
  buffer_atomic_add_f32 v137, v4, s[48:51], s67 offen offset:2304 sc1
  buffer_atomic_add_f32 v138, v4, s[48:51], s67 offen offset:2560 sc1
  buffer_atomic_add_f32 v139, v4, s[48:51], s67 offen offset:2816 sc1
  s_mov_b32 exec_hi, -1
  s_waitcnt vmcnt(12)
  s_mov_b32 s7, -1
  s_mov_b32 s8, 4
  s_branch P2
INITOK_19o:
  s_mov_b32 s89, 0x80000
POLL_1020:
  v_mov_b32 v29, 0
  buffer_load_dword v29, v29, s[84:87], 0 offen offset:128 sc1
  s_waitcnt vmcnt(0)
  v_readfirstlane_b32 s14, v29
  s_nop 0
  s_cmp_lg_u32 s14, 0
  s_cbranch_scc1 POLLD_1021
  s_sleep 2
  s_sub_u32 s89, s89, 1
  s_cbranch_scc0 POLL_1020
POLLD_1021:
  s_branch INITOK_19
R_SPARE:
  s_mul_i32 s4, s95, 2
  s_add_u32 s4, s4, s101
  v_add_u32 v21, s4, v23
  s_mov_b64 exec, 0xff
  buffer_load_dword v19, v21, s[96:99], 0 offen
  s_mov_b64 exec, -1
  s_mov_b32 s52, s30
  s_and_b32 s53, s31, 0xffff
  s_mov_b32 s54, 2211840
  s_mov_b32 s55, 0x20000
  s_mov_b32 s56, s22
  s_and_b32 s57, s23, 0xffff
  s_mov_b32 s58, 819200
  s_mov_b32 s59, 0x20000
  s_lshr_b32 s77, s67, 1
  s_lshl_b32 s77, s77, 3
  s_add_u32 s77, s77, s63
  s_lshl_b32 s67, s3, 2
  s_mul_i32 s68, s3, 20
  v_add_u32 v2, 0, v0
  v_mul_u32_u24 v3, 205, v2
  v_lshrrev_b32 v3, 14, v3
  v_mul_u32_u24 v4, 80, v3
  v_sub_u32 v4, v2, v4
  v_add_u32 v3, s67, v3
  v_and_b32 v5, 7, v3
  v_lshlrev_b32 v5, 1, v5
  v_xor_b32 v4, v4, v5
  v_mul_u32_u24 v3, 1280, v3
  v_lshl_add_u32 v176, v4, 4, v3
  v_add_u32 v2, 64, v0
  v_mul_u32_u24 v3, 205, v2
  v_lshrrev_b32 v3, 14, v3
  v_mul_u32_u24 v4, 80, v3
  v_sub_u32 v4, v2, v4
  v_add_u32 v3, s67, v3
  v_and_b32 v5, 7, v3
  v_lshlrev_b32 v5, 1, v5
  v_xor_b32 v4, v4, v5
  v_mul_u32_u24 v3, 1280, v3
  v_lshl_add_u32 v177, v4, 4, v3
  v_subrev_u32 v177, 1024, v177
  v_add_u32 v2, 128, v0
  v_mul_u32_u24 v3, 205, v2
  v_lshrrev_b32 v3, 14, v3
  v_mul_u32_u24 v4, 80, v3
  v_sub_u32 v4, v2, v4
  v_add_u32 v3, s67, v3
  v_and_b32 v5, 7, v3
  v_lshlrev_b32 v5, 1, v5
  v_xor_b32 v4, v4, v5
  v_mul_u32_u24 v3, 1280, v3
  v_lshl_add_u32 v178, v4, 4, v3
  v_subrev_u32 v178, 2048, v178
  v_add_u32 v2, 192, v0
  v_mul_u32_u24 v3, 205, v2
  v_lshrrev_b32 v3, 14, v3
  v_mul_u32_u24 v4, 80, v3
  v_sub_u32 v4, v2, v4
  v_add_u32 v3, s67, v3
  v_and_b32 v5, 7, v3
  v_lshlrev_b32 v5, 1, v5
  v_xor_b32 v4, v4, v5
  v_mul_u32_u24 v3, 1280, v3
  v_lshl_add_u32 v179, v4, 4, v3
  v_subrev_u32 v179, 3072, v179
  v_add_u32 v2, 256, v0
  v_mul_u32_u24 v3, 205, v2
  v_lshrrev_b32 v3, 14, v3
  v_mul_u32_u24 v4, 80, v3
  v_sub_u32 v4, v2, v4
  v_add_u32 v3, s67, v3
  v_and_b32 v5, 7, v3
  v_lshlrev_b32 v5, 1, v5
  v_xor_b32 v4, v4, v5
  v_mul_u32_u24 v3, 1280, v3
  v_lshl_add_u32 v180, v4, 4, v3
  s_mul_i32 s66, s3, 5120
  s_add_u32 s78, s77, 0
  s_mul_i32 s79, s78, 40960
  s_add_u32 m0, s66, 0
  s_nop 0
  buffer_load_dwordx4 v176, s[52:55], s79 offen offset:0 nt lds
  buffer_load_dwordx4 v177, s[52:55], s79 offen offset:1024 nt lds
  buffer_load_dwordx4 v178, s[52:55], s79 offen offset:2048 nt lds
  buffer_load_dwordx4 v179, s[52:55], s79 offen offset:3072 nt lds
  s_add_u32 m0, s66, 4096
  s_nop 0
  buffer_load_dwordx4 v180, s[52:55], s79 offen nt lds
  s_add_u32 s78, s77, 16
  s_mul_i32 s79, s78, 40960
  s_add_u32 m0, s66, 40960
  s_nop 0
  buffer_load_dwordx4 v176, s[52:55], s79 offen offset:0 nt lds
  buffer_load_dwordx4 v177, s[52:55], s79 offen offset:1024 nt lds
  buffer_load_dwordx4 v178, s[52:55], s79 offen offset:2048 nt lds
  buffer_load_dwordx4 v179, s[52:55], s79 offen offset:3072 nt lds
  s_add_u32 m0, s66, 45056
  s_nop 0
  buffer_load_dwordx4 v180, s[52:55], s79 offen nt lds
  s_add_u32 s78, s77, 32
  s_mul_i32 s79, s78, 40960
  s_add_u32 m0, s66, 81920
  s_nop 0
  buffer_load_dwordx4 v176, s[52:55], s79 offen offset:0 nt lds
  buffer_load_dwordx4 v177, s[52:55], s79 offen offset:1024 nt lds
  buffer_load_dwordx4 v178, s[52:55], s79 offen offset:2048 nt lds
  buffer_load_dwordx4 v179, s[52:55], s79 offen offset:3072 nt lds
  s_add_u32 m0, s66, 86016
  s_nop 0
  buffer_load_dwordx4 v180, s[52:55], s79 offen nt lds
  v_lshlrev_b32 v2, 4, v1
  v_mov_b32 v236, 0
  v_mov_b32 v237, 0
  v_mov_b32 v238, 0
  v_mov_b32 v239, 0
  s_mul_i32 s69, s77, 13568
  s_add_u32 s69, s69, 18874368
  buffer_store_dwordx4 v[236:239], v2, s[48:51], s69 offen sc1
  s_add_u32 s69, s69, 5376
  buffer_store_dwordx4 v[236:239], v2, s[48:51], s69 offen sc1
  v_add_u32 v3, 0, v7
  v_add_u32 v3, s68, v3
  v_and_b32 v5, 7, v3
  v_lshlrev_b32 v5, 1, v5
  v_xor_b32 v4, v10, v5
  v_mul_u32_u24 v3, 1280, v3
  v_lshl_add_u32 v181, v4, 4, v3
  v_add_u32 v3, 4, v7
  v_add_u32 v3, s68, v3
  v_and_b32 v5, 7, v3
  v_lshlrev_b32 v5, 1, v5
  v_xor_b32 v4, v10, v5
  v_mul_u32_u24 v3, 1280, v3
  v_lshl_add_u32 v182, v4, 4, v3
  v_subrev_u32 v182, 1024, v182
  v_add_u32 v3, 8, v7
  v_add_u32 v3, s68, v3
  v_and_b32 v5, 7, v3
  v_lshlrev_b32 v5, 1, v5
  v_xor_b32 v4, v10, v5
  v_mul_u32_u24 v3, 1280, v3
  v_lshl_add_u32 v183, v4, 4, v3
  v_subrev_u32 v183, 2048, v183
  v_add_u32 v3, 12, v7
  v_add_u32 v3, s68, v3
  v_and_b32 v5, 7, v3
  v_lshlrev_b32 v5, 1, v5
  v_xor_b32 v4, v10, v5
  v_mul_u32_u24 v3, 1280, v3
  v_lshl_add_u32 v184, v4, 4, v3
  v_subrev_u32 v184, 3072, v184
  v_add_u32 v3, 16, v7
  v_add_u32 v3, s68, v3
  v_and_b32 v5, 7, v3
  v_lshlrev_b32 v5, 1, v5
  v_xor_b32 v4, v10, v5
  v_mul_u32_u24 v3, 1280, v3
  v_lshl_add_u32 v185, v4, 4, v3
  v_lshl_add_u32 v2, v7, 2, v8
  v_and_b32 v3, 7, v2
  v_lshlrev_b32 v3, 1, v3
  v_mul_u32_u24 v2, 1280, v2
  v_and_b32 v4, 1, v9
  v_lshl_add_u32 v2, v4, 3, v2
  v_lshrrev_b32 v5, 1, v9
  s_mul_i32 s67, s3, 10
  v_add_u32 v6, s67, v5
  v_add_u32 v186, 0, v6
  v_xor_b32 v186, v186, v3
  v_lshl_add_u32 v186, v186, 4, v2
  v_add_u32 v187, 2, v6
  v_xor_b32 v187, v187, v3
  v_lshl_add_u32 v187, v187, 4, v2
  v_add_u32 v188, 4, v6
  v_xor_b32 v188, v188, v3
  v_lshl_add_u32 v188, v188, 4, v2
  v_add_u32 v189, 6, v6
  v_xor_b32 v189, v189, v3
  v_lshl_add_u32 v189, v189, 4, v2
  v_add_u32 v190, 8, v6
  v_xor_b32 v190, v190, v3
  v_lshl_add_u32 v190, v190, 4, v2
  v_mul_u32_u24 v2, 20, v7
  v_add_u32 v2, v2, v8
  v_lshlrev_b32 v2, 8, v2
  v_lshl_add_u32 v2, v4, 3, v2
  s_lshl_b32 s67, s3, 1
  v_add_u32 v6, s67, v5
  v_xor_b32 v6, v6, v3
  v_lshl_add_u32 v191, v6, 4, v2
  v_xor_b32 v192, 128, v191
  v_lshlrev_b32 v193, 4, v0
  v_add_u32 v194, 4096, v193
  s_waitcnt vmcnt(12)
  s_barrier
  s_add_u32 s78, s77, 0
  v_add_u32 v2, 0, v186
  ds_read_b64_tr_b16 v[196:197], v2 offset:0
  ds_read_b64_tr_b16 v[198:199], v2 offset:20480
  v_add_u32 v2, 0, v187
  ds_read_b64_tr_b16 v[200:201], v2 offset:0
  ds_read_b64_tr_b16 v[202:203], v2 offset:20480
  v_add_u32 v2, 0, v188
  ds_read_b64_tr_b16 v[204:205], v2 offset:0
  ds_read_b64_tr_b16 v[206:207], v2 offset:20480
  v_add_u32 v2, 0, v189
  ds_read_b64_tr_b16 v[208:209], v2 offset:0
  ds_read_b64_tr_b16 v[210:211], v2 offset:20480
  v_add_u32 v2, 0, v190
  ds_read_b64_tr_b16 v[212:213], v2 offset:0
  ds_read_b64_tr_b16 v[214:215], v2 offset:20480
  s_lshl3_add_u32 s80, s78, s3
  s_mul_i32 s80, s80, 5120
  s_add_u32 s80, s80, 10485760
  s_waitcnt lgkmcnt(0)
  buffer_store_dwordx4 v[196:199], v193, s[48:51], s80 offen offset:0 sc1
  buffer_store_dwordx4 v[200:203], v193, s[48:51], s80 offen offset:1024 sc1
  buffer_store_dwordx4 v[204:207], v193, s[48:51], s80 offen offset:2048 sc1
  buffer_store_dwordx4 v[208:211], v193, s[48:51], s80 offen offset:3072 sc1
  buffer_store_dwordx4 v[212:215], v194, s[48:51], s80 offen sc1
  s_waitcnt vmcnt(12)
  s_barrier
  s_add_u32 s78, s77, 16
  v_add_u32 v2, 40960, v186
  ds_read_b64_tr_b16 v[216:217], v2 offset:0
  ds_read_b64_tr_b16 v[218:219], v2 offset:20480
  v_add_u32 v2, 40960, v187
  ds_read_b64_tr_b16 v[220:221], v2 offset:0
  ds_read_b64_tr_b16 v[222:223], v2 offset:20480
  v_add_u32 v2, 40960, v188
  ds_read_b64_tr_b16 v[224:225], v2 offset:0
  ds_read_b64_tr_b16 v[226:227], v2 offset:20480
  v_add_u32 v2, 40960, v189
  ds_read_b64_tr_b16 v[228:229], v2 offset:0
  ds_read_b64_tr_b16 v[230:231], v2 offset:20480
  v_add_u32 v2, 40960, v190
  ds_read_b64_tr_b16 v[232:233], v2 offset:0
  ds_read_b64_tr_b16 v[234:235], v2 offset:20480
  s_lshl3_add_u32 s80, s78, s3
  s_mul_i32 s80, s80, 5120
  s_add_u32 s80, s80, 10485760
  s_waitcnt lgkmcnt(0)
  buffer_store_dwordx4 v[216:219], v193, s[48:51], s80 offen offset:0 sc1
  buffer_store_dwordx4 v[220:223], v193, s[48:51], s80 offen offset:1024 sc1
  buffer_store_dwordx4 v[224:227], v193, s[48:51], s80 offen offset:2048 sc1
  buffer_store_dwordx4 v[228:231], v193, s[48:51], s80 offen offset:3072 sc1
  buffer_store_dwordx4 v[232:235], v194, s[48:51], s80 offen sc1
  s_add_u32 s78, s77, 48
  s_cmp_ge_u32 s78, 54
  s_cbranch_scc1 SP_25
  s_mul_i32 s79, s78, 40960
  s_add_u32 m0, s66, 0
  s_nop 0
  buffer_load_dwordx4 v176, s[52:55], s79 offen offset:0 nt lds
  buffer_load_dwordx4 v177, s[52:55], s79 offen offset:1024 nt lds
  buffer_load_dwordx4 v178, s[52:55], s79 offen offset:2048 nt lds
  buffer_load_dwordx4 v179, s[52:55], s79 offen offset:3072 nt lds
  s_add_u32 m0, s66, 4096
  s_nop 0
  buffer_load_dwordx4 v180, s[52:55], s79 offen nt lds
  s_branch SP_26
SP_25:
  s_sub_u32 s69, s78, 54
  s_mul_i32 s70, s69, 52
  s_lshr_b32 s70, s70, 8
  s_mul_i32 s79, s70, 203520
  s_lshl_b32 s69, s69, 8
  s_add_u32 s79, s79, s69
  s_add_u32 m0, s66, 0
  s_nop 0
  buffer_load_dwordx4 v181, s[56:59], s79 offen offset:0 nt lds
  buffer_load_dwordx4 v182, s[56:59], s79 offen offset:1024 nt lds
  buffer_load_dwordx4 v183, s[56:59], s79 offen offset:2048 nt lds
  buffer_load_dwordx4 v184, s[56:59], s79 offen offset:3072 nt lds
  s_add_u32 m0, s66, 4096
  s_nop 0
  buffer_load_dwordx4 v185, s[56:59], s79 offen nt lds
SP_26:
  s_waitcnt vmcnt(5)
  s_barrier
  s_cmp_lg_u32 s3, 7
  s_cbranch_scc1 SPD_27
  v_mov_b32 v4, 0
  v_mov_b32 v5, 1
  s_mov_b64 exec, 1
  buffer_atomic_add v5, v4, s[84:87], 0 offen offset:0 sc0 sc1
  s_waitcnt vmcnt(0)
  v_cmp_eq_u32 vcc, 15, v5
  s_nop 0
  s_and_b64 exec, exec, vcc
  buffer_store_dword v5, v4, s[84:87], 0 offen offset:128 sc1
  s_mov_b64 exec, -1
SPD_27:
  s_add_u32 s78, s77, 32
  v_add_u32 v2, 81920, v186
  ds_read_b64_tr_b16 v[196:197], v2 offset:0
  ds_read_b64_tr_b16 v[198:199], v2 offset:20480
  v_add_u32 v2, 81920, v187
  ds_read_b64_tr_b16 v[200:201], v2 offset:0
  ds_read_b64_tr_b16 v[202:203], v2 offset:20480
  v_add_u32 v2, 81920, v188
  ds_read_b64_tr_b16 v[204:205], v2 offset:0
  ds_read_b64_tr_b16 v[206:207], v2 offset:20480
  v_add_u32 v2, 81920, v189
  ds_read_b64_tr_b16 v[208:209], v2 offset:0
  ds_read_b64_tr_b16 v[210:211], v2 offset:20480
  v_add_u32 v2, 81920, v190
  ds_read_b64_tr_b16 v[212:213], v2 offset:0
  ds_read_b64_tr_b16 v[214:215], v2 offset:20480
  s_lshl3_add_u32 s80, s78, s3
  s_mul_i32 s80, s80, 5120
  s_add_u32 s80, s80, 10485760
  s_waitcnt lgkmcnt(0)
  buffer_store_dwordx4 v[196:199], v193, s[48:51], s80 offen offset:0 sc1
  buffer_store_dwordx4 v[200:203], v193, s[48:51], s80 offen offset:1024 sc1
  buffer_store_dwordx4 v[204:207], v193, s[48:51], s80 offen offset:2048 sc1
  buffer_store_dwordx4 v[208:211], v193, s[48:51], s80 offen offset:3072 sc1
  buffer_store_dwordx4 v[212:215], v194, s[48:51], s80 offen sc1
  s_add_u32 s78, s77, 64
  s_min_u32 s78, s78, 73
  s_sub_u32 s69, s78, 54
  s_mul_i32 s70, s69, 52
  s_lshr_b32 s70, s70, 8
  s_mul_i32 s79, s70, 203520
  s_lshl_b32 s69, s69, 8
  s_add_u32 s79, s79, s69
  s_add_u32 m0, s66, 40960
  s_nop 0
  buffer_load_dwordx4 v181, s[56:59], s79 offen offset:0 nt lds
  buffer_load_dwordx4 v182, s[56:59], s79 offen offset:1024 nt lds
  buffer_load_dwordx4 v183, s[56:59], s79 offen offset:2048 nt lds
  buffer_load_dwordx4 v184, s[56:59], s79 offen offset:3072 nt lds
  s_add_u32 m0, s66, 45056
  s_nop 0
  buffer_load_dwordx4 v185, s[56:59], s79 offen nt lds
  s_waitcnt vmcnt(5)
  s_barrier
  s_cmp_lg_u32 s3, 7
  s_cbranch_scc1 SPD_28
  v_mov_b32 v4, 0
  v_mov_b32 v5, 1
  s_mov_b64 exec, 1
  buffer_atomic_add v5, v4, s[84:87], 0 offen offset:8 sc0 sc1
  s_waitcnt vmcnt(0)
  v_cmp_eq_u32 vcc, 15, v5
  s_nop 0
  s_and_b64 exec, exec, vcc
  buffer_store_dword v5, v4, s[84:87], 0 offen offset:136 sc1
  s_mov_b64 exec, -1
SPD_28:
  s_add_u32 s78, s77, 48
  s_cmp_ge_u32 s78, 54
  s_cbranch_scc1 SP_29
  v_add_u32 v2, 0, v186
  ds_read_b64_tr_b16 v[216:217], v2 offset:0
  ds_read_b64_tr_b16 v[218:219], v2 offset:20480
  v_add_u32 v2, 0, v187
  ds_read_b64_tr_b16 v[220:221], v2 offset:0
  ds_read_b64_tr_b16 v[222:223], v2 offset:20480
  v_add_u32 v2, 0, v188
  ds_read_b64_tr_b16 v[224:225], v2 offset:0
  ds_read_b64_tr_b16 v[226:227], v2 offset:20480
  v_add_u32 v2, 0, v189
  ds_read_b64_tr_b16 v[228:229], v2 offset:0
  ds_read_b64_tr_b16 v[230:231], v2 offset:20480
  v_add_u32 v2, 0, v190
  ds_read_b64_tr_b16 v[232:233], v2 offset:0
  ds_read_b64_tr_b16 v[234:235], v2 offset:20480
  s_lshl3_add_u32 s80, s78, s3
  s_mul_i32 s80, s80, 5120
  s_add_u32 s80, s80, 10485760
  s_waitcnt lgkmcnt(0)
  buffer_store_dwordx4 v[216:219], v193, s[48:51], s80 offen offset:0 sc1
  buffer_store_dwordx4 v[220:223], v193, s[48:51], s80 offen offset:1024 sc1
  buffer_store_dwordx4 v[224:227], v193, s[48:51], s80 offen offset:2048 sc1
  buffer_store_dwordx4 v[228:231], v193, s[48:51], s80 offen offset:3072 sc1
  buffer_store_dwordx4 v[232:235], v194, s[48:51], s80 offen sc1
  s_branch SP_30
SP_29:
  v_add_u32 v2, 0, v191
  v_add_u32 v3, 0, v192
  v_lshrrev_b32 v6, 1, v7
  v_mul_u32_u24 v6, 10240, v6
  v_add_u32 v6, v6, v2
  ds_read_b64_tr_b16 v[216:217], v2 offset:0
  ds_read_b64_tr_b16 v[218:219], v3 offset:1024
  ds_read_b64_tr_b16 v[220:221], v2 offset:2048
  ds_read_b64_tr_b16 v[222:223], v3 offset:3072
  ds_read_b64_tr_b16 v[224:225], v6 offset:4096
  ds_read_b64_tr_b16 v[226:227], v6 offset:14336
  ds_read_b64_tr_b16 v[228:229], v2 offset:20480
  ds_read_b64_tr_b16 v[230:231], v3 offset:21504
  ds_read_b64_tr_b16 v[232:233], v2 offset:22528
  ds_read_b64_tr_b16 v[234:235], v3 offset:23552
  s_sub_u32 s69, s78, 54
  s_mul_i32 s70, s69, 52
  s_lshr_b32 s70, s70, 8
  s_mul_i32 s67, s70, 5
  s_sub_u32 s69, s69, s67
  s_lshl_b32 s69, s69, 3
  s_add_u32 s69, s69, s3
  s_mul_i32 s68, s69, 52
  s_lshr_b32 s68, s68, 8
  s_mul_i32 s80, s68, 5
  s_sub_u32 s69, s69, s80
  s_add_u32 s80, s67, 54
  s_lshl3_add_u32 s80, s80, s68
  s_mul_i32 s80, s80, 5120
  s_lshl_b32 s69, s69, 10
  s_add_u32 s80, s80, s69
  s_add_u32 s80, s80, 10485760
  s_waitcnt lgkmcnt(0)
  buffer_store_dwordx4 v[216:219], v193, s[48:51], s80 offen sc1
  s_add_u32 s80, s80, 40960
  buffer_store_dwordx4 v[220:223], v193, s[48:51], s80 offen sc1
  s_add_u32 s80, s80, 40960
  buffer_store_dwordx4 v[224:227], v193, s[48:51], s80 offen sc1
  s_add_u32 s80, s80, 40960
  buffer_store_dwordx4 v[228:231], v193, s[48:51], s80 offen sc1
  s_add_u32 s80, s80, 40960
  buffer_store_dwordx4 v[232:235], v193, s[48:51], s80 offen sc1
SP_30:
  s_waitcnt vmcnt(5)
  s_barrier
  s_add_u32 s78, s77, 64
  s_min_u32 s78, s78, 73
  v_add_u32 v2, 40960, v191
  v_add_u32 v3, 40960, v192
  v_lshrrev_b32 v6, 1, v7
  v_mul_u32_u24 v6, 10240, v6
  v_add_u32 v6, v6, v2
  ds_read_b64_tr_b16 v[196:197], v2 offset:0
  ds_read_b64_tr_b16 v[198:199], v3 offset:1024
  ds_read_b64_tr_b16 v[200:201], v2 offset:2048
  ds_read_b64_tr_b16 v[202:203], v3 offset:3072
  ds_read_b64_tr_b16 v[204:205], v6 offset:4096
  ds_read_b64_tr_b16 v[206:207], v6 offset:14336
  ds_read_b64_tr_b16 v[208:209], v2 offset:20480
  ds_read_b64_tr_b16 v[210:211], v3 offset:21504
  ds_read_b64_tr_b16 v[212:213], v2 offset:22528
  ds_read_b64_tr_b16 v[214:215], v3 offset:23552
  s_sub_u32 s69, s78, 54
  s_mul_i32 s70, s69, 52
  s_lshr_b32 s70, s70, 8
  s_mul_i32 s67, s70, 5
  s_sub_u32 s69, s69, s67
  s_lshl_b32 s69, s69, 3
  s_add_u32 s69, s69, s3
  s_mul_i32 s68, s69, 52
  s_lshr_b32 s68, s68, 8
  s_mul_i32 s80, s68, 5
  s_sub_u32 s69, s69, s80
  s_add_u32 s80, s67, 54
  s_lshl3_add_u32 s80, s80, s68
  s_mul_i32 s80, s80, 5120
  s_lshl_b32 s69, s69, 10
  s_add_u32 s80, s80, s69
  s_add_u32 s80, s80, 10485760
  s_waitcnt lgkmcnt(0)
  buffer_store_dwordx4 v[196:199], v193, s[48:51], s80 offen sc1
  s_add_u32 s80, s80, 40960
  buffer_store_dwordx4 v[200:203], v193, s[48:51], s80 offen sc1
  s_add_u32 s80, s80, 40960
  buffer_store_dwordx4 v[204:207], v193, s[48:51], s80 offen sc1
  s_add_u32 s80, s80, 40960
  buffer_store_dwordx4 v[208:211], v193, s[48:51], s80 offen sc1
  s_add_u32 s80, s80, 40960
  buffer_store_dwordx4 v[212:215], v193, s[48:51], s80 offen sc1
  s_waitcnt vmcnt(0)
  s_barrier
  s_cmp_lg_u32 s3, 7
  s_cbranch_scc1 SPD_31
  v_mov_b32 v4, 0
  v_mov_b32 v5, 1
  s_mov_b64 exec, 1
  buffer_atomic_add v5, v4, s[84:87], 0 offen offset:4 sc0 sc1
  s_waitcnt vmcnt(0)
  v_cmp_eq_u32 vcc, 15, v5
  s_nop 0
  s_and_b64 exec, exec, vcc
  buffer_store_dword v5, v4, s[84:87], 0 offen offset:132 sc1
  s_mov_b64 exec, -1
SPD_31:
  s_mov_b32 s44, s32
  s_and_b32 s45, s33, 0xffff
  s_mov_b32 s46, 1280
  s_mov_b32 s47, 0x20000
  v_lshlrev_b32 v2, 4, v10
  buffer_load_dwordx4 v[72:75], v2, s[44:47], 0 offen offset:0
  buffer_load_dwordx4 v[76:79], v2, s[44:47], 0 offen offset:256
  buffer_load_dwordx4 v[80:83], v2, s[44:47], 0 offen offset:512
  buffer_load_dwordx4 v[84:87], v2, s[44:47], 0 offen offset:768
  buffer_load_dwordx4 v[88:91], v2, s[44:47], 0 offen offset:1024
  v_mul_u32_u24 v3, 1280, v7
  v_add_u32 v2, v2, v3
  s_lshl_b32 s70, s77, 3
  s_add_u32 s70, s70, s3
  s_mul_i32 s69, s70, 20480
  buffer_load_dwordx4 v[96:99], v2, s[40:43], s69 offen offset:0
  buffer_load_dwordx4 v[100:103], v2, s[40:43], s69 offen offset:256
  buffer_load_dwordx4 v[104:107], v2, s[40:43], s69 offen offset:512
  buffer_load_dwordx4 v[108:111], v2, s[40:43], s69 offen offset:768
  buffer_load_dwordx4 v[112:115], v2, s[40:43], s69 offen offset:1024
  s_add_u32 s69, s69, 5120
  buffer_load_dwordx4 v[116:119], v2, s[40:43], s69 offen offset:0
  buffer_load_dwordx4 v[120:123], v2, s[40:43], s69 offen offset:256
  buffer_load_dwordx4 v[124:127], v2, s[40:43], s69 offen offset:512
  buffer_load_dwordx4 v[128:131], v2, s[40:43], s69 offen offset:768
  buffer_load_dwordx4 v[132:135], v2, s[40:43], s69 offen offset:1024
  s_add_u32 s69, s69, 5120
  buffer_load_dwordx4 v[136:139], v2, s[40:43], s69 offen offset:0
  buffer_load_dwordx4 v[140:143], v2, s[40:43], s69 offen offset:256
  buffer_load_dwordx4 v[144:147], v2, s[40:43], s69 offen offset:512
  buffer_load_dwordx4 v[148:151], v2, s[40:43], s69 offen offset:768
  buffer_load_dwordx4 v[152:155], v2, s[40:43], s69 offen offset:1024
  s_add_u32 s69, s69, 5120
  buffer_load_dwordx4 v[156:159], v2, s[40:43], s69 offen offset:0
  buffer_load_dwordx4 v[160:163], v2, s[40:43], s69 offen offset:256
  buffer_load_dwordx4 v[164:167], v2, s[40:43], s69 offen offset:512
  buffer_load_dwordx4 v[168:171], v2, s[40:43], s69 offen offset:768
  buffer_load_dwordx4 v[172:175], v2, s[40:43], s69 offen offset:1024
  v_mov_b32 v92, 0
  v_mov_b32 v93, 0
  v_mov_b32 v94, 0
  v_mov_b32 v95, 0
  s_mov_b32 s89, 0x80000
POLL_32:
  v_mov_b32 v3, 0
  buffer_load_dword v3, v3, s[84:87], 0 offen offset:128 sc1
  s_waitcnt vmcnt(0)
  v_readfirstlane_b32 s14, v3
  s_nop 0
  s_cmp_lg_u32 s14, 0
  s_cbranch_scc1 POLLD_33
  s_sleep 2
  s_sub_u32 s89, s89, 1
  s_cbranch_scc0 POLL_32
POLLD_33:
  v_dot2c_f32_bf16 v92, v96, v72
  v_dot2c_f32_bf16 v93, v116, v72
  v_dot2c_f32_bf16 v94, v136, v72
  v_dot2c_f32_bf16 v95, v156, v72
  v_dot2c_f32_bf16 v92, v97, v73
  v_dot2c_f32_bf16 v93, v117, v73
  v_dot2c_f32_bf16 v94, v137, v73
  v_dot2c_f32_bf16 v95, v157, v73
  v_dot2c_f32_bf16 v92, v98, v74
  v_dot2c_f32_bf16 v93, v118, v74
  v_dot2c_f32_bf16 v94, v138, v74
  v_dot2c_f32_bf16 v95, v158, v74
  v_dot2c_f32_bf16 v92, v99, v75
  v_dot2c_f32_bf16 v93, v119, v75
  v_dot2c_f32_bf16 v94, v139, v75
  v_dot2c_f32_bf16 v95, v159, v75
  v_dot2c_f32_bf16 v92, v100, v76
  v_dot2c_f32_bf16 v93, v120, v76
  v_dot2c_f32_bf16 v94, v140, v76
  v_dot2c_f32_bf16 v95, v160, v76
  v_dot2c_f32_bf16 v92, v101, v77
  v_dot2c_f32_bf16 v93, v121, v77
  v_dot2c_f32_bf16 v94, v141, v77
  v_dot2c_f32_bf16 v95, v161, v77
  v_dot2c_f32_bf16 v92, v102, v78
  v_dot2c_f32_bf16 v93, v122, v78
  v_dot2c_f32_bf16 v94, v142, v78
  v_dot2c_f32_bf16 v95, v162, v78
  v_dot2c_f32_bf16 v92, v103, v79
  v_dot2c_f32_bf16 v93, v123, v79
  v_dot2c_f32_bf16 v94, v143, v79
  v_dot2c_f32_bf16 v95, v163, v79
  v_dot2c_f32_bf16 v92, v104, v80
  v_dot2c_f32_bf16 v93, v124, v80
  v_dot2c_f32_bf16 v94, v144, v80
  v_dot2c_f32_bf16 v95, v164, v80
  v_dot2c_f32_bf16 v92, v105, v81
  v_dot2c_f32_bf16 v93, v125, v81
  v_dot2c_f32_bf16 v94, v145, v81
  v_dot2c_f32_bf16 v95, v165, v81
  v_dot2c_f32_bf16 v92, v106, v82
  v_dot2c_f32_bf16 v93, v126, v82
  v_dot2c_f32_bf16 v94, v146, v82
  v_dot2c_f32_bf16 v95, v166, v82
  v_dot2c_f32_bf16 v92, v107, v83
  v_dot2c_f32_bf16 v93, v127, v83
  v_dot2c_f32_bf16 v94, v147, v83
  v_dot2c_f32_bf16 v95, v167, v83
  v_dot2c_f32_bf16 v92, v108, v84
  v_dot2c_f32_bf16 v93, v128, v84
  v_dot2c_f32_bf16 v94, v148, v84
  v_dot2c_f32_bf16 v95, v168, v84
  v_dot2c_f32_bf16 v92, v109, v85
  v_dot2c_f32_bf16 v93, v129, v85
  v_dot2c_f32_bf16 v94, v149, v85
  v_dot2c_f32_bf16 v95, v169, v85
  v_dot2c_f32_bf16 v92, v110, v86
  v_dot2c_f32_bf16 v93, v130, v86
  v_dot2c_f32_bf16 v94, v150, v86
  v_dot2c_f32_bf16 v95, v170, v86
  v_dot2c_f32_bf16 v92, v111, v87
  v_dot2c_f32_bf16 v93, v131, v87
  v_dot2c_f32_bf16 v94, v151, v87
  v_dot2c_f32_bf16 v95, v171, v87
  v_dot2c_f32_bf16 v92, v112, v88
  v_dot2c_f32_bf16 v93, v132, v88
  v_dot2c_f32_bf16 v94, v152, v88
  v_dot2c_f32_bf16 v95, v172, v88
  v_dot2c_f32_bf16 v92, v113, v89
  v_dot2c_f32_bf16 v93, v133, v89
  v_dot2c_f32_bf16 v94, v153, v89
  v_dot2c_f32_bf16 v95, v173, v89
  v_dot2c_f32_bf16 v92, v114, v90
  v_dot2c_f32_bf16 v93, v134, v90
  v_dot2c_f32_bf16 v94, v154, v90
  v_dot2c_f32_bf16 v95, v174, v90
  v_dot2c_f32_bf16 v92, v115, v91
  v_dot2c_f32_bf16 v93, v135, v91
  v_dot2c_f32_bf16 v94, v155, v91
  v_dot2c_f32_bf16 v95, v175, v91
  v_add_f32_dpp v92, v92, v92 row_ror:8 row_mask:0xf bank_mask:0xf
  v_add_f32_dpp v93, v93, v93 row_ror:8 row_mask:0xf bank_mask:0xf
  v_add_f32_dpp v94, v94, v94 row_ror:8 row_mask:0xf bank_mask:0xf
  v_add_f32_dpp v95, v95, v95 row_ror:8 row_mask:0xf bank_mask:0xf
  v_add_f32_dpp v92, v92, v92 row_ror:4 row_mask:0xf bank_mask:0xf
  v_add_f32_dpp v93, v93, v93 row_ror:4 row_mask:0xf bank_mask:0xf
  v_add_f32_dpp v94, v94, v94 row_ror:4 row_mask:0xf bank_mask:0xf
  v_add_f32_dpp v95, v95, v95 row_ror:4 row_mask:0xf bank_mask:0xf
  v_add_f32_dpp v92, v92, v92 row_ror:2 row_mask:0xf bank_mask:0xf
  v_add_f32_dpp v93, v93, v93 row_ror:2 row_mask:0xf bank_mask:0xf
  v_add_f32_dpp v94, v94, v94 row_ror:2 row_mask:0xf bank_mask:0xf
  v_add_f32_dpp v95, v95, v95 row_ror:2 row_mask:0xf bank_mask:0xf
  v_add_f32_dpp v92, v92, v92 row_ror:1 row_mask:0xf bank_mask:0xf
  v_add_f32_dpp v93, v93, v93 row_ror:1 row_mask:0xf bank_mask:0xf
  v_add_f32_dpp v94, v94, v94 row_ror:1 row_mask:0xf bank_mask:0xf
  v_add_f32_dpp v95, v95, v95 row_ror:1 row_mask:0xf bank_mask:0xf
  v_mul_f32 v92, 0x3fb8aa3b, v92
  v_mul_f32 v93, 0x3fb8aa3b, v93
  v_mul_f32 v94, 0x3fb8aa3b, v94
  v_mul_f32 v95, 0x3fb8aa3b, v95
  v_min_f32 v92, 0x42a00000, v92
  v_min_f32 v93, 0x42a00000, v93
  v_min_f32 v94, 0x42a00000, v94
  v_min_f32 v95, 0x42a00000, v95
  v_exp_f32 v92, v92
  v_exp_f32 v93, v93
  v_exp_f32 v94, v94
  v_exp_f32 v95, v95
  v_mov_b32 v4, v92
  v_cmp_eq_u32 vcc, 1, v10
  s_nop 1
  v_cndmask_b32 v4, v4, v93, vcc
  v_cmp_eq_u32 vcc, 2, v10
  s_nop 1
  v_cndmask_b32 v4, v4, v94, vcc
  v_cmp_eq_u32 vcc, 3, v10
  s_nop 1
  v_cndmask_b32 v4, v4, v95, vcc
  v_lshl_add_u32 v2, v10, 2, v7
  v_lshlrev_b32 v5, 2, v2
  s_lshl_b32 s69, s70, 6
  s_add_u32 s69, s69, 19136512
  s_mov_b32 exec_lo, 0x000f000f
  s_mov_b32 exec_hi, 0x000f000f
  buffer_store_dword v4, v5, s[48:51], s69 offen sc1
  s_mov_b64 exec, -1
  s_lshr_b32 s88, s70, 2
  s_lshl_b32 s88, s88, 7
  s_add_u32 s88, s88, 19070988
  s_mov_b32 s7, 3
  v_mov_b32 v31, 0
  s_mov_b32 s8, 7
  s_mov_b32 s77, 0
P2:
  s_bitcmp0_b32 s8, 0
  s_cbranch_scc1 P2_E1
  s_bfe_u32 s16, s2, 0x20001
  s_lshr_b32 s4, s2, 5
  s_lshl3_add_u32 s16, s16, s4
  s_lshr_b32 s17, s2, 3
  s_lshr_b32 s4, s2, 6
  s_add_u32 s17, s17, s4
  s_and_b32 s17, s17, 3
  s_and_b32 s4, s2, 1
  s_lshl2_add_u32 s17, s4, s17
  v_lshlrev_b32 v20, 4, v0
  v_add_u32 v21, 4096, v20
  s_lshl3_add_u32 s19, s71, s17
  s_mul_i32 s19, s19, 5120
  s_add_u32 s19, s19, 10485760
  s_mov_b32 s56, s38
  s_and_b32 s57, s39, 0xffff
  s_mul_i32 s58, s72, 23068672
  s_mov_b32 s59, 0x20000
  s_mul_i32 s21, s71, 5120
  s_mul_i32 s22, s72, 163840
  s_mul_i32 s23, s72, 20480
  s_xor_b32 s4, s72, 1
  s_mul_i32 s20, s4, 655360
  s_add_u32 s20, s20, s19
  s_mul_i32 s18, s16, 74
  s_mul_i32 s4, s4, 16
  s_add_u32 s18, s18, s4
  s_add_u32 s18, s18, s71
  s_lshl_b32 s18, s18, 12
  s_lshr_b32 s4, s17, 1
  s_mul_i32 s4, s4, 5
  s_mul_i32 s80, s16, 74
  s_add_u32 s80, s80, s4
  s_add_u32 s80, s80, 54
  s_lshl2_add_u32 s80, s80, s71
  s_lshl_b32 s80, s80, 10
  s_and_b32 s4, s17, 1
  s_mul_i32 s79, s4, 12288
  s_add_u32 s79, s79, s80
  s_lshl_b32 s4, s4, 9
  s_add_u32 s80, s80, s4
  s_add_u32 s80, s80, 8192
  s_lshl_b32 s78, s16, 7
  s_add_u32 s78, s78, 19075072
P2_E1:
  v_mov_b32 v11, 0
  v_mov_b32 v14, 161024
  v_add_u32 v15, s21, v20
  v_add_u32 v23, 61440, v15
  v_readfirstlane_b32 s83, v31
  s_cmp_eq_u32 s72, 1
  s_cselect_b32 s83, 0, s83
  s_cmp_eq_u32 s83, 0
  s_cbranch_scc1 P2_NQ
  s_lshl3_add_u32 s67, s16, s17
  s_mul_i32 s67, s67, 10240
  s_add_u32 s67, s67, 13631488
  s_lshl_b32 s68, s71, 11
  s_add_u32 s68, s68, s67
  buffer_load_dwordx4 v[176:179], v20, s[48:51], s68 offen offset:0 sc1
  buffer_load_dwordx4 v[180:183], v20, s[48:51], s68 offen offset:1024 sc1
  s_lshr_b32 s68, s71, 1
  s_lshl_b32 s68, s68, 10
  s_add_u32 s67, s67, s68
  s_and_b32 s68, s71, 1
  s_lshl3_add_u32 s67, s68, s67
  s_add_u32 s67, s67, 8192
  buffer_load_dwordx2 v[184:185], v20, s[48:51], s67 offen sc1
P2_NQ:
  buffer_load_dword v30, v11, s[84:87], 0 offen offset:132 sc1
  v_mov_b32 v29, 1
  v_mov_b32 v3, 1
  s_waitcnt vmcnt(0) lgkmcnt(0)
  s_mov_b64 exec, 1
  ds_add_rtn_u32 v3, v14, v3 offset:16
  s_cmp_eq_u32 s7, -1
  s_cbranch_scc1 P2_A2
  buffer_atomic_add v29, v11, s[48:51], s88 offen sc0 sc1
P2_A2:
  s_mov_b64 exec, -1
  s_cmp_eq_u32 s72, 0
  s_cbranch_scc1 P2_C
  s_waitcnt vmcnt(0)
  v_readfirstlane_b32 s14, v29
  s_add_u32 s15, s88, 4096
  s_cmp_lg_u32 s14, s7
  s_cbranch_scc1 GO_34
  s_mov_b64 exec, 1
  buffer_store_dword v29, v11, s[48:51], s15 offen sc1
  s_mov_b64 exec, -1
GO_34:
  s_setprio 0
  v_readfirstlane_b32 s14, v30
  s_nop 0
  s_cmp_lg_u32 s14, 0
  s_cbranch_scc1 INITOK_35
  s_mov_b32 s89, 0x80000
POLL_36:
  v_mov_b32 v30, 0
  buffer_load_dword v30, v30, s[84:87], 0 offen offset:132 sc1
  s_waitcnt vmcnt(0)
  v_readfirstlane_b32 s14, v30
  s_nop 0
  s_cmp_lg_u32 s14, 0
  s_cbranch_scc1 POLLD_37
  s_sleep 2
  s_sub_u32 s89, s89, 1
  s_cbranch_scc0 POLL_36
POLLD_37:
INITOK_35:
  s_cmp_lt_u32 s71, 2
  s_cselect_b32 s58, 23068672, 0
  s_cmp_lt_u32 s8, 6
  s_cbranch_scc1 P2_E2
  s_add_u32 s4, s20, 0
  buffer_load_dwordx4 v[208:211], v20, s[48:51], s4 offen offset:0 sc1
  buffer_load_dwordx4 v[212:215], v20, s[48:51], s4 offen offset:1024 sc1
  buffer_load_dwordx4 v[216:219], v20, s[48:51], s4 offen offset:2048 sc1
  buffer_load_dwordx4 v[220:223], v20, s[48:51], s4 offen offset:3072 sc1
  buffer_load_dwordx4 v[224:227], v21, s[48:51], s4 offen sc1
  s_add_u32 s4, s20, 163840
  buffer_load_dwordx4 v[228:231], v20, s[48:51], s4 offen offset:0 sc1
  buffer_load_dwordx4 v[232:235], v20, s[48:51], s4 offen offset:1024 sc1
  buffer_load_dwordx4 v[236:239], v20, s[48:51], s4 offen offset:2048 sc1
  buffer_load_dwordx4 v[240:243], v20, s[48:51], s4 offen offset:3072 sc1
  buffer_load_dwordx4 v[244:247], v21, s[48:51], s4 offen sc1
  s_add_u32 s4, s20, 327680
  buffer_load_dwordx4 v[32:35], v20, s[48:51], s4 offen offset:0 sc1
  buffer_load_dwordx4 v[36:39], v20, s[48:51], s4 offen offset:1024 sc1
  buffer_load_dwordx4 v[40:43], v20, s[48:51], s4 offen offset:2048 sc1
  buffer_load_dwordx4 v[44:47], v20, s[48:51], s4 offen offset:3072 sc1
  buffer_load_dwordx4 v[48:51], v21, s[48:51], s4 offen sc1
  s_add_u32 s4, s20, 491520
  buffer_load_dwordx4 v[52:55], v20, s[48:51], s4 offen offset:0 sc1
  buffer_load_dwordx4 v[56:59], v20, s[48:51], s4 offen offset:1024 sc1
  buffer_load_dwordx4 v[60:63], v20, s[48:51], s4 offen offset:2048 sc1
  buffer_load_dwordx4 v[64:67], v20, s[48:51], s4 offen offset:3072 sc1
  buffer_load_dwordx4 v[68:71], v21, s[48:51], s4 offen sc1
LW_38:
  ds_read_b32 v3, v14 offset:16
  s_waitcnt lgkmcnt(0)
  v_readfirstlane_b32 s67, v3
  s_nop 0
  s_cmp_ge_u32 s67, 8
  s_cbranch_scc1 LW_38d
  s_sleep 1
  s_branch LW_38
LW_38d:
  s_add_u32 s4, s19, 1310720
  s_add_u32 s5, s21, 40960
  s_mov_b32 m0, s5
  s_nop 0
  buffer_load_dwordx4 v20, s[48:51], s4 offen offset:0 sc1 lds
  buffer_load_dwordx4 v20, s[48:51], s4 offen offset:1024 sc1 lds
  buffer_load_dwordx4 v20, s[48:51], s4 offen offset:2048 sc1 lds
  buffer_load_dwordx4 v20, s[48:51], s4 offen offset:3072 sc1 lds
  s_add_u32 m0, s5, 4096
  s_nop 0
  buffer_load_dwordx4 v21, s[48:51], s4 offen sc1 lds
  s_add_u32 s4, s19, 1474560
  s_add_u32 s5, s21, 102400
  s_mov_b32 m0, s5
  s_nop 0
  buffer_load_dwordx4 v20, s[48:51], s4 offen offset:0 sc1 lds
  buffer_load_dwordx4 v20, s[48:51], s4 offen offset:1024 sc1 lds
  buffer_load_dwordx4 v20, s[48:51], s4 offen offset:2048 sc1 lds
  buffer_load_dwordx4 v20, s[48:51], s4 offen offset:3072 sc1 lds
  s_add_u32 m0, s5, 4096
  s_nop 0
  buffer_load_dwordx4 v21, s[48:51], s4 offen sc1 lds
  s_add_u32 s4, s19, 1638400
  s_add_u32 s5, s21, 61440
  s_mov_b32 m0, s5
  s_nop 0
  buffer_load_dwordx4 v20, s[48:51], s4 offen offset:0 sc1 lds
  buffer_load_dwordx4 v20, s[48:51], s4 offen offset:1024 sc1 lds
  buffer_load_dwordx4 v20, s[48:51], s4 offen offset:2048 sc1 lds
  buffer_load_dwordx4 v20, s[48:51], s4 offen offset:3072 sc1 lds
  s_add_u32 m0, s5, 4096
  s_nop 0
  buffer_load_dwordx4 v21, s[48:51], s4 offen sc1 lds
  s_add_u32 s4, s19, 1802240
  s_add_u32 s5, s21, 81920
  s_mov_b32 m0, s5
  s_nop 0
  buffer_load_dwordx4 v20, s[48:51], s4 offen offset:0 sc1 lds
  buffer_load_dwordx4 v20, s[48:51], s4 offen offset:1024 sc1 lds
  buffer_load_dwordx4 v20, s[48:51], s4 offen offset:2048 sc1 lds
  buffer_load_dwordx4 v20, s[48:51], s4 offen offset:3072 sc1 lds
  s_add_u32 m0, s5, 4096
  s_nop 0
  buffer_load_dwordx4 v21, s[48:51], s4 offen sc1 lds
P2_E2:
  s_cmp_lg_u32 s8, 0
  s_cbranch_scc1 P2_E4
  s_add_u32 s4, s20, 327680
  buffer_load_dwordx4 v[32:35], v20, s[48:51], s4 offen offset:0 sc1
  buffer_load_dwordx4 v[36:39], v20, s[48:51], s4 offen offset:1024 sc1
  buffer_load_dwordx4 v[40:43], v20, s[48:51], s4 offen offset:2048 sc1
  buffer_load_dwordx4 v[44:47], v20, s[48:51], s4 offen offset:3072 sc1
  buffer_load_dwordx4 v[48:51], v21, s[48:51], s4 offen sc1
  s_add_u32 s4, s20, 491520
  buffer_load_dwordx4 v[52:55], v20, s[48:51], s4 offen offset:0 sc1
  buffer_load_dwordx4 v[56:59], v20, s[48:51], s4 offen offset:1024 sc1
  buffer_load_dwordx4 v[60:63], v20, s[48:51], s4 offen offset:2048 sc1
  buffer_load_dwordx4 v[64:67], v20, s[48:51], s4 offen offset:3072 sc1
  buffer_load_dwordx4 v[68:71], v21, s[48:51], s4 offen sc1
P2_E4:
LW_39:
  ds_read_b32 v3, v14 offset:16
  s_waitcnt lgkmcnt(0)
  v_readfirstlane_b32 s67, v3
  s_nop 0
  s_cmp_ge_u32 s67, 8
  s_cbranch_scc1 LW_39d
  s_sleep 1
  s_branch LW_39
LW_39d:
  s_add_u32 s4, s19, 2211840
  s_add_u32 s5, s21, 0
  s_mov_b32 m0, s5
  s_nop 0
  buffer_load_dwordx4 v20, s[48:51], s4 offen offset:0 sc1 lds
  buffer_load_dwordx4 v20, s[48:51], s4 offen offset:1024 sc1 lds
  buffer_load_dwordx4 v20, s[48:51], s4 offen offset:2048 sc1 lds
  buffer_load_dwordx4 v20, s[48:51], s4 offen offset:3072 sc1 lds
  s_add_u32 m0, s5, 4096
  s_nop 0
  buffer_load_dwordx4 v21, s[48:51], s4 offen sc1 lds
  s_add_u32 s4, s19, 2375680
  s_add_u32 s5, s21, 20480
  s_mov_b32 m0, s5
  s_nop 0
  buffer_load_dwordx4 v20, s[48:51], s4 offen offset:0 sc1 lds
  buffer_load_dwordx4 v20, s[48:51], s4 offen offset:1024 sc1 lds
  buffer_load_dwordx4 v20, s[48:51], s4 offen offset:2048 sc1 lds
  buffer_load_dwordx4 v20, s[48:51], s4 offen offset:3072 sc1 lds
  s_add_u32 m0, s5, 4096
  s_nop 0
  buffer_load_dwordx4 v21, s[48:51], s4 offen sc1 lds
  s_add_u32 s4, s19, 2539520
  s_add_u32 s5, s21, 122880
  s_mov_b32 m0, s5
  s_nop 0
  buffer_load_dwordx4 v20, s[48:51], s4 offen offset:0 sc1 lds
  buffer_load_dwordx4 v20, s[48:51], s4 offen offset:1024 sc1 lds
  buffer_load_dwordx4 v20, s[48:51], s4 offen offset:2048 sc1 lds
  buffer_load_dwordx4 v20, s[48:51], s4 offen offset:3072 sc1 lds
  s_add_u32 m0, s5, 4096
  s_nop 0
  buffer_load_dwordx4 v21, s[48:51], s4 offen sc1 lds
  s_cmp_eq_u32 s8, 4
  s_cbranch_scc1 P2_GK
  s_mov_b32 s89, 0x80000
POLL_40:
  buffer_load_dword v3, v11, s[48:51], s78 offen offset:0 sc1
  s_waitcnt vmcnt(0)
  v_cmp_eq_u32 vcc, 0, v3
  s_nop 0
  s_cbranch_vccz POLLD_41
  s_sleep 3
  s_sub_u32 s89, s89, 1
  s_cbranch_scc0 POLL_40
POLLD_41:
  v_mov_b32 v3, 1
  s_waitcnt lgkmcnt(0)
  s_mov_b64 exec, 1
  ds_add_u32 v14, v3 offset:20
  s_mov_b64 exec, -1
  s_setprio 3
  s_add_u32 s67, s18, 0
  buffer_load_dwordx4 v[152:155], v20, s[48:51], s67 offen offset:0 sc1
  buffer_load_dwordx4 v[156:159], v20, s[48:51], s67 offen offset:1024 sc1
  buffer_load_dwordx4 v[160:163], v20, s[48:51], s67 offen offset:2048 sc1
  buffer_load_dwordx4 v[164:167], v20, s[48:51], s67 offen offset:3072 sc1
  s_add_u32 s67, s18, 16384
  buffer_load_dwordx4 v[168:171], v20, s[48:51], s67 offen offset:0 sc1
  buffer_load_dwordx4 v[172:175], v20, s[48:51], s67 offen offset:1024 sc1
  buffer_load_dwordx4 v[176:179], v20, s[48:51], s67 offen offset:2048 sc1
  buffer_load_dwordx4 v[180:183], v20, s[48:51], s67 offen offset:3072 sc1
  s_add_u32 s67, s18, 32768
  buffer_load_dwordx4 v[184:187], v20, s[48:51], s67 offen offset:0 sc1
  buffer_load_dwordx4 v[188:191], v20, s[48:51], s67 offen offset:1024 sc1
  buffer_load_dwordx4 v[192:195], v20, s[48:51], s67 offen offset:2048 sc1
  buffer_load_dwordx4 v[196:199], v20, s[48:51], s67 offen offset:3072 sc1
  s_add_u32 s67, s18, 49152
  buffer_load_dwordx4 v[200:203], v20, s[48:51], s67 offen offset:0 sc1
  buffer_load_dwordx4 v[204:207], v20, s[48:51], s67 offen offset:1024 sc1
  buffer_load_dwordx4 v[248:251], v20, s[48:51], s67 offen offset:2048 sc1
  buffer_load_dwordx4 v[24:27], v20, s[48:51], s67 offen offset:3072 sc1
  s_waitcnt vmcnt(12)
  s_setprio 2
  v_mfma_f32_16x16x32_bf16 v[72:75], v[208:211], v[152:155], 0
  v_mfma_f32_16x16x32_bf16 v[92:95], v[208:211], v[156:159], 0
  v_mfma_f32_16x16x32_bf16 v[112:115], v[208:211], v[160:163], 0
  v_mfma_f32_16x16x32_bf16 v[132:135], v[208:211], v[164:167], 0
  v_mfma_f32_16x16x32_bf16 v[76:79], v[212:215], v[152:155], 0
  v_mfma_f32_16x16x32_bf16 v[96:99], v[212:215], v[156:159], 0
  v_mfma_f32_16x16x32_bf16 v[116:119], v[212:215], v[160:163], 0
  v_mfma_f32_16x16x32_bf16 v[136:139], v[212:215], v[164:167], 0
  v_mfma_f32_16x16x32_bf16 v[80:83], v[216:219], v[152:155], 0
  v_mfma_f32_16x16x32_bf16 v[100:103], v[216:219], v[156:159], 0
  v_mfma_f32_16x16x32_bf16 v[120:123], v[216:219], v[160:163], 0
  v_mfma_f32_16x16x32_bf16 v[140:143], v[216:219], v[164:167], 0
  v_mfma_f32_16x16x32_bf16 v[84:87], v[220:223], v[152:155], 0
  v_mfma_f32_16x16x32_bf16 v[104:107], v[220:223], v[156:159], 0
  v_mfma_f32_16x16x32_bf16 v[124:127], v[220:223], v[160:163], 0
  v_mfma_f32_16x16x32_bf16 v[144:147], v[220:223], v[164:167], 0
  v_mfma_f32_16x16x32_bf16 v[88:91], v[224:227], v[152:155], 0
  v_mfma_f32_16x16x32_bf16 v[108:111], v[224:227], v[156:159], 0
  v_mfma_f32_16x16x32_bf16 v[128:131], v[224:227], v[160:163], 0
  v_mfma_f32_16x16x32_bf16 v[148:151], v[224:227], v[164:167], 0
  s_waitcnt vmcnt(8)
  v_mfma_f32_16x16x32_bf16 v[72:75], v[228:231], v[168:171], v[72:75]
  s_add_u32 s67, s18, 131072
  v_mfma_f32_16x16x32_bf16 v[92:95], v[228:231], v[172:175], v[92:95]
  buffer_load_dwordx4 v[152:155], v20, s[48:51], s67 offen offset:0 sc1
  v_mfma_f32_16x16x32_bf16 v[112:115], v[228:231], v[176:179], v[112:115]
  v_mfma_f32_16x16x32_bf16 v[132:135], v[228:231], v[180:183], v[132:135]
  buffer_load_dwordx4 v[156:159], v20, s[48:51], s67 offen offset:1024 sc1
  v_mfma_f32_16x16x32_bf16 v[76:79], v[232:235], v[168:171], v[76:79]
  v_mfma_f32_16x16x32_bf16 v[96:99], v[232:235], v[172:175], v[96:99]
  buffer_load_dwordx4 v[160:163], v20, s[48:51], s67 offen offset:2048 sc1
  v_mfma_f32_16x16x32_bf16 v[116:119], v[232:235], v[176:179], v[116:119]
  v_mfma_f32_16x16x32_bf16 v[136:139], v[232:235], v[180:183], v[136:139]
  buffer_load_dwordx4 v[164:167], v20, s[48:51], s67 offen offset:3072 sc1
  v_mfma_f32_16x16x32_bf16 v[80:83], v[236:239], v[168:171], v[80:83]
  v_mfma_f32_16x16x32_bf16 v[100:103], v[236:239], v[172:175], v[100:103]
  ds_read_b128 v[208:211], v15 offset:40960
  v_mfma_f32_16x16x32_bf16 v[120:123], v[236:239], v[176:179], v[120:123]
  v_mfma_f32_16x16x32_bf16 v[140:143], v[236:239], v[180:183], v[140:143]
  ds_read_b128 v[212:215], v15 offset:41984
  v_mfma_f32_16x16x32_bf16 v[84:87], v[240:243], v[168:171], v[84:87]
  v_mfma_f32_16x16x32_bf16 v[104:107], v[240:243], v[172:175], v[104:107]
  ds_read_b128 v[216:219], v15 offset:43008
  v_mfma_f32_16x16x32_bf16 v[124:127], v[240:243], v[176:179], v[124:127]
  v_mfma_f32_16x16x32_bf16 v[144:147], v[240:243], v[180:183], v[144:147]
  ds_read_b128 v[220:223], v15 offset:44032
  v_mfma_f32_16x16x32_bf16 v[88:91], v[244:247], v[168:171], v[88:91]
  v_mfma_f32_16x16x32_bf16 v[108:111], v[244:247], v[172:175], v[108:111]
  ds_read_b128 v[224:227], v15 offset:45056
  v_mfma_f32_16x16x32_bf16 v[128:131], v[244:247], v[176:179], v[128:131]
  v_mfma_f32_16x16x32_bf16 v[148:151], v[244:247], v[180:183], v[148:151]
  s_waitcnt vmcnt(8)
  v_mfma_f32_16x16x32_bf16 v[72:75], v[32:35], v[184:187], v[72:75]
  s_add_u32 s67, s18, 196608
  v_mfma_f32_16x16x32_bf16 v[92:95], v[32:35], v[188:191], v[92:95]
  buffer_load_dwordx4 v[168:171], v20, s[48:51], s67 offen offset:0 sc1
  v_mfma_f32_16x16x32_bf16 v[112:115], v[32:35], v[192:195], v[112:115]
  v_mfma_f32_16x16x32_bf16 v[132:135], v[32:35], v[196:199], v[132:135]
  buffer_load_dwordx4 v[172:175], v20, s[48:51], s67 offen offset:1024 sc1
  v_mfma_f32_16x16x32_bf16 v[76:79], v[36:39], v[184:187], v[76:79]
  v_mfma_f32_16x16x32_bf16 v[96:99], v[36:39], v[188:191], v[96:99]
  buffer_load_dwordx4 v[176:179], v20, s[48:51], s67 offen offset:2048 sc1
  v_mfma_f32_16x16x32_bf16 v[116:119], v[36:39], v[192:195], v[116:119]
  v_mfma_f32_16x16x32_bf16 v[136:139], v[36:39], v[196:199], v[136:139]
  buffer_load_dwordx4 v[180:183], v20, s[48:51], s67 offen offset:3072 sc1
  v_mfma_f32_16x16x32_bf16 v[80:83], v[40:43], v[184:187], v[80:83]
  s_add_u32 s4, s20, 1966080
  v_mfma_f32_16x16x32_bf16 v[100:103], v[40:43], v[188:191], v[100:103]
  buffer_load_dwordx4 v[228:231], v20, s[48:51], s4 offen offset:0 sc1
  v_mfma_f32_16x16x32_bf16 v[120:123], v[40:43], v[192:195], v[120:123]
  v_mfma_f32_16x16x32_bf16 v[140:143], v[40:43], v[196:199], v[140:143]
  buffer_load_dwordx4 v[232:235], v20, s[48:51], s4 offen offset:1024 sc1
  v_mfma_f32_16x16x32_bf16 v[84:87], v[44:47], v[184:187], v[84:87]
  v_mfma_f32_16x16x32_bf16 v[104:107], v[44:47], v[188:191], v[104:107]
  buffer_load_dwordx4 v[236:239], v20, s[48:51], s4 offen offset:2048 sc1
  v_mfma_f32_16x16x32_bf16 v[124:127], v[44:47], v[192:195], v[124:127]
  v_mfma_f32_16x16x32_bf16 v[144:147], v[44:47], v[196:199], v[144:147]
  buffer_load_dwordx4 v[240:243], v20, s[48:51], s4 offen offset:3072 sc1
  v_mfma_f32_16x16x32_bf16 v[88:91], v[48:51], v[184:187], v[88:91]
  v_mfma_f32_16x16x32_bf16 v[108:111], v[48:51], v[188:191], v[108:111]
  buffer_load_dwordx4 v[244:247], v21, s[48:51], s4 offen sc1
  v_mfma_f32_16x16x32_bf16 v[128:131], v[48:51], v[192:195], v[128:131]
  v_mfma_f32_16x16x32_bf16 v[148:151], v[48:51], v[196:199], v[148:151]
  s_waitcnt vmcnt(13)
  v_mfma_f32_16x16x32_bf16 v[72:75], v[52:55], v[200:203], v[72:75]
  s_add_u32 s67, s18, 147456
  v_mfma_f32_16x16x32_bf16 v[92:95], v[52:55], v[204:207], v[92:95]
  buffer_load_dwordx4 v[184:187], v20, s[48:51], s67 offen offset:0 sc1
  v_mfma_f32_16x16x32_bf16 v[112:115], v[52:55], v[248:251], v[112:115]
  v_mfma_f32_16x16x32_bf16 v[132:135], v[52:55], v[24:27], v[132:135]
  buffer_load_dwordx4 v[188:191], v20, s[48:51], s67 offen offset:1024 sc1
  v_mfma_f32_16x16x32_bf16 v[76:79], v[56:59], v[200:203], v[76:79]
  v_mfma_f32_16x16x32_bf16 v[96:99], v[56:59], v[204:207], v[96:99]
  buffer_load_dwordx4 v[192:195], v20, s[48:51], s67 offen offset:2048 sc1
  v_mfma_f32_16x16x32_bf16 v[116:119], v[56:59], v[248:251], v[116:119]
  v_mfma_f32_16x16x32_bf16 v[136:139], v[56:59], v[24:27], v[136:139]
  buffer_load_dwordx4 v[196:199], v20, s[48:51], s67 offen offset:3072 sc1
  v_mfma_f32_16x16x32_bf16 v[80:83], v[60:63], v[200:203], v[80:83]
  v_mfma_f32_16x16x32_bf16 v[100:103], v[60:63], v[204:207], v[100:103]
  ds_read_b128 v[32:35], v23 offset:40960
  v_mfma_f32_16x16x32_bf16 v[120:123], v[60:63], v[248:251], v[120:123]
  v_mfma_f32_16x16x32_bf16 v[140:143], v[60:63], v[24:27], v[140:143]
  ds_read_b128 v[36:39], v23 offset:41984
  v_mfma_f32_16x16x32_bf16 v[84:87], v[64:67], v[200:203], v[84:87]
  v_mfma_f32_16x16x32_bf16 v[104:107], v[64:67], v[204:207], v[104:107]
  ds_read_b128 v[40:43], v23 offset:43008
  v_mfma_f32_16x16x32_bf16 v[124:127], v[64:67], v[248:251], v[124:127]
  v_mfma_f32_16x16x32_bf16 v[144:147], v[64:67], v[24:27], v[144:147]
  ds_read_b128 v[44:47], v23 offset:44032
  v_mfma_f32_16x16x32_bf16 v[88:91], v[68:71], v[200:203], v[88:91]
  v_mfma_f32_16x16x32_bf16 v[108:111], v[68:71], v[204:207], v[108:111]
  ds_read_b128 v[48:51], v23 offset:45056
  v_mfma_f32_16x16x32_bf16 v[128:131], v[68:71], v[248:251], v[128:131]
  v_mfma_f32_16x16x32_bf16 v[148:151], v[68:71], v[24:27], v[148:151]
  s_waitcnt vmcnt(13) lgkmcnt(5)
  v_mfma_f32_16x16x32_bf16 v[72:75], v[208:211], v[152:155], v[72:75]
  s_add_u32 s67, s18, 163840
  v_mfma_f32_16x16x32_bf16 v[92:95], v[208:211], v[156:159], v[92:95]
  buffer_load_dwordx4 v[200:203], v20, s[48:51], s67 offen offset:0 sc1
  v_mfma_f32_16x16x32_bf16 v[112:115], v[208:211], v[160:163], v[112:115]
  v_mfma_f32_16x16x32_bf16 v[132:135], v[208:211], v[164:167], v[132:135]
  buffer_load_dwordx4 v[204:207], v20, s[48:51], s67 offen offset:1024 sc1
  v_mfma_f32_16x16x32_bf16 v[76:79], v[212:215], v[152:155], v[76:79]
  v_mfma_f32_16x16x32_bf16 v[96:99], v[212:215], v[156:159], v[96:99]
  buffer_load_dwordx4 v[248:251], v20, s[48:51], s67 offen offset:2048 sc1
  v_mfma_f32_16x16x32_bf16 v[116:119], v[212:215], v[160:163], v[116:119]
  v_mfma_f32_16x16x32_bf16 v[136:139], v[212:215], v[164:167], v[136:139]
  buffer_load_dwordx4 v[24:27], v20, s[48:51], s67 offen offset:3072 sc1
  v_mfma_f32_16x16x32_bf16 v[80:83], v[216:219], v[152:155], v[80:83]
  v_mfma_f32_16x16x32_bf16 v[100:103], v[216:219], v[156:159], v[100:103]
  ds_read_b128 v[52:55], v23 offset:0
  v_mfma_f32_16x16x32_bf16 v[120:123], v[216:219], v[160:163], v[120:123]
  v_mfma_f32_16x16x32_bf16 v[140:143], v[216:219], v[164:167], v[140:143]
  ds_read_b128 v[56:59], v23 offset:1024
  v_mfma_f32_16x16x32_bf16 v[84:87], v[220:223], v[152:155], v[84:87]
  v_mfma_f32_16x16x32_bf16 v[104:107], v[220:223], v[156:159], v[104:107]
  ds_read_b128 v[60:63], v23 offset:2048
  v_mfma_f32_16x16x32_bf16 v[124:127], v[220:223], v[160:163], v[124:127]
  v_mfma_f32_16x16x32_bf16 v[144:147], v[220:223], v[164:167], v[144:147]
  ds_read_b128 v[64:67], v23 offset:3072
  v_mfma_f32_16x16x32_bf16 v[88:91], v[224:227], v[152:155], v[88:91]
  v_mfma_f32_16x16x32_bf16 v[108:111], v[224:227], v[156:159], v[108:111]
  ds_read_b128 v[68:71], v23 offset:4096
  v_mfma_f32_16x16x32_bf16 v[128:131], v[224:227], v[160:163], v[128:131]
  v_mfma_f32_16x16x32_bf16 v[148:151], v[224:227], v[164:167], v[148:151]
  s_waitcnt vmcnt(8)
  s_setprio 1
  v_mfma_f32_16x16x32_bf16 v[72:75], v[228:231], v[168:171], v[72:75]
  s_add_u32 s67, s18, 212992
  v_mfma_f32_16x16x32_bf16 v[92:95], v[228:231], v[172:175], v[92:95]
  buffer_load_dwordx4 v[152:155], v20, s[56:59], s67 offen offset:0 sc1
  v_mfma_f32_16x16x32_bf16 v[112:115], v[228:231], v[176:179], v[112:115]
  v_mfma_f32_16x16x32_bf16 v[132:135], v[228:231], v[180:183], v[132:135]
  buffer_load_dwordx4 v[156:159], v20, s[56:59], s67 offen offset:1024 sc1
  v_mfma_f32_16x16x32_bf16 v[76:79], v[232:235], v[168:171], v[76:79]
  v_mfma_f32_16x16x32_bf16 v[96:99], v[232:235], v[172:175], v[96:99]
  buffer_load_dwordx4 v[160:163], v20, s[56:59], s67 offen offset:2048 sc1
  v_mfma_f32_16x16x32_bf16 v[116:119], v[232:235], v[176:179], v[116:119]
  v_mfma_f32_16x16x32_bf16 v[136:139], v[232:235], v[180:183], v[136:139]
  buffer_load_dwordx4 v[164:167], v20, s[56:59], s67 offen offset:3072 sc1
  v_mfma_f32_16x16x32_bf16 v[80:83], v[236:239], v[168:171], v[80:83]
  s_add_u32 s4, s20, 2129920
  v_mfma_f32_16x16x32_bf16 v[100:103], v[236:239], v[172:175], v[100:103]
  buffer_load_dwordx4 v[208:211], v20, s[56:59], s4 offen offset:0 sc1
  v_mfma_f32_16x16x32_bf16 v[120:123], v[236:239], v[176:179], v[120:123]
  v_mfma_f32_16x16x32_bf16 v[140:143], v[236:239], v[180:183], v[140:143]
  buffer_load_dwordx4 v[212:215], v20, s[56:59], s4 offen offset:1024 sc1
  v_mfma_f32_16x16x32_bf16 v[84:87], v[240:243], v[168:171], v[84:87]
  v_mfma_f32_16x16x32_bf16 v[104:107], v[240:243], v[172:175], v[104:107]
  buffer_load_dwordx4 v[216:219], v20, s[56:59], s4 offen offset:2048 sc1
  v_mfma_f32_16x16x32_bf16 v[124:127], v[240:243], v[176:179], v[124:127]
  v_mfma_f32_16x16x32_bf16 v[144:147], v[240:243], v[180:183], v[144:147]
  buffer_load_dwordx4 v[220:223], v20, s[56:59], s4 offen offset:3072 sc1
  v_mfma_f32_16x16x32_bf16 v[88:91], v[244:247], v[168:171], v[88:91]
  v_mfma_f32_16x16x32_bf16 v[108:111], v[244:247], v[172:175], v[108:111]
  buffer_load_dwordx4 v[224:227], v21, s[56:59], s4 offen sc1
  v_mfma_f32_16x16x32_bf16 v[128:131], v[244:247], v[176:179], v[128:131]
  v_mfma_f32_16x16x32_bf16 v[148:151], v[244:247], v[180:183], v[148:151]
  s_waitcnt vmcnt(13) lgkmcnt(5)
  v_mfma_f32_16x16x32_bf16 v[72:75], v[32:35], v[184:187], v[72:75]
  s_add_u32 s67, s18, 180224
  v_mfma_f32_16x16x32_bf16 v[92:95], v[32:35], v[188:191], v[92:95]
  buffer_load_dwordx4 v[168:171], v20, s[48:51], s67 offen offset:0 sc1
  v_mfma_f32_16x16x32_bf16 v[112:115], v[32:35], v[192:195], v[112:115]
  v_mfma_f32_16x16x32_bf16 v[132:135], v[32:35], v[196:199], v[132:135]
  buffer_load_dwordx4 v[172:175], v20, s[48:51], s67 offen offset:1024 sc1
  v_mfma_f32_16x16x32_bf16 v[76:79], v[36:39], v[184:187], v[76:79]
  v_mfma_f32_16x16x32_bf16 v[96:99], v[36:39], v[188:191], v[96:99]
  buffer_load_dwordx4 v[176:179], v20, s[48:51], s67 offen offset:2048 sc1
  v_mfma_f32_16x16x32_bf16 v[116:119], v[36:39], v[192:195], v[116:119]
  v_mfma_f32_16x16x32_bf16 v[136:139], v[36:39], v[196:199], v[136:139]
  buffer_load_dwordx4 v[180:183], v20, s[48:51], s67 offen offset:3072 sc1
  v_mfma_f32_16x16x32_bf16 v[80:83], v[40:43], v[184:187], v[80:83]
  v_mfma_f32_16x16x32_bf16 v[100:103], v[40:43], v[188:191], v[100:103]
  ds_read_b128 v[228:231], v23 offset:20480
  v_mfma_f32_16x16x32_bf16 v[120:123], v[40:43], v[192:195], v[120:123]
  v_mfma_f32_16x16x32_bf16 v[140:143], v[40:43], v[196:199], v[140:143]
  ds_read_b128 v[232:235], v23 offset:21504
  v_mfma_f32_16x16x32_bf16 v[84:87], v[44:47], v[184:187], v[84:87]
  v_mfma_f32_16x16x32_bf16 v[104:107], v[44:47], v[188:191], v[104:107]
  ds_read_b128 v[236:239], v23 offset:22528
  v_mfma_f32_16x16x32_bf16 v[124:127], v[44:47], v[192:195], v[124:127]
  v_mfma_f32_16x16x32_bf16 v[144:147], v[44:47], v[196:199], v[144:147]
  ds_read_b128 v[240:243], v23 offset:23552
  v_mfma_f32_16x16x32_bf16 v[88:91], v[48:51], v[184:187], v[88:91]
  v_mfma_f32_16x16x32_bf16 v[108:111], v[48:51], v[188:191], v[108:111]
  ds_read_b128 v[244:247], v23 offset:24576
  v_mfma_f32_16x16x32_bf16 v[128:131], v[48:51], v[192:195], v[128:131]
  v_mfma_f32_16x16x32_bf16 v[148:151], v[48:51], v[196:199], v[148:151]
  s_waitcnt vmcnt(13) lgkmcnt(5)
  s_setprio 3
  v_mfma_f32_16x16x32_bf16 v[72:75], v[52:55], v[200:203], v[72:75]
  v_mfma_f32_16x16x32_bf16 v[92:95], v[52:55], v[204:207], v[92:95]
  v_mfma_f32_16x16x32_bf16 v[112:115], v[52:55], v[248:251], v[112:115]
  v_mfma_f32_16x16x32_bf16 v[132:135], v[52:55], v[24:27], v[132:135]
  v_mfma_f32_16x16x32_bf16 v[76:79], v[56:59], v[200:203], v[76:79]
  v_mfma_f32_16x16x32_bf16 v[96:99], v[56:59], v[204:207], v[96:99]
  v_mfma_f32_16x16x32_bf16 v[116:119], v[56:59], v[248:251], v[116:119]
  v_mfma_f32_16x16x32_bf16 v[136:139], v[56:59], v[24:27], v[136:139]
  v_mfma_f32_16x16x32_bf16 v[80:83], v[60:63], v[200:203], v[80:83]
  v_mfma_f32_16x16x32_bf16 v[100:103], v[60:63], v[204:207], v[100:103]
  v_mfma_f32_16x16x32_bf16 v[120:123], v[60:63], v[248:251], v[120:123]
  v_mfma_f32_16x16x32_bf16 v[140:143], v[60:63], v[24:27], v[140:143]
  v_mfma_f32_16x16x32_bf16 v[84:87], v[64:67], v[200:203], v[84:87]
  v_mfma_f32_16x16x32_bf16 v[104:107], v[64:67], v[204:207], v[104:107]
  v_mfma_f32_16x16x32_bf16 v[124:127], v[64:67], v[248:251], v[124:127]
  v_mfma_f32_16x16x32_bf16 v[144:147], v[64:67], v[24:27], v[144:147]
  v_mfma_f32_16x16x32_bf16 v[88:91], v[68:71], v[200:203], v[88:91]
  v_mfma_f32_16x16x32_bf16 v[108:111], v[68:71], v[204:207], v[108:111]
  v_mfma_f32_16x16x32_bf16 v[128:131], v[68:71], v[248:251], v[128:131]
  v_mfma_f32_16x16x32_bf16 v[148:151], v[68:71], v[24:27], v[148:151]
  s_waitcnt vmcnt(4)
  v_mfma_f32_16x16x32_bf16 v[72:75], v[208:211], v[152:155], v[72:75]
  v_mfma_f32_16x16x32_bf16 v[92:95], v[208:211], v[156:159], v[92:95]
  v_mfma_f32_16x16x32_bf16 v[112:115], v[208:211], v[160:163], v[112:115]
  v_mfma_f32_16x16x32_bf16 v[132:135], v[208:211], v[164:167], v[132:135]
  v_mfma_f32_16x16x32_bf16 v[76:79], v[212:215], v[152:155], v[76:79]
  v_mfma_f32_16x16x32_bf16 v[96:99], v[212:215], v[156:159], v[96:99]
  v_mfma_f32_16x16x32_bf16 v[116:119], v[212:215], v[160:163], v[116:119]
  v_mfma_f32_16x16x32_bf16 v[136:139], v[212:215], v[164:167], v[136:139]
  v_mfma_f32_16x16x32_bf16 v[80:83], v[216:219], v[152:155], v[80:83]
  v_mfma_f32_16x16x32_bf16 v[100:103], v[216:219], v[156:159], v[100:103]
  v_mfma_f32_16x16x32_bf16 v[120:123], v[216:219], v[160:163], v[120:123]
  v_mfma_f32_16x16x32_bf16 v[140:143], v[216:219], v[164:167], v[140:143]
  v_mfma_f32_16x16x32_bf16 v[84:87], v[220:223], v[152:155], v[84:87]
  v_mfma_f32_16x16x32_bf16 v[104:107], v[220:223], v[156:159], v[104:107]
  v_mfma_f32_16x16x32_bf16 v[124:127], v[220:223], v[160:163], v[124:127]
  v_mfma_f32_16x16x32_bf16 v[144:147], v[220:223], v[164:167], v[144:147]
  v_mfma_f32_16x16x32_bf16 v[88:91], v[224:227], v[152:155], v[88:91]
  v_mfma_f32_16x16x32_bf16 v[108:111], v[224:227], v[156:159], v[108:111]
  v_mfma_f32_16x16x32_bf16 v[128:131], v[224:227], v[160:163], v[128:131]
  v_mfma_f32_16x16x32_bf16 v[148:151], v[224:227], v[164:167], v[148:151]
  s_branch P2_GL
P2_GK:
  s_mov_b32 s89, 0x80000
POLL_42:
  buffer_load_dword v3, v11, s[48:51], s78 offen offset:0 sc1
  s_waitcnt vmcnt(0)
  v_cmp_eq_u32 vcc, 0, v3
  s_nop 0
  s_cbranch_vccz POLLD_43
  s_sleep 3
  s_sub_u32 s89, s89, 1
  s_cbranch_scc0 POLL_42
POLLD_43:
  v_mov_b32 v3, 1
  s_waitcnt lgkmcnt(0)
  s_mov_b64 exec, 1
  ds_add_u32 v14, v3 offset:20
  s_mov_b64 exec, -1
  s_setprio 3
  s_add_u32 s67, s18, 0
  buffer_load_dwordx4 v[152:155], v20, s[48:51], s67 offen offset:0 sc1
  buffer_load_dwordx4 v[156:159], v20, s[48:51], s67 offen offset:1024 sc1
  buffer_load_dwordx4 v[160:163], v20, s[48:51], s67 offen offset:2048 sc1
  buffer_load_dwordx4 v[164:167], v20, s[48:51], s67 offen offset:3072 sc1
  s_add_u32 s67, s18, 16384
  buffer_load_dwordx4 v[168:171], v20, s[48:51], s67 offen offset:0 sc1
  buffer_load_dwordx4 v[172:175], v20, s[48:51], s67 offen offset:1024 sc1
  buffer_load_dwordx4 v[176:179], v20, s[48:51], s67 offen offset:2048 sc1
  buffer_load_dwordx4 v[180:183], v20, s[48:51], s67 offen offset:3072 sc1
  s_add_u32 s67, s18, 32768
  buffer_load_dwordx4 v[184:187], v20, s[48:51], s67 offen offset:0 sc1
  buffer_load_dwordx4 v[188:191], v20, s[48:51], s67 offen offset:1024 sc1
  buffer_load_dwordx4 v[192:195], v20, s[48:51], s67 offen offset:2048 sc1
  buffer_load_dwordx4 v[196:199], v20, s[48:51], s67 offen offset:3072 sc1
  s_add_u32 s67, s18, 49152
  buffer_load_dwordx4 v[200:203], v20, s[48:51], s67 offen offset:0 sc1
  buffer_load_dwordx4 v[204:207], v20, s[48:51], s67 offen offset:1024 sc1
  buffer_load_dwordx4 v[248:251], v20, s[48:51], s67 offen offset:2048 sc1
  buffer_load_dwordx4 v[24:27], v20, s[48:51], s67 offen offset:3072 sc1
  s_waitcnt vmcnt(12)
  s_setprio 2
  v_mfma_f32_16x16x32_bf16 v[72:75], v[208:211], v[152:155], 0
  v_mfma_f32_16x16x32_bf16 v[92:95], v[208:211], v[156:159], 0
  v_mfma_f32_16x16x32_bf16 v[112:115], v[208:211], v[160:163], 0
  v_mfma_f32_16x16x32_bf16 v[132:135], v[208:211], v[164:167], 0
  v_mfma_f32_16x16x32_bf16 v[76:79], v[212:215], v[152:155], 0
  v_mfma_f32_16x16x32_bf16 v[96:99], v[212:215], v[156:159], 0
  v_mfma_f32_16x16x32_bf16 v[116:119], v[212:215], v[160:163], 0
  v_mfma_f32_16x16x32_bf16 v[136:139], v[212:215], v[164:167], 0
  v_mfma_f32_16x16x32_bf16 v[80:83], v[216:219], v[152:155], 0
  v_mfma_f32_16x16x32_bf16 v[100:103], v[216:219], v[156:159], 0
  v_mfma_f32_16x16x32_bf16 v[120:123], v[216:219], v[160:163], 0
  v_mfma_f32_16x16x32_bf16 v[140:143], v[216:219], v[164:167], 0
  v_mfma_f32_16x16x32_bf16 v[84:87], v[220:223], v[152:155], 0
  v_mfma_f32_16x16x32_bf16 v[104:107], v[220:223], v[156:159], 0
  v_mfma_f32_16x16x32_bf16 v[124:127], v[220:223], v[160:163], 0
  v_mfma_f32_16x16x32_bf16 v[144:147], v[220:223], v[164:167], 0
  v_mfma_f32_16x16x32_bf16 v[88:91], v[224:227], v[152:155], 0
  v_mfma_f32_16x16x32_bf16 v[108:111], v[224:227], v[156:159], 0
  v_mfma_f32_16x16x32_bf16 v[128:131], v[224:227], v[160:163], 0
  v_mfma_f32_16x16x32_bf16 v[148:151], v[224:227], v[164:167], 0
  s_waitcnt vmcnt(8)
  v_mfma_f32_16x16x32_bf16 v[72:75], v[228:231], v[168:171], v[72:75]
  s_add_u32 s67, s18, 131072
  v_mfma_f32_16x16x32_bf16 v[92:95], v[228:231], v[172:175], v[92:95]
  buffer_load_dwordx4 v[152:155], v20, s[48:51], s67 offen offset:0 sc1
  v_mfma_f32_16x16x32_bf16 v[112:115], v[228:231], v[176:179], v[112:115]
  v_mfma_f32_16x16x32_bf16 v[132:135], v[228:231], v[180:183], v[132:135]
  buffer_load_dwordx4 v[156:159], v20, s[48:51], s67 offen offset:1024 sc1
  v_mfma_f32_16x16x32_bf16 v[76:79], v[232:235], v[168:171], v[76:79]
  v_mfma_f32_16x16x32_bf16 v[96:99], v[232:235], v[172:175], v[96:99]
  buffer_load_dwordx4 v[160:163], v20, s[48:51], s67 offen offset:2048 sc1
  v_mfma_f32_16x16x32_bf16 v[116:119], v[232:235], v[176:179], v[116:119]
  v_mfma_f32_16x16x32_bf16 v[136:139], v[232:235], v[180:183], v[136:139]
  buffer_load_dwordx4 v[164:167], v20, s[48:51], s67 offen offset:3072 sc1
  v_mfma_f32_16x16x32_bf16 v[80:83], v[236:239], v[168:171], v[80:83]
  s_add_u32 s4, s20, 1310720
  v_mfma_f32_16x16x32_bf16 v[100:103], v[236:239], v[172:175], v[100:103]
  buffer_load_dwordx4 v[208:211], v20, s[48:51], s4 offen offset:0 sc1
  v_mfma_f32_16x16x32_bf16 v[120:123], v[236:239], v[176:179], v[120:123]
  v_mfma_f32_16x16x32_bf16 v[140:143], v[236:239], v[180:183], v[140:143]
  buffer_load_dwordx4 v[212:215], v20, s[48:51], s4 offen offset:1024 sc1
  v_mfma_f32_16x16x32_bf16 v[84:87], v[240:243], v[168:171], v[84:87]
  v_mfma_f32_16x16x32_bf16 v[104:107], v[240:243], v[172:175], v[104:107]
  buffer_load_dwordx4 v[216:219], v20, s[48:51], s4 offen offset:2048 sc1
  v_mfma_f32_16x16x32_bf16 v[124:127], v[240:243], v[176:179], v[124:127]
  v_mfma_f32_16x16x32_bf16 v[144:147], v[240:243], v[180:183], v[144:147]
  buffer_load_dwordx4 v[220:223], v20, s[48:51], s4 offen offset:3072 sc1
  v_mfma_f32_16x16x32_bf16 v[88:91], v[244:247], v[168:171], v[88:91]
  v_mfma_f32_16x16x32_bf16 v[108:111], v[244:247], v[172:175], v[108:111]
  buffer_load_dwordx4 v[224:227], v21, s[48:51], s4 offen sc1
  v_mfma_f32_16x16x32_bf16 v[128:131], v[244:247], v[176:179], v[128:131]
  v_mfma_f32_16x16x32_bf16 v[148:151], v[244:247], v[180:183], v[148:151]
  s_waitcnt vmcnt(13)
  v_mfma_f32_16x16x32_bf16 v[72:75], v[32:35], v[184:187], v[72:75]
  s_add_u32 s67, s18, 196608
  v_mfma_f32_16x16x32_bf16 v[92:95], v[32:35], v[188:191], v[92:95]
  buffer_load_dwordx4 v[168:171], v20, s[48:51], s67 offen offset:0 sc1
  v_mfma_f32_16x16x32_bf16 v[112:115], v[32:35], v[192:195], v[112:115]
  v_mfma_f32_16x16x32_bf16 v[132:135], v[32:35], v[196:199], v[132:135]
  buffer_load_dwordx4 v[172:175], v20, s[48:51], s67 offen offset:1024 sc1
  v_mfma_f32_16x16x32_bf16 v[76:79], v[36:39], v[184:187], v[76:79]
  v_mfma_f32_16x16x32_bf16 v[96:99], v[36:39], v[188:191], v[96:99]
  buffer_load_dwordx4 v[176:179], v20, s[48:51], s67 offen offset:2048 sc1
  v_mfma_f32_16x16x32_bf16 v[116:119], v[36:39], v[192:195], v[116:119]
  v_mfma_f32_16x16x32_bf16 v[136:139], v[36:39], v[196:199], v[136:139]
  buffer_load_dwordx4 v[180:183], v20, s[48:51], s67 offen offset:3072 sc1
  v_mfma_f32_16x16x32_bf16 v[80:83], v[40:43], v[184:187], v[80:83]
  s_add_u32 s4, s20, 1966080
  v_mfma_f32_16x16x32_bf16 v[100:103], v[40:43], v[188:191], v[100:103]
  buffer_load_dwordx4 v[228:231], v20, s[48:51], s4 offen offset:0 sc1
  v_mfma_f32_16x16x32_bf16 v[120:123], v[40:43], v[192:195], v[120:123]
  v_mfma_f32_16x16x32_bf16 v[140:143], v[40:43], v[196:199], v[140:143]
  buffer_load_dwordx4 v[232:235], v20, s[48:51], s4 offen offset:1024 sc1
  v_mfma_f32_16x16x32_bf16 v[84:87], v[44:47], v[184:187], v[84:87]
  v_mfma_f32_16x16x32_bf16 v[104:107], v[44:47], v[188:191], v[104:107]
  buffer_load_dwordx4 v[236:239], v20, s[48:51], s4 offen offset:2048 sc1
  v_mfma_f32_16x16x32_bf16 v[124:127], v[44:47], v[192:195], v[124:127]
  v_mfma_f32_16x16x32_bf16 v[144:147], v[44:47], v[196:199], v[144:147]
  buffer_load_dwordx4 v[240:243], v20, s[48:51], s4 offen offset:3072 sc1
  v_mfma_f32_16x16x32_bf16 v[88:91], v[48:51], v[184:187], v[88:91]
  v_mfma_f32_16x16x32_bf16 v[108:111], v[48:51], v[188:191], v[108:111]
  buffer_load_dwordx4 v[244:247], v21, s[48:51], s4 offen sc1
  v_mfma_f32_16x16x32_bf16 v[128:131], v[48:51], v[192:195], v[128:131]
  v_mfma_f32_16x16x32_bf16 v[148:151], v[48:51], v[196:199], v[148:151]
  s_waitcnt vmcnt(18)
  v_mfma_f32_16x16x32_bf16 v[72:75], v[52:55], v[200:203], v[72:75]
  s_add_u32 s67, s18, 147456
  v_mfma_f32_16x16x32_bf16 v[92:95], v[52:55], v[204:207], v[92:95]
  buffer_load_dwordx4 v[184:187], v20, s[48:51], s67 offen offset:0 sc1
  v_mfma_f32_16x16x32_bf16 v[112:115], v[52:55], v[248:251], v[112:115]
  v_mfma_f32_16x16x32_bf16 v[132:135], v[52:55], v[24:27], v[132:135]
  buffer_load_dwordx4 v[188:191], v20, s[48:51], s67 offen offset:1024 sc1
  v_mfma_f32_16x16x32_bf16 v[76:79], v[56:59], v[200:203], v[76:79]
  v_mfma_f32_16x16x32_bf16 v[96:99], v[56:59], v[204:207], v[96:99]
  buffer_load_dwordx4 v[192:195], v20, s[48:51], s67 offen offset:2048 sc1
  v_mfma_f32_16x16x32_bf16 v[116:119], v[56:59], v[248:251], v[116:119]
  v_mfma_f32_16x16x32_bf16 v[136:139], v[56:59], v[24:27], v[136:139]
  buffer_load_dwordx4 v[196:199], v20, s[48:51], s67 offen offset:3072 sc1
  v_mfma_f32_16x16x32_bf16 v[80:83], v[60:63], v[200:203], v[80:83]
  s_add_u32 s4, s20, 1474560
  v_mfma_f32_16x16x32_bf16 v[100:103], v[60:63], v[204:207], v[100:103]
  buffer_load_dwordx4 v[32:35], v20, s[48:51], s4 offen offset:0 sc1
  v_mfma_f32_16x16x32_bf16 v[120:123], v[60:63], v[248:251], v[120:123]
  v_mfma_f32_16x16x32_bf16 v[140:143], v[60:63], v[24:27], v[140:143]
  buffer_load_dwordx4 v[36:39], v20, s[48:51], s4 offen offset:1024 sc1
  v_mfma_f32_16x16x32_bf16 v[84:87], v[64:67], v[200:203], v[84:87]
  v_mfma_f32_16x16x32_bf16 v[104:107], v[64:67], v[204:207], v[104:107]
  buffer_load_dwordx4 v[40:43], v20, s[48:51], s4 offen offset:2048 sc1
  v_mfma_f32_16x16x32_bf16 v[124:127], v[64:67], v[248:251], v[124:127]
  v_mfma_f32_16x16x32_bf16 v[144:147], v[64:67], v[24:27], v[144:147]
  buffer_load_dwordx4 v[44:47], v20, s[48:51], s4 offen offset:3072 sc1
  v_mfma_f32_16x16x32_bf16 v[88:91], v[68:71], v[200:203], v[88:91]
  v_mfma_f32_16x16x32_bf16 v[108:111], v[68:71], v[204:207], v[108:111]
  buffer_load_dwordx4 v[48:51], v21, s[48:51], s4 offen sc1
  v_mfma_f32_16x16x32_bf16 v[128:131], v[68:71], v[248:251], v[128:131]
  v_mfma_f32_16x16x32_bf16 v[148:151], v[68:71], v[24:27], v[148:151]
  s_waitcnt vmcnt(18)
  v_mfma_f32_16x16x32_bf16 v[72:75], v[208:211], v[152:155], v[72:75]
  s_add_u32 s67, s18, 163840
  v_mfma_f32_16x16x32_bf16 v[92:95], v[208:211], v[156:159], v[92:95]
  buffer_load_dwordx4 v[200:203], v20, s[48:51], s67 offen offset:0 sc1
  v_mfma_f32_16x16x32_bf16 v[112:115], v[208:211], v[160:163], v[112:115]
  v_mfma_f32_16x16x32_bf16 v[132:135], v[208:211], v[164:167], v[132:135]
  buffer_load_dwordx4 v[204:207], v20, s[48:51], s67 offen offset:1024 sc1
  v_mfma_f32_16x16x32_bf16 v[76:79], v[212:215], v[152:155], v[76:79]
  v_mfma_f32_16x16x32_bf16 v[96:99], v[212:215], v[156:159], v[96:99]
  buffer_load_dwordx4 v[248:251], v20, s[48:51], s67 offen offset:2048 sc1
  v_mfma_f32_16x16x32_bf16 v[116:119], v[212:215], v[160:163], v[116:119]
  v_mfma_f32_16x16x32_bf16 v[136:139], v[212:215], v[164:167], v[136:139]
  buffer_load_dwordx4 v[24:27], v20, s[48:51], s67 offen offset:3072 sc1
  v_mfma_f32_16x16x32_bf16 v[80:83], v[216:219], v[152:155], v[80:83]
  s_add_u32 s4, s20, 1638400
  v_mfma_f32_16x16x32_bf16 v[100:103], v[216:219], v[156:159], v[100:103]
  buffer_load_dwordx4 v[52:55], v20, s[48:51], s4 offen offset:0 sc1
  v_mfma_f32_16x16x32_bf16 v[120:123], v[216:219], v[160:163], v[120:123]
  v_mfma_f32_16x16x32_bf16 v[140:143], v[216:219], v[164:167], v[140:143]
  buffer_load_dwordx4 v[56:59], v20, s[48:51], s4 offen offset:1024 sc1
  v_mfma_f32_16x16x32_bf16 v[84:87], v[220:223], v[152:155], v[84:87]
  v_mfma_f32_16x16x32_bf16 v[104:107], v[220:223], v[156:159], v[104:107]
  buffer_load_dwordx4 v[60:63], v20, s[48:51], s4 offen offset:2048 sc1
  v_mfma_f32_16x16x32_bf16 v[124:127], v[220:223], v[160:163], v[124:127]
  v_mfma_f32_16x16x32_bf16 v[144:147], v[220:223], v[164:167], v[144:147]
  buffer_load_dwordx4 v[64:67], v20, s[48:51], s4 offen offset:3072 sc1
  v_mfma_f32_16x16x32_bf16 v[88:91], v[224:227], v[152:155], v[88:91]
  v_mfma_f32_16x16x32_bf16 v[108:111], v[224:227], v[156:159], v[108:111]
  buffer_load_dwordx4 v[68:71], v21, s[48:51], s4 offen sc1
  v_mfma_f32_16x16x32_bf16 v[128:131], v[224:227], v[160:163], v[128:131]
  v_mfma_f32_16x16x32_bf16 v[148:151], v[224:227], v[164:167], v[148:151]
  s_waitcnt vmcnt(18)
  s_setprio 1
  v_mfma_f32_16x16x32_bf16 v[72:75], v[228:231], v[168:171], v[72:75]
  s_add_u32 s67, s18, 212992
  v_mfma_f32_16x16x32_bf16 v[92:95], v[228:231], v[172:175], v[92:95]
  buffer_load_dwordx4 v[152:155], v20, s[56:59], s67 offen offset:0 sc1
  v_mfma_f32_16x16x32_bf16 v[112:115], v[228:231], v[176:179], v[112:115]
  v_mfma_f32_16x16x32_bf16 v[132:135], v[228:231], v[180:183], v[132:135]
  buffer_load_dwordx4 v[156:159], v20, s[56:59], s67 offen offset:1024 sc1
  v_mfma_f32_16x16x32_bf16 v[76:79], v[232:235], v[168:171], v[76:79]
  v_mfma_f32_16x16x32_bf16 v[96:99], v[232:235], v[172:175], v[96:99]
  buffer_load_dwordx4 v[160:163], v20, s[56:59], s67 offen offset:2048 sc1
  v_mfma_f32_16x16x32_bf16 v[116:119], v[232:235], v[176:179], v[116:119]
  v_mfma_f32_16x16x32_bf16 v[136:139], v[232:235], v[180:183], v[136:139]
  buffer_load_dwordx4 v[164:167], v20, s[56:59], s67 offen offset:3072 sc1
  v_mfma_f32_16x16x32_bf16 v[80:83], v[236:239], v[168:171], v[80:83]
  s_add_u32 s4, s20, 2129920
  v_mfma_f32_16x16x32_bf16 v[100:103], v[236:239], v[172:175], v[100:103]
  buffer_load_dwordx4 v[208:211], v20, s[56:59], s4 offen offset:0 sc1
  v_mfma_f32_16x16x32_bf16 v[120:123], v[236:239], v[176:179], v[120:123]
  v_mfma_f32_16x16x32_bf16 v[140:143], v[236:239], v[180:183], v[140:143]
  buffer_load_dwordx4 v[212:215], v20, s[56:59], s4 offen offset:1024 sc1
  v_mfma_f32_16x16x32_bf16 v[84:87], v[240:243], v[168:171], v[84:87]
  v_mfma_f32_16x16x32_bf16 v[104:107], v[240:243], v[172:175], v[104:107]
  buffer_load_dwordx4 v[216:219], v20, s[56:59], s4 offen offset:2048 sc1
  v_mfma_f32_16x16x32_bf16 v[124:127], v[240:243], v[176:179], v[124:127]
  v_mfma_f32_16x16x32_bf16 v[144:147], v[240:243], v[180:183], v[144:147]
  buffer_load_dwordx4 v[220:223], v20, s[56:59], s4 offen offset:3072 sc1
  v_mfma_f32_16x16x32_bf16 v[88:91], v[244:247], v[168:171], v[88:91]
  v_mfma_f32_16x16x32_bf16 v[108:111], v[244:247], v[172:175], v[108:111]
  buffer_load_dwordx4 v[224:227], v21, s[56:59], s4 offen sc1
  v_mfma_f32_16x16x32_bf16 v[128:131], v[244:247], v[176:179], v[128:131]
  v_mfma_f32_16x16x32_bf16 v[148:151], v[244:247], v[180:183], v[148:151]
  s_waitcnt vmcnt(18)
  v_mfma_f32_16x16x32_bf16 v[72:75], v[32:35], v[184:187], v[72:75]
  s_add_u32 s67, s18, 180224
  v_mfma_f32_16x16x32_bf16 v[92:95], v[32:35], v[188:191], v[92:95]
  buffer_load_dwordx4 v[168:171], v20, s[48:51], s67 offen offset:0 sc1
  v_mfma_f32_16x16x32_bf16 v[112:115], v[32:35], v[192:195], v[112:115]
  v_mfma_f32_16x16x32_bf16 v[132:135], v[32:35], v[196:199], v[132:135]
  buffer_load_dwordx4 v[172:175], v20, s[48:51], s67 offen offset:1024 sc1
  v_mfma_f32_16x16x32_bf16 v[76:79], v[36:39], v[184:187], v[76:79]
  v_mfma_f32_16x16x32_bf16 v[96:99], v[36:39], v[188:191], v[96:99]
  buffer_load_dwordx4 v[176:179], v20, s[48:51], s67 offen offset:2048 sc1
  v_mfma_f32_16x16x32_bf16 v[116:119], v[36:39], v[192:195], v[116:119]
  v_mfma_f32_16x16x32_bf16 v[136:139], v[36:39], v[196:199], v[136:139]
  buffer_load_dwordx4 v[180:183], v20, s[48:51], s67 offen offset:3072 sc1
  v_mfma_f32_16x16x32_bf16 v[80:83], v[40:43], v[184:187], v[80:83]
  s_add_u32 s4, s20, 1802240
  v_mfma_f32_16x16x32_bf16 v[100:103], v[40:43], v[188:191], v[100:103]
  buffer_load_dwordx4 v[228:231], v20, s[48:51], s4 offen offset:0 sc1
  v_mfma_f32_16x16x32_bf16 v[120:123], v[40:43], v[192:195], v[120:123]
  v_mfma_f32_16x16x32_bf16 v[140:143], v[40:43], v[196:199], v[140:143]
  buffer_load_dwordx4 v[232:235], v20, s[48:51], s4 offen offset:1024 sc1
  v_mfma_f32_16x16x32_bf16 v[84:87], v[44:47], v[184:187], v[84:87]
  v_mfma_f32_16x16x32_bf16 v[104:107], v[44:47], v[188:191], v[104:107]
  buffer_load_dwordx4 v[236:239], v20, s[48:51], s4 offen offset:2048 sc1
  v_mfma_f32_16x16x32_bf16 v[124:127], v[44:47], v[192:195], v[124:127]
  v_mfma_f32_16x16x32_bf16 v[144:147], v[44:47], v[196:199], v[144:147]
  buffer_load_dwordx4 v[240:243], v20, s[48:51], s4 offen offset:3072 sc1
  v_mfma_f32_16x16x32_bf16 v[88:91], v[48:51], v[184:187], v[88:91]
  v_mfma_f32_16x16x32_bf16 v[108:111], v[48:51], v[188:191], v[108:111]
  buffer_load_dwordx4 v[244:247], v21, s[48:51], s4 offen sc1
  v_mfma_f32_16x16x32_bf16 v[128:131], v[48:51], v[192:195], v[128:131]
  v_mfma_f32_16x16x32_bf16 v[148:151], v[48:51], v[196:199], v[148:151]
  s_waitcnt vmcnt(18)
  s_setprio 3
  v_mfma_f32_16x16x32_bf16 v[72:75], v[52:55], v[200:203], v[72:75]
  v_mfma_f32_16x16x32_bf16 v[92:95], v[52:55], v[204:207], v[92:95]
  v_mfma_f32_16x16x32_bf16 v[112:115], v[52:55], v[248:251], v[112:115]
  v_mfma_f32_16x16x32_bf16 v[132:135], v[52:55], v[24:27], v[132:135]
  v_mfma_f32_16x16x32_bf16 v[76:79], v[56:59], v[200:203], v[76:79]
  v_mfma_f32_16x16x32_bf16 v[96:99], v[56:59], v[204:207], v[96:99]
  v_mfma_f32_16x16x32_bf16 v[116:119], v[56:59], v[248:251], v[116:119]
  v_mfma_f32_16x16x32_bf16 v[136:139], v[56:59], v[24:27], v[136:139]
  v_mfma_f32_16x16x32_bf16 v[80:83], v[60:63], v[200:203], v[80:83]
  v_mfma_f32_16x16x32_bf16 v[100:103], v[60:63], v[204:207], v[100:103]
  v_mfma_f32_16x16x32_bf16 v[120:123], v[60:63], v[248:251], v[120:123]
  v_mfma_f32_16x16x32_bf16 v[140:143], v[60:63], v[24:27], v[140:143]
  v_mfma_f32_16x16x32_bf16 v[84:87], v[64:67], v[200:203], v[84:87]
  v_mfma_f32_16x16x32_bf16 v[104:107], v[64:67], v[204:207], v[104:107]
  v_mfma_f32_16x16x32_bf16 v[124:127], v[64:67], v[248:251], v[124:127]
  v_mfma_f32_16x16x32_bf16 v[144:147], v[64:67], v[24:27], v[144:147]
  v_mfma_f32_16x16x32_bf16 v[88:91], v[68:71], v[200:203], v[88:91]
  v_mfma_f32_16x16x32_bf16 v[108:111], v[68:71], v[204:207], v[108:111]
  v_mfma_f32_16x16x32_bf16 v[128:131], v[68:71], v[248:251], v[128:131]
  v_mfma_f32_16x16x32_bf16 v[148:151], v[68:71], v[24:27], v[148:151]
  s_waitcnt vmcnt(9)
  v_mfma_f32_16x16x32_bf16 v[72:75], v[208:211], v[152:155], v[72:75]
  v_mfma_f32_16x16x32_bf16 v[92:95], v[208:211], v[156:159], v[92:95]
  v_mfma_f32_16x16x32_bf16 v[112:115], v[208:211], v[160:163], v[112:115]
  v_mfma_f32_16x16x32_bf16 v[132:135], v[208:211], v[164:167], v[132:135]
  v_mfma_f32_16x16x32_bf16 v[76:79], v[212:215], v[152:155], v[76:79]
  v_mfma_f32_16x16x32_bf16 v[96:99], v[212:215], v[156:159], v[96:99]
  v_mfma_f32_16x16x32_bf16 v[116:119], v[212:215], v[160:163], v[116:119]
  v_mfma_f32_16x16x32_bf16 v[136:139], v[212:215], v[164:167], v[136:139]
  v_mfma_f32_16x16x32_bf16 v[80:83], v[216:219], v[152:155], v[80:83]
  v_mfma_f32_16x16x32_bf16 v[100:103], v[216:219], v[156:159], v[100:103]
  v_mfma_f32_16x16x32_bf16 v[120:123], v[216:219], v[160:163], v[120:123]
  v_mfma_f32_16x16x32_bf16 v[140:143], v[216:219], v[164:167], v[140:143]
  v_mfma_f32_16x16x32_bf16 v[84:87], v[220:223], v[152:155], v[84:87]
  v_mfma_f32_16x16x32_bf16 v[104:107], v[220:223], v[156:159], v[104:107]
  v_mfma_f32_16x16x32_bf16 v[124:127], v[220:223], v[160:163], v[124:127]
  v_mfma_f32_16x16x32_bf16 v[144:147], v[220:223], v[164:167], v[144:147]
  v_mfma_f32_16x16x32_bf16 v[88:91], v[224:227], v[152:155], v[88:91]
  v_mfma_f32_16x16x32_bf16 v[108:111], v[224:227], v[156:159], v[108:111]
  v_mfma_f32_16x16x32_bf16 v[128:131], v[224:227], v[160:163], v[128:131]
  v_mfma_f32_16x16x32_bf16 v[148:151], v[224:227], v[164:167], v[148:151]
P2_GL:
  s_waitcnt vmcnt(0) lgkmcnt(0)
  v_mfma_f32_16x16x32_bf16 v[72:75], v[228:231], v[168:171], v[72:75]
  v_mfma_f32_16x16x32_bf16 v[76:79], v[232:235], v[168:171], v[76:79]
  v_mfma_f32_16x16x32_bf16 v[80:83], v[236:239], v[168:171], v[80:83]
  v_mfma_f32_16x16x32_bf16 v[84:87], v[240:243], v[168:171], v[84:87]
  v_mfma_f32_16x16x32_bf16 v[88:91], v[244:247], v[168:171], v[88:91]
  v_mfma_f32_16x16x32_bf16 v[92:95], v[228:231], v[172:175], v[92:95]
  v_mfma_f32_16x16x32_bf16 v[96:99], v[232:235], v[172:175], v[96:99]
  v_mfma_f32_16x16x32_bf16 v[100:103], v[236:239], v[172:175], v[100:103]
  v_mfma_f32_16x16x32_bf16 v[104:107], v[240:243], v[172:175], v[104:107]
  v_mfma_f32_16x16x32_bf16 v[108:111], v[244:247], v[172:175], v[108:111]
  v_mfma_f32_16x16x32_bf16 v[112:115], v[228:231], v[176:179], v[112:115]
  ds_write_b128 v15, v[72:75] offset:40960
  v_mfma_f32_16x16x32_bf16 v[116:119], v[232:235], v[176:179], v[116:119]
  ds_write_b128 v15, v[76:79] offset:41984
  v_mfma_f32_16x16x32_bf16 v[120:123], v[236:239], v[176:179], v[120:123]
  ds_write_b128 v15, v[80:83] offset:43008
  v_mfma_f32_16x16x32_bf16 v[124:127], v[240:243], v[176:179], v[124:127]
  ds_write_b128 v15, v[84:87] offset:44032
  v_mfma_f32_16x16x32_bf16 v[128:131], v[244:247], v[176:179], v[128:131]
  ds_write_b128 v15, v[88:91] offset:45056
  v_mfma_f32_16x16x32_bf16 v[132:135], v[228:231], v[180:183], v[132:135]
  ds_write_b128 v23, v[92:95] offset:0
  v_mfma_f32_16x16x32_bf16 v[136:139], v[232:235], v[180:183], v[136:139]
  ds_write_b128 v23, v[96:99] offset:1024
  v_mfma_f32_16x16x32_bf16 v[140:143], v[236:239], v[180:183], v[140:143]
  ds_write_b128 v23, v[100:103] offset:2048
  v_mfma_f32_16x16x32_bf16 v[144:147], v[240:243], v[180:183], v[144:147]
  ds_write_b128 v23, v[104:107] offset:3072
  v_mfma_f32_16x16x32_bf16 v[148:151], v[244:247], v[180:183], v[148:151]
  ds_write_b128 v23, v[108:111] offset:4096
  ds_write_b128 v23, v[112:115] offset:20480
  ds_write_b128 v23, v[116:119] offset:21504
  ds_write_b128 v23, v[120:123] offset:22528
  ds_write_b128 v23, v[124:127] offset:23552
  ds_write_b128 v23, v[128:131] offset:24576
  ds_write_b128 v23, v[132:135] offset:40960
  ds_write_b128 v23, v[136:139] offset:41984
  ds_write_b128 v23, v[140:143] offset:43008
  ds_write_b128 v23, v[144:147] offset:44032
  ds_write_b128 v23, v[148:151] offset:45056
  v_mov_b32 v3, 1
  s_waitcnt lgkmcnt(0)
  s_mov_b64 exec, 1
  ds_add_u32 v14, v3 offset:4
  s_mov_b64 exec, -1
  s_branch P2_FIN
P2_C:
  s_setprio 3
  s_cmp_lg_u32 s83, 0
  s_cbranch_scc1 P2_C1
  s_waitcnt vmcnt(0)
  v_readfirstlane_b32 s14, v29
  s_add_u32 s15, s88, 4096
  s_cmp_lg_u32 s14, s7
  s_cbranch_scc1 GO_44
  s_mov_b64 exec, 1
  buffer_store_dword v29, v11, s[48:51], s15 offen sc1
  s_mov_b64 exec, -1
GO_44:
  s_mov_b32 s7, -1
  s_mov_b32 s89, 0x80000
POLL_45:
  buffer_load_dword v3, v11, s[48:51], s78 offen offset:4 sc1
  s_waitcnt vmcnt(0)
  v_cmp_eq_u32 vcc, 0, v3
  s_nop 0
  s_cbranch_vccz POLLD_46
  s_sleep 3
  s_sub_u32 s89, s89, 1
  s_cbranch_scc0 POLL_45
POLLD_46:
  s_lshl3_add_u32 s67, s16, s17
  s_mul_i32 s67, s67, 10240
  s_add_u32 s67, s67, 13631488
  s_lshl_b32 s68, s71, 11
  s_add_u32 s68, s68, s67
  buffer_load_dwordx4 v[176:179], v20, s[48:51], s68 offen offset:0 sc1
  buffer_load_dwordx4 v[180:183], v20, s[48:51], s68 offen offset:1024 sc1
  s_lshr_b32 s68, s71, 1
  s_lshl_b32 s68, s68, 10
  s_add_u32 s67, s67, s68
  s_and_b32 s68, s71, 1
  s_lshl3_add_u32 s67, s68, s67
  s_add_u32 s67, s67, 8192
  buffer_load_dwordx2 v[184:185], v20, s[48:51], s67 offen sc1
  s_waitcnt vmcnt(0)
P2_C1:
  buffer_load_dword v28, v11, s[48:51], s78 offen offset:12 sc1
  s_mov_b32 s40, s34
  s_and_b32 s41, s35, 0xffff
  s_mov_b32 s42, 2621440
  s_mov_b32 s43, 0x20000
  v_lshl_add_u32 v13, v8, 2, v7
  v_lshlrev_b32 v13, 6, v13
  v_lshl_add_u32 v13, v9, 3, v13
  s_mul_i32 s67, s71, 3088
  s_add_u32 s67, s67, 147456
  v_add_u32 v13, s67, v13
  v_mul_u32_u24 v6, 3088, v7
  v_lshl_add_u32 v6, v8, 6, v6
  v_add_u32 v6, 147456, v6
  v_mov_b32 v12, 161288
  v_cmp_eq_u32 vcc, v9, v7
  s_nop 1
  v_cndmask_b32 v12, v12, v6, vcc
  s_add_u32 s67, s71, 0
  s_and_b32 s67, s67, 3
  s_lshl_b32 s67, s67, 10
  v_add_u32 v16, s67, v20
  s_add_u32 s67, s71, 1
  s_and_b32 s67, s67, 3
  s_lshl_b32 s67, s67, 10
  v_add_u32 v17, s67, v20
  s_add_u32 s67, s71, 2
  s_and_b32 s67, s67, 3
  s_lshl_b32 s67, s67, 10
  v_add_u32 v18, s67, v20
  s_add_u32 s67, s71, 3
  s_and_b32 s67, s67, 3
  s_lshl_b32 s67, s67, 10
  v_add_u32 v19, s67, v20
  v_lshlrev_b32 v152, 16, v176
  v_and_b32 v153, 0xffff0000, v176
  v_lshlrev_b32 v154, 16, v177
  v_and_b32 v155, 0xffff0000, v177
  v_lshlrev_b32 v156, 16, v178
  v_and_b32 v157, 0xffff0000, v178
  v_lshlrev_b32 v158, 16, v179
  v_and_b32 v159, 0xffff0000, v179
  v_lshlrev_b32 v160, 16, v180
  v_and_b32 v161, 0xffff0000, v180
  v_lshlrev_b32 v162, 16, v181
  v_and_b32 v163, 0xffff0000, v181
  v_lshlrev_b32 v164, 16, v182
  v_and_b32 v165, 0xffff0000, v182
  v_lshlrev_b32 v166, 16, v183
  v_and_b32 v167, 0xffff0000, v183
  v_lshlrev_b32 v168, 16, v184
  v_and_b32 v169, 0xffff0000, v184
  v_lshlrev_b32 v170, 16, v185
  v_and_b32 v171, 0xffff0000, v185
  v_max3_f32 v132, v152, v153, v154
  v_min3_f32 v134, v152, v153, v154
  v_max3_f32 v132, v132, v155, v156
  v_min3_f32 v134, v134, v155, v156
  v_max3_f32 v132, v132, v157, v158
  v_min3_f32 v134, v134, v157, v158
  v_max3_f32 v132, v132, v159, v160
  v_min3_f32 v134, v134, v159, v160
  v_max3_f32 v132, v132, v161, v162
  v_min3_f32 v134, v134, v161, v162
  v_max3_f32 v132, v132, v163, v164
  v_min3_f32 v134, v134, v163, v164
  v_max3_f32 v132, v132, v165, v166
  v_min3_f32 v134, v134, v165, v166
  v_max3_f32 v132, v132, v167, v168
  v_min3_f32 v134, v134, v167, v168
  v_max3_f32 v132, v132, v169, v170
  v_min3_f32 v134, v134, v169, v170
  v_max_f32 v132, v132, v171
  v_min_f32 v134, v134, v171
  v_mul_f32 v132, s60, v132
  v_mul_f32 v134, s60, v134
  v_pk_fma_f32 v[92:93], v[152:153], s[60:61], v[132:133] op_sel_hi:[1,1,0] neg_lo:[0,0,1] neg_hi:[0,0,1]
  v_pk_fma_f32 v[112:113], v[152:153], s[60:61], v[134:135] op_sel_hi:[1,1,0] neg_lo:[1,0,0] neg_hi:[1,0,0]
  v_pk_fma_f32 v[94:95], v[154:155], s[60:61], v[132:133] op_sel_hi:[1,1,0] neg_lo:[0,0,1] neg_hi:[0,0,1]
  v_pk_fma_f32 v[114:115], v[154:155], s[60:61], v[134:135] op_sel_hi:[1,1,0] neg_lo:[1,0,0] neg_hi:[1,0,0]
  v_pk_fma_f32 v[96:97], v[156:157], s[60:61], v[132:133] op_sel_hi:[1,1,0] neg_lo:[0,0,1] neg_hi:[0,0,1]
  v_pk_fma_f32 v[116:117], v[156:157], s[60:61], v[134:135] op_sel_hi:[1,1,0] neg_lo:[1,0,0] neg_hi:[1,0,0]
  v_pk_fma_f32 v[98:99], v[158:159], s[60:61], v[132:133] op_sel_hi:[1,1,0] neg_lo:[0,0,1] neg_hi:[0,0,1]
  v_pk_fma_f32 v[118:119], v[158:159], s[60:61], v[134:135] op_sel_hi:[1,1,0] neg_lo:[1,0,0] neg_hi:[1,0,0]
  v_pk_fma_f32 v[100:101], v[160:161], s[60:61], v[132:133] op_sel_hi:[1,1,0] neg_lo:[0,0,1] neg_hi:[0,0,1]
  v_pk_fma_f32 v[120:121], v[160:161], s[60:61], v[134:135] op_sel_hi:[1,1,0] neg_lo:[1,0,0] neg_hi:[1,0,0]
  v_pk_fma_f32 v[102:103], v[162:163], s[60:61], v[132:133] op_sel_hi:[1,1,0] neg_lo:[0,0,1] neg_hi:[0,0,1]
  v_pk_fma_f32 v[122:123], v[162:163], s[60:61], v[134:135] op_sel_hi:[1,1,0] neg_lo:[1,0,0] neg_hi:[1,0,0]
  v_pk_fma_f32 v[104:105], v[164:165], s[60:61], v[132:133] op_sel_hi:[1,1,0] neg_lo:[0,0,1] neg_hi:[0,0,1]
  v_pk_fma_f32 v[124:125], v[164:165], s[60:61], v[134:135] op_sel_hi:[1,1,0] neg_lo:[1,0,0] neg_hi:[1,0,0]
  v_pk_fma_f32 v[106:107], v[166:167], s[60:61], v[132:133] op_sel_hi:[1,1,0] neg_lo:[0,0,1] neg_hi:[0,0,1]
  v_pk_fma_f32 v[126:127], v[166:167], s[60:61], v[134:135] op_sel_hi:[1,1,0] neg_lo:[1,0,0] neg_hi:[1,0,0]
  v_pk_fma_f32 v[108:109], v[168:169], s[60:61], v[132:133] op_sel_hi:[1,1,0] neg_lo:[0,0,1] neg_hi:[0,0,1]
  v_pk_fma_f32 v[128:129], v[168:169], s[60:61], v[134:135] op_sel_hi:[1,1,0] neg_lo:[1,0,0] neg_hi:[1,0,0]
  v_pk_fma_f32 v[110:111], v[170:171], s[60:61], v[132:133] op_sel_hi:[1,1,0] neg_lo:[0,0,1] neg_hi:[0,0,1]
  v_pk_fma_f32 v[130:131], v[170:171], s[60:61], v[134:135] op_sel_hi:[1,1,0] neg_lo:[1,0,0] neg_hi:[1,0,0]
  v_exp_f32 v92, v92
  v_exp_f32 v93, v93
  v_exp_f32 v94, v94
  v_exp_f32 v95, v95
  v_exp_f32 v96, v96
  v_exp_f32 v97, v97
  v_exp_f32 v98, v98
  v_exp_f32 v99, v99
  v_exp_f32 v100, v100
  v_exp_f32 v101, v101
  v_exp_f32 v102, v102
  v_exp_f32 v103, v103
  v_exp_f32 v104, v104
  v_exp_f32 v105, v105
  v_exp_f32 v106, v106
  v_exp_f32 v107, v107
  v_exp_f32 v108, v108
  v_exp_f32 v109, v109
  v_exp_f32 v110, v110
  v_exp_f32 v111, v111
  v_exp_f32 v112, v112
  v_exp_f32 v113, v113
  v_exp_f32 v114, v114
  v_exp_f32 v115, v115
  v_exp_f32 v116, v116
  v_exp_f32 v117, v117
  v_exp_f32 v118, v118
  v_exp_f32 v119, v119
  v_exp_f32 v120, v120
  v_exp_f32 v121, v121
  v_exp_f32 v122, v122
  v_exp_f32 v123, v123
  v_exp_f32 v124, v124
  v_exp_f32 v125, v125
  v_exp_f32 v126, v126
  v_exp_f32 v127, v127
  v_exp_f32 v128, v128
  v_exp_f32 v129, v129
  v_exp_f32 v130, v130
  v_exp_f32 v131, v131
  s_waitcnt vmcnt(1)
  v_readfirstlane_b32 s14, v29
  s_add_u32 s15, s88, 4096
  s_cmp_lg_u32 s14, s7
  s_cbranch_scc1 GOC
  s_mov_b64 exec, 1
  buffer_store_dword v29, v11, s[48:51], s15 offen sc1
  s_mov_b64 exec, -1
GOC:
  v_pk_add_f32 v[136:137], v[92:93], v[94:95]
  v_pk_add_f32 v[138:139], v[112:113], v[114:115]
  v_pk_add_f32 v[136:137], v[136:137], v[96:97]
  v_pk_add_f32 v[138:139], v[138:139], v[116:117]
  v_pk_add_f32 v[136:137], v[136:137], v[98:99]
  v_pk_add_f32 v[138:139], v[138:139], v[118:119]
  v_pk_add_f32 v[136:137], v[136:137], v[100:101]
  v_pk_add_f32 v[138:139], v[138:139], v[120:121]
  v_pk_add_f32 v[136:137], v[136:137], v[102:103]
  v_pk_add_f32 v[138:139], v[138:139], v[122:123]
  v_pk_add_f32 v[136:137], v[136:137], v[104:105]
  v_pk_add_f32 v[138:139], v[138:139], v[124:125]
  v_pk_add_f32 v[136:137], v[136:137], v[106:107]
  v_pk_add_f32 v[138:139], v[138:139], v[126:127]
  v_pk_add_f32 v[136:137], v[136:137], v[108:109]
  v_pk_add_f32 v[138:139], v[138:139], v[128:129]
  v_pk_add_f32 v[136:137], v[136:137], v[110:111]
  v_pk_add_f32 v[138:139], v[138:139], v[130:131]
  v_add_f32 v136, v136, v137
  v_add_f32 v138, v138, v139
  v_rcp_f32 v136, v136
  v_rcp_f32 v138, v138
  v_pk_mul_f32 v[92:93], v[92:93], v[136:137] op_sel_hi:[1,0]
  v_pk_mul_f32 v[112:113], v[112:113], v[138:139] op_sel_hi:[1,0]
  v_pk_mul_f32 v[94:95], v[94:95], v[136:137] op_sel_hi:[1,0]
  v_pk_mul_f32 v[114:115], v[114:115], v[138:139] op_sel_hi:[1,0]
  v_pk_mul_f32 v[96:97], v[96:97], v[136:137] op_sel_hi:[1,0]
  v_pk_mul_f32 v[116:117], v[116:117], v[138:139] op_sel_hi:[1,0]
  v_pk_mul_f32 v[98:99], v[98:99], v[136:137] op_sel_hi:[1,0]
  v_pk_mul_f32 v[118:119], v[118:119], v[138:139] op_sel_hi:[1,0]
  v_pk_mul_f32 v[100:101], v[100:101], v[136:137] op_sel_hi:[1,0]
  v_pk_mul_f32 v[120:121], v[120:121], v[138:139] op_sel_hi:[1,0]
  v_pk_mul_f32 v[102:103], v[102:103], v[136:137] op_sel_hi:[1,0]
  v_pk_mul_f32 v[122:123], v[122:123], v[138:139] op_sel_hi:[1,0]
  v_pk_mul_f32 v[104:105], v[104:105], v[136:137] op_sel_hi:[1,0]
  v_pk_mul_f32 v[124:125], v[124:125], v[138:139] op_sel_hi:[1,0]
  v_pk_mul_f32 v[106:107], v[106:107], v[136:137] op_sel_hi:[1,0]
  v_pk_mul_f32 v[126:127], v[126:127], v[138:139] op_sel_hi:[1,0]
  v_pk_mul_f32 v[108:109], v[108:109], v[136:137] op_sel_hi:[1,0]
  v_pk_mul_f32 v[128:129], v[128:129], v[138:139] op_sel_hi:[1,0]
  v_pk_mul_f32 v[110:111], v[110:111], v[136:137] op_sel_hi:[1,0]
  v_pk_mul_f32 v[130:131], v[130:131], v[138:139] op_sel_hi:[1,0]
  v_cvt_pk_bf16_f32 v72, v92, v93
  v_cvt_pk_bf16_f32 v73, v94, v95
  v_cvt_pk_bf16_f32 v74, v96, v97
  v_cvt_pk_bf16_f32 v75, v98, v99
  v_cvt_pk_bf16_f32 v76, v100, v101
  v_cvt_pk_bf16_f32 v77, v102, v103
  v_cvt_pk_bf16_f32 v78, v104, v105
  v_cvt_pk_bf16_f32 v79, v106, v107
  v_cvt_pk_bf16_f32 v80, v108, v109
  v_cvt_pk_bf16_f32 v81, v110, v111
  v_cvt_pk_bf16_f32 v82, v112, v113
  v_cvt_pk_bf16_f32 v83, v114, v115
  v_cvt_pk_bf16_f32 v84, v116, v117
  v_cvt_pk_bf16_f32 v85, v118, v119
  v_cvt_pk_bf16_f32 v86, v120, v121
  v_cvt_pk_bf16_f32 v87, v122, v123
  v_cvt_pk_bf16_f32 v88, v124, v125
  v_cvt_pk_bf16_f32 v89, v126, v127
  v_cvt_pk_bf16_f32 v90, v128, v129
  v_cvt_pk_bf16_f32 v91, v130, v131
  s_waitcnt vmcnt(0)
  v_cmp_ne_u32 vcc, 0, v28
  s_nop 0
  s_cbranch_vccnz P2_GOK
  s_mov_b32 s89, 0x80000
POLL_47:
  buffer_load_dword v3, v11, s[48:51], s78 offen offset:12 sc1
  s_waitcnt vmcnt(0)
  v_cmp_eq_u32 vcc, 0, v3
  s_nop 0
  s_cbranch_vccz POLLD_48
  s_sleep 3
  s_sub_u32 s89, s89, 1
  s_cbranch_scc0 POLL_47
POLLD_48:
P2_GOK:
  v_lshlrev_b32 v2, 2, v10
  s_lshl2_add_u32 s67, s16, s71
  s_lshl_b32 s67, s67, 6
  s_add_u32 s67, s67, 19136512
  buffer_load_dword v5, v2, s[48:51], s67 offen sc1
  v_readfirstlane_b32 s14, v30
  s_nop 0
  s_cmp_lg_u32 s14, 0
  s_cbranch_scc1 INITOK_49
  s_mov_b32 s89, 0x80000
POLL_50:
  v_mov_b32 v30, 0
  buffer_load_dword v30, v30, s[84:87], 0 offen offset:132 sc1
  s_waitcnt vmcnt(0)
  v_readfirstlane_b32 s14, v30
  s_nop 0
  s_cmp_lg_u32 s14, 0
  s_cbranch_scc1 POLLD_51
  s_sleep 2
  s_sub_u32 s89, s89, 1
  s_cbranch_scc0 POLL_50
POLLD_51:
INITOK_49:
LW_52:
  ds_read_b32 v3, v14 offset:16
  s_waitcnt lgkmcnt(0)
  v_readfirstlane_b32 s67, v3
  s_nop 0
  s_cmp_ge_u32 s67, 8
  s_cbranch_scc1 LW_52d
  s_sleep 1
  s_branch LW_52
LW_52d:
  s_lshl_b32 s69, s17, 7
  s_add_u32 s69, s69, 19083264
  s_lshl_b32 s70, s17, 2
  s_add_u32 s70, s70, s71
  s_mul_i32 s70, s70, 6144
  s_add_u32 s70, s70, 18874368
  s_cmp_eq_u32 s8, 0
  s_cbranch_scc1 P2_K2
  s_cmp_lt_u32 s8, 6
  s_cbranch_scc1 P2_K4
  s_mov_b32 s81, 0
  buffer_load_dword v3, v11, s[48:51], s69 offen sc1
  s_waitcnt vmcnt(0)
  v_cmp_ne_u32 vcc, 0, v3
  s_nop 0
  s_cbranch_vccnz P2_KGO
  s_add_u32 s4, s20, 0
  buffer_load_dwordx4 v[208:211], v20, s[48:51], s4 offen offset:0 sc1
  buffer_load_dwordx4 v[212:215], v20, s[48:51], s4 offen offset:1024 sc1
  buffer_load_dwordx4 v[216:219], v20, s[48:51], s4 offen offset:2048 sc1
  buffer_load_dwordx4 v[220:223], v20, s[48:51], s4 offen offset:3072 sc1
  buffer_load_dwordx4 v[224:227], v21, s[48:51], s4 offen sc1
  s_mov_b32 s81, 1
  buffer_load_dword v3, v11, s[48:51], s69 offen sc1
  s_waitcnt vmcnt(0)
  v_cmp_ne_u32 vcc, 0, v3
  s_nop 0
  s_cbranch_vccnz P2_KGO
  s_add_u32 s4, s20, 163840
  buffer_load_dwordx4 v[228:231], v20, s[48:51], s4 offen offset:0 sc1
  buffer_load_dwordx4 v[232:235], v20, s[48:51], s4 offen offset:1024 sc1
  buffer_load_dwordx4 v[236:239], v20, s[48:51], s4 offen offset:2048 sc1
  buffer_load_dwordx4 v[240:243], v20, s[48:51], s4 offen offset:3072 sc1
  buffer_load_dwordx4 v[244:247], v21, s[48:51], s4 offen sc1
P2_K2:
  s_mov_b32 s81, 2
  buffer_load_dword v3, v11, s[48:51], s69 offen sc1
  s_waitcnt vmcnt(0)
  v_cmp_ne_u32 vcc, 0, v3
  s_nop 0
  s_cbranch_vccnz P2_KGO
  s_add_u32 s4, s20, 327680
  buffer_load_dwordx4 v[32:35], v20, s[48:51], s4 offen offset:0 sc1
  buffer_load_dwordx4 v[36:39], v20, s[48:51], s4 offen offset:1024 sc1
  buffer_load_dwordx4 v[40:43], v20, s[48:51], s4 offen offset:2048 sc1
  buffer_load_dwordx4 v[44:47], v20, s[48:51], s4 offen offset:3072 sc1
  buffer_load_dwordx4 v[48:51], v21, s[48:51], s4 offen sc1
  s_mov_b32 s81, 3
  buffer_load_dword v3, v11, s[48:51], s69 offen sc1
  s_waitcnt vmcnt(0)
  v_cmp_ne_u32 vcc, 0, v3
  s_nop 0
  s_cbranch_vccnz P2_KGO
  s_add_u32 s4, s20, 491520
  buffer_load_dwordx4 v[52:55], v20, s[48:51], s4 offen offset:0 sc1
  buffer_load_dwordx4 v[56:59], v20, s[48:51], s4 offen offset:1024 sc1
  buffer_load_dwordx4 v[60:63], v20, s[48:51], s4 offen offset:2048 sc1
  buffer_load_dwordx4 v[64:67], v20, s[48:51], s4 offen offset:3072 sc1
  buffer_load_dwordx4 v[68:71], v21, s[48:51], s4 offen sc1
P2_K4:
  s_mov_b32 s81, 4
  s_mov_b32 s89, 0x80000
POLL_53:
  buffer_load_dword v3, v11, s[48:51], s69 offen offset:0 sc1
  s_waitcnt vmcnt(0)
  v_cmp_eq_u32 vcc, 0, v3
  s_nop 0
  s_cbranch_vccz POLLD_54
  s_sleep 3
  s_sub_u32 s89, s89, 1
  s_cbranch_scc0 POLL_53
POLLD_54:
P2_KGO:
  s_mov_b32 s89, 0x80000
  s_mov_b32 s82, 0x41000000
KVRETRY:
  buffer_load_dwordx4 v[92:95], v20, s[48:51], s70 offen offset:0 sc1
  buffer_load_dwordx4 v[96:99], v20, s[48:51], s70 offen offset:1024 sc1
  buffer_load_dwordx4 v[100:103], v20, s[48:51], s70 offen offset:2048 sc1
  buffer_load_dwordx4 v[104:107], v20, s[48:51], s70 offen offset:3072 sc1
  buffer_load_dwordx4 v[108:111], v21, s[48:51], s70 offen offset:0 sc1
  buffer_load_dwordx4 v[112:115], v21, s[48:51], s70 offen offset:1024 sc1
  s_waitcnt vmcnt(5)
  v_cvt_pk_bf16_f32 v92, v92, v93
  v_cvt_pk_bf16_f32 v93, v94, v95
  ds_write_b64 v13, v[92:93] offset:0
  s_waitcnt vmcnt(4)
  v_cvt_pk_bf16_f32 v96, v96, v97
  v_cvt_pk_bf16_f32 v97, v98, v99
  ds_write_b64 v13, v[96:97] offset:1024
  s_waitcnt vmcnt(3)
  v_cvt_pk_bf16_f32 v100, v100, v101
  v_cvt_pk_bf16_f32 v101, v102, v103
  ds_write_b64 v13, v[100:101] offset:2048
  s_waitcnt vmcnt(2)
  v_cvt_pk_bf16_f32 v104, v104, v105
  v_cvt_pk_bf16_f32 v105, v106, v107
  ds_write_b64 v13, v[104:105] offset:32
  s_waitcnt vmcnt(1)
  v_cvt_pk_bf16_f32 v108, v108, v109
  v_cvt_pk_bf16_f32 v109, v110, v111
  ds_write_b64 v13, v[108:109] offset:1056
  s_waitcnt vmcnt(0)
  v_cvt_pk_bf16_f32 v112, v112, v113
  v_cvt_pk_bf16_f32 v113, v114, v115
  ds_write_b64 v13, v[112:113] offset:2080
  v_min3_f32 v3, v95, v99, v107
  v_min_f32 v6, v103, v115
  v_min_f32 v3, v3, v111
  v_cmp_neq_f32 vcc, s82, v6
  v_cmp_neq_f32 s[14:15], s82, v3
  s_and_b32 s4, vcc_lo, 0x00880088
  s_and_b32 s5, vcc_hi, 0x00880088
  s_or_b32 s4, s4, s5
  s_or_b32 s5, s14, s15
  s_and_b32 s5, s5, 0x88888888
  s_or_b32 s4, s4, s5
  s_cbranch_scc0 KVOK
  s_waitcnt lgkmcnt(0)
  s_sleep 4
  s_sub_u32 s89, s89, 1
  s_cbranch_scc0 KVRETRY
KVOK:
  v_mov_b32 v3, 1
  s_waitcnt lgkmcnt(0)
  s_mov_b64 exec, 1
  ds_add_u32 v14, v3 offset:0
  s_mov_b64 exec, -1
LW_55:
  ds_read_b32 v3, v14 offset:0
  s_waitcnt lgkmcnt(0)
  v_readfirstlane_b32 s67, v3
  s_nop 0
  s_cmp_ge_u32 s67, 4
  s_cbranch_scc1 LW_55d
  s_sleep 1
  s_branch LW_55
LW_55d:
  ds_read_b64_tr_b16 v[92:93], v12 offset:48
  ds_read_b64_tr_b16 v[94:95], v12 offset:304
  ds_read_b64_tr_b16 v[96:97], v12 offset:0
  ds_read_b64_tr_b16 v[98:99], v12 offset:256
  ds_read_b64_tr_b16 v[100:101], v12 offset:8
  ds_read_b64_tr_b16 v[102:103], v12 offset:264
  ds_read_b64_tr_b16 v[104:105], v12 offset:16
  ds_read_b64_tr_b16 v[106:107], v12 offset:272
  ds_read_b64_tr_b16 v[108:109], v12 offset:32
  ds_read_b64_tr_b16 v[110:111], v12 offset:288
  ds_read_b64_tr_b16 v[112:113], v12 offset:40
  ds_read_b64_tr_b16 v[114:115], v12 offset:296
  ds_read_b64_tr_b16 v[116:117], v12 offset:560
  ds_read_b64_tr_b16 v[118:119], v12 offset:816
  s_waitcnt lgkmcnt(12)
  v_mfma_f32_16x16x32_bf16 v[172:175], v[92:95], v[72:75], 0
  ds_read_b64_tr_b16 v[120:121], v12 offset:512
  ds_read_b64_tr_b16 v[122:123], v12 offset:768
  s_waitcnt lgkmcnt(12)
  v_mfma_f32_16x16x32_bf16 v[152:155], v[96:99], v[72:75], 0
  ds_read_b64_tr_b16 v[124:125], v12 offset:520
  ds_read_b64_tr_b16 v[126:127], v12 offset:776
  s_waitcnt lgkmcnt(12)
  v_mfma_f32_16x16x32_bf16 v[156:159], v[100:103], v[72:75], 0
  ds_read_b64_tr_b16 v[128:129], v12 offset:528
  ds_read_b64_tr_b16 v[130:131], v12 offset:784
  s_waitcnt lgkmcnt(12)
  v_mfma_f32_16x16x32_bf16 v[160:163], v[104:107], v[72:75], 0
  ds_read_b64_tr_b16 v[132:133], v12 offset:544
  ds_read_b64_tr_b16 v[134:135], v12 offset:800
  s_waitcnt lgkmcnt(12)
  v_mfma_f32_16x16x32_bf16 v[164:167], v[108:111], v[72:75], 0
  ds_read_b64_tr_b16 v[136:137], v12 offset:552
  ds_read_b64_tr_b16 v[138:139], v12 offset:808
  s_waitcnt lgkmcnt(12)
  v_mfma_f32_16x16x32_bf16 v[168:171], v[112:115], v[72:75], 0
  ds_read_b64_tr_b16 v[140:141], v12 offset:1072
  ds_read_b64_tr_b16 v[142:143], v12 offset:1328
  s_waitcnt lgkmcnt(12)
  v_mfma_f32_16x16x32_bf16 v[172:175], v[116:119], v[76:79], v[172:175]
  ds_read_b64_tr_b16 v[144:145], v12 offset:1024
  ds_read_b64_tr_b16 v[146:147], v12 offset:1280
  s_waitcnt lgkmcnt(12)
  v_mfma_f32_16x16x32_bf16 v[152:155], v[120:123], v[76:79], v[152:155]
  ds_read_b64_tr_b16 v[148:149], v12 offset:1032
  ds_read_b64_tr_b16 v[150:151], v12 offset:1288
  s_waitcnt lgkmcnt(12)
  v_mfma_f32_16x16x32_bf16 v[156:159], v[124:127], v[76:79], v[156:159]
  ds_read_b64_tr_b16 v[92:93], v12 offset:1040
  ds_read_b64_tr_b16 v[94:95], v12 offset:1296
  s_waitcnt lgkmcnt(12)
  v_mfma_f32_16x16x32_bf16 v[160:163], v[128:131], v[76:79], v[160:163]
  ds_read_b64_tr_b16 v[96:97], v12 offset:1056
  ds_read_b64_tr_b16 v[98:99], v12 offset:1312
  s_waitcnt lgkmcnt(12)
  v_mfma_f32_16x16x32_bf16 v[164:167], v[132:135], v[76:79], v[164:167]
  ds_read_b64_tr_b16 v[100:101], v12 offset:1064
  ds_read_b64_tr_b16 v[102:103], v12 offset:1320
  s_waitcnt lgkmcnt(12)
  v_mfma_f32_16x16x32_bf16 v[168:171], v[136:139], v[76:79], v[168:171]
  ds_read_b64_tr_b16 v[104:105], v12 offset:1584
  ds_read_b64_tr_b16 v[106:107], v12 offset:1840
  s_waitcnt lgkmcnt(12)
  v_mfma_f32_16x16x32_bf16 v[172:175], v[140:143], v[80:83], v[172:175]
  ds_read_b64_tr_b16 v[108:109], v12 offset:1536
  ds_read_b64_tr_b16 v[110:111], v12 offset:1792
  s_waitcnt lgkmcnt(12)
  v_mfma_f32_16x16x32_bf16 v[152:155], v[144:147], v[80:83], v[152:155]
  ds_read_b64_tr_b16 v[112:113], v12 offset:1544
  ds_read_b64_tr_b16 v[114:115], v12 offset:1800
  s_waitcnt lgkmcnt(12)
  v_mfma_f32_16x16x32_bf16 v[156:159], v[148:151], v[80:83], v[156:159]
  ds_read_b64_tr_b16 v[116:117], v12 offset:1552
  ds_read_b64_tr_b16 v[118:119], v12 offset:1808
  s_waitcnt lgkmcnt(12)
  v_mfma_f32_16x16x32_bf16 v[160:163], v[92:95], v[80:83], v[160:163]
  ds_read_b64_tr_b16 v[120:121], v12 offset:1568
  ds_read_b64_tr_b16 v[122:123], v12 offset:1824
  s_waitcnt lgkmcnt(12)
  v_mfma_f32_16x16x32_bf16 v[164:167], v[96:99], v[80:83], v[164:167]
  ds_read_b64_tr_b16 v[124:125], v12 offset:1576
  ds_read_b64_tr_b16 v[126:127], v12 offset:1832
  s_waitcnt lgkmcnt(12)
  v_mfma_f32_16x16x32_bf16 v[168:171], v[100:103], v[80:83], v[168:171]
  ds_read_b64_tr_b16 v[128:129], v12 offset:2096
  ds_read_b64_tr_b16 v[130:131], v12 offset:2352
  s_waitcnt lgkmcnt(12)
  v_mfma_f32_16x16x32_bf16 v[172:175], v[104:107], v[84:87], v[172:175]
  ds_read_b64_tr_b16 v[132:133], v12 offset:2048
  ds_read_b64_tr_b16 v[134:135], v12 offset:2304
  s_waitcnt lgkmcnt(12)
  v_mfma_f32_16x16x32_bf16 v[152:155], v[108:111], v[84:87], v[152:155]
  ds_read_b64_tr_b16 v[136:137], v12 offset:2056
  ds_read_b64_tr_b16 v[138:139], v12 offset:2312
  s_waitcnt lgkmcnt(12)
  v_mfma_f32_16x16x32_bf16 v[156:159], v[112:115], v[84:87], v[156:159]
  ds_read_b64_tr_b16 v[140:141], v12 offset:2064
  ds_read_b64_tr_b16 v[142:143], v12 offset:2320
  s_waitcnt lgkmcnt(12)
  v_mfma_f32_16x16x32_bf16 v[160:163], v[116:119], v[84:87], v[160:163]
  ds_read_b64_tr_b16 v[144:145], v12 offset:2080
  ds_read_b64_tr_b16 v[146:147], v12 offset:2336
  s_waitcnt lgkmcnt(12)
  v_mfma_f32_16x16x32_bf16 v[164:167], v[120:123], v[84:87], v[164:167]
  ds_read_b64_tr_b16 v[148:149], v12 offset:2088
  ds_read_b64_tr_b16 v[150:151], v12 offset:2344
  s_waitcnt lgkmcnt(12)
  v_mfma_f32_16x16x32_bf16 v[168:171], v[124:127], v[84:87], v[168:171]
  s_waitcnt lgkmcnt(10)
  v_mfma_f32_16x16x32_bf16 v[172:175], v[128:131], v[88:91], v[172:175]
  s_waitcnt lgkmcnt(8)
  v_mfma_f32_16x16x32_bf16 v[152:155], v[132:135], v[88:91], v[152:155]
  s_waitcnt lgkmcnt(6)
  v_mfma_f32_16x16x32_bf16 v[156:159], v[136:139], v[88:91], v[156:159]
  s_waitcnt lgkmcnt(4)
  v_mfma_f32_16x16x32_bf16 v[160:163], v[140:143], v[88:91], v[160:163]
  s_waitcnt lgkmcnt(2)
  v_mfma_f32_16x16x32_bf16 v[164:167], v[144:147], v[88:91], v[164:167]
  s_waitcnt lgkmcnt(0)
  v_mfma_f32_16x16x32_bf16 v[168:171], v[148:151], v[88:91], v[168:171]
  v_add_f32 v4, 0x358637bd, v172
  v_rcp_f32 v4, v4
  s_nop 0
  v_mul_f32 v4, v4, v5
  v_mul_f32 v152, v152, v4
  v_mul_f32 v153, v153, v4
  v_mul_f32 v154, v154, v4
  v_mul_f32 v155, v155, v4
  v_cvt_pk_bf16_f32 v176, v152, v153
  v_cvt_pk_bf16_f32 v177, v154, v155
  v_mul_f32 v156, v156, v4
  v_mul_f32 v157, v157, v4
  v_mul_f32 v158, v158, v4
  v_mul_f32 v159, v159, v4
  v_cvt_pk_bf16_f32 v178, v156, v157
  v_cvt_pk_bf16_f32 v179, v158, v159
  buffer_store_dwordx4 v[176:179], v20, s[48:51], s79 offen sc1
  v_mul_f32 v160, v160, v4
  v_mul_f32 v161, v161, v4
  v_mul_f32 v162, v162, v4
  v_mul_f32 v163, v163, v4
  v_cvt_pk_bf16_f32 v180, v160, v161
  v_cvt_pk_bf16_f32 v181, v162, v163
  v_mul_f32 v164, v164, v4
  v_mul_f32 v165, v165, v4
  v_mul_f32 v166, v166, v4
  v_mul_f32 v167, v167, v4
  v_cvt_pk_bf16_f32 v182, v164, v165
  v_cvt_pk_bf16_f32 v183, v166, v167
  buffer_store_dwordx4 v[180:183], v21, s[48:51], s79 offen sc1
  v_mul_f32 v168, v168, v4
  v_mul_f32 v169, v169, v4
  v_mul_f32 v170, v170, v4
  v_mul_f32 v171, v171, v4
  v_cvt_pk_bf16_f32 v184, v168, v169
  v_cvt_pk_bf16_f32 v185, v170, v171
  v_mov_b32 v186, v184
  v_mov_b32 v187, v185
  s_nop 0
  v_permlane32_swap_b32 v184, v186
  v_permlane32_swap_b32 v185, v187
  s_mov_b32 exec_hi, 0
  buffer_store_dwordx4 v[184:187], v20, s[48:51], s80 offen sc1
  s_mov_b32 exec_hi, -1
  s_sub_u32 s69, s78, 4088
  v_mov_b32 v2, 0
  v_mov_b32 v3, 1
  s_waitcnt vmcnt(0)
  s_mov_b64 exec, 1
  buffer_atomic_add v3, v2, s[48:51], s69 offen sc0 sc1
  s_waitcnt vmcnt(0)
  v_readfirstlane_b32 s14, v3
  s_add_u32 s15, s69, 4096
  s_cmp_lg_u32 s14, 31
  s_cbranch_scc1 ARR_56
  buffer_store_dword v3, v2, s[48:51], s15 offen sc1
ARR_56:
  s_mov_b64 exec, -1
  s_cmp_gt_u32 s81, 0
  s_cbranch_scc1 CB_57
  s_add_u32 s4, s20, 0
  buffer_load_dwordx4 v[208:211], v20, s[48:51], s4 offen offset:0 sc1
  buffer_load_dwordx4 v[212:215], v20, s[48:51], s4 offen offset:1024 sc1
  buffer_load_dwordx4 v[216:219], v20, s[48:51], s4 offen offset:2048 sc1
  buffer_load_dwordx4 v[220:223], v20, s[48:51], s4 offen offset:3072 sc1
  buffer_load_dwordx4 v[224:227], v21, s[48:51], s4 offen sc1
CB_57:
  s_cmp_gt_u32 s81, 1
  s_cbranch_scc1 CB_58
  s_add_u32 s4, s20, 163840
  buffer_load_dwordx4 v[228:231], v20, s[48:51], s4 offen offset:0 sc1
  buffer_load_dwordx4 v[232:235], v20, s[48:51], s4 offen offset:1024 sc1
  buffer_load_dwordx4 v[236:239], v20, s[48:51], s4 offen offset:2048 sc1
  buffer_load_dwordx4 v[240:243], v20, s[48:51], s4 offen offset:3072 sc1
  buffer_load_dwordx4 v[244:247], v21, s[48:51], s4 offen sc1
CB_58:
  s_cmp_gt_u32 s81, 2
  s_cbranch_scc1 CB_59
  s_add_u32 s4, s20, 327680
  buffer_load_dwordx4 v[32:35], v20, s[48:51], s4 offen offset:0 sc1
  buffer_load_dwordx4 v[36:39], v20, s[48:51], s4 offen offset:1024 sc1
  buffer_load_dwordx4 v[40:43], v20, s[48:51], s4 offen offset:2048 sc1
  buffer_load_dwordx4 v[44:47], v20, s[48:51], s4 offen offset:3072 sc1
  buffer_load_dwordx4 v[48:51], v21, s[48:51], s4 offen sc1
CB_59:
  s_cmp_gt_u32 s81, 3
  s_cbranch_scc1 CB_60
  s_add_u32 s4, s20, 491520
  buffer_load_dwordx4 v[52:55], v20, s[48:51], s4 offen offset:0 sc1
  buffer_load_dwordx4 v[56:59], v20, s[48:51], s4 offen offset:1024 sc1
  buffer_load_dwordx4 v[60:63], v20, s[48:51], s4 offen offset:2048 sc1
  buffer_load_dwordx4 v[64:67], v20, s[48:51], s4 offen offset:3072 sc1
  buffer_load_dwordx4 v[68:71], v21, s[48:51], s4 offen sc1
CB_60:
  s_sub_u32 s67, s71, 1
  s_and_b32 s67, s67, 3
  s_mul_i32 s67, s67, 5120
  s_add_u32 s67, s67, 0
  v_add_u32 v28, s67, v20
  s_sub_u32 s67, s71, 2
  s_and_b32 s67, s67, 3
  s_mul_i32 s67, s67, 5120
  s_add_u32 s67, s67, 20480
  v_add_u32 v13, s67, v20
  s_sub_u32 s67, s71, 3
  s_and_b32 s67, s67, 3
  s_mul_i32 s67, s67, 5120
  s_add_u32 s67, s67, 122880
  v_add_u32 v30, s67, v20
  v_add_u32 v31, 122880, v15
  s_add_u32 s67, s71, 2
  s_mul_i32 s67, s67, 20480
  v_add_u32 v12, s67, v20
  v_mul_u32_u24 v2, 1280, v10
  v_lshl_add_u32 v2, v7, 3, v2
  s_lshl_b32 s69, s16, 2
  s_add_u32 s69, s69, s71
  s_mul_i32 s69, s69, 20480
  s_mul_i32 s70, s17, 160
  s_add_u32 s69, s69, s70
  v_add_f32 v22, 1.0, v5
  v_rcp_f32 v22, v22
  v_mul_u32_u24 v5, 1280, v10
  v_and_b32 v6, 1, v7
  v_lshl_add_u32 v5, v6, 5, v5
  v_lshrrev_b32 v6, 1, v7
  v_lshl_add_u32 v5, v6, 4, v5
LW_61:
  ds_read_b32 v3, v14 offset:20
  s_waitcnt lgkmcnt(0)
  v_readfirstlane_b32 s67, v3
  s_nop 0
  s_cmp_ge_u32 s67, 4
  s_cbranch_scc1 LW_61d
  s_sleep 1
  s_branch LW_61
LW_61d:
  s_setprio 3
  s_add_u32 s67, s18, 0
  s_nop 0
  buffer_load_dwordx4 v[152:155], v16, s[48:51], s67 offen sc1
  buffer_load_dwordx4 v[156:159], v17, s[48:51], s67 offen sc1
  buffer_load_dwordx4 v[160:163], v18, s[48:51], s67 offen sc1
  buffer_load_dwordx4 v[164:167], v19, s[48:51], s67 offen sc1
  s_add_u32 s67, s18, 16384
  buffer_load_dwordx4 v[168:171], v16, s[48:51], s67 offen sc1
  buffer_load_dwordx4 v[172:175], v17, s[48:51], s67 offen sc1
  buffer_load_dwordx4 v[176:179], v18, s[48:51], s67 offen sc1
  buffer_load_dwordx4 v[180:183], v19, s[48:51], s67 offen sc1
  s_add_u32 s67, s18, 32768
  buffer_load_dwordx4 v[184:187], v16, s[48:51], s67 offen sc1
  buffer_load_dwordx4 v[188:191], v17, s[48:51], s67 offen sc1
  buffer_load_dwordx4 v[192:195], v18, s[48:51], s67 offen sc1
  buffer_load_dwordx4 v[196:199], v19, s[48:51], s67 offen sc1
  s_add_u32 s67, s18, 49152
  buffer_load_dwordx4 v[200:203], v16, s[48:51], s67 offen sc1
  buffer_load_dwordx4 v[204:207], v17, s[48:51], s67 offen sc1
  buffer_load_dwordx4 v[248:251], v18, s[48:51], s67 offen sc1
  buffer_load_dwordx4 v[24:27], v19, s[48:51], s67 offen sc1
  s_waitcnt vmcnt(12)
  s_setprio 1
  v_mfma_f32_16x16x32_bf16 v[72:75], v[208:211], v[152:155], 0
  v_mfma_f32_16x16x32_bf16 v[92:95], v[208:211], v[156:159], 0
  v_mfma_f32_16x16x32_bf16 v[112:115], v[208:211], v[160:163], 0
  v_mfma_f32_16x16x32_bf16 v[132:135], v[208:211], v[164:167], 0
  v_mfma_f32_16x16x32_bf16 v[76:79], v[212:215], v[152:155], 0
  v_mfma_f32_16x16x32_bf16 v[96:99], v[212:215], v[156:159], 0
  v_mfma_f32_16x16x32_bf16 v[116:119], v[212:215], v[160:163], 0
  v_mfma_f32_16x16x32_bf16 v[136:139], v[212:215], v[164:167], 0
  v_mfma_f32_16x16x32_bf16 v[80:83], v[216:219], v[152:155], 0
  v_mfma_f32_16x16x32_bf16 v[100:103], v[216:219], v[156:159], 0
  v_mfma_f32_16x16x32_bf16 v[120:123], v[216:219], v[160:163], 0
  v_mfma_f32_16x16x32_bf16 v[140:143], v[216:219], v[164:167], 0
  v_mfma_f32_16x16x32_bf16 v[84:87], v[220:223], v[152:155], 0
  v_mfma_f32_16x16x32_bf16 v[104:107], v[220:223], v[156:159], 0
  v_mfma_f32_16x16x32_bf16 v[124:127], v[220:223], v[160:163], 0
  v_mfma_f32_16x16x32_bf16 v[144:147], v[220:223], v[164:167], 0
  v_mfma_f32_16x16x32_bf16 v[88:91], v[224:227], v[152:155], 0
  v_mfma_f32_16x16x32_bf16 v[108:111], v[224:227], v[156:159], 0
  v_mfma_f32_16x16x32_bf16 v[128:131], v[224:227], v[160:163], 0
  v_mfma_f32_16x16x32_bf16 v[148:151], v[224:227], v[164:167], 0
  s_waitcnt vmcnt(8)
  v_mfma_f32_16x16x32_bf16 v[72:75], v[228:231], v[168:171], v[72:75]
  v_mfma_f32_16x16x32_bf16 v[92:95], v[228:231], v[172:175], v[92:95]
  buffer_load_dword v4, v11, s[48:51], s78 offen offset:8 sc1
  v_mfma_f32_16x16x32_bf16 v[112:115], v[228:231], v[176:179], v[112:115]
  v_mfma_f32_16x16x32_bf16 v[132:135], v[228:231], v[180:183], v[132:135]
  ds_read_b128 v[208:211], v15 offset:0
  v_mfma_f32_16x16x32_bf16 v[76:79], v[232:235], v[168:171], v[76:79]
  v_mfma_f32_16x16x32_bf16 v[96:99], v[232:235], v[172:175], v[96:99]
  ds_read_b128 v[212:215], v15 offset:1024
  v_mfma_f32_16x16x32_bf16 v[116:119], v[232:235], v[176:179], v[116:119]
  v_mfma_f32_16x16x32_bf16 v[136:139], v[232:235], v[180:183], v[136:139]
  ds_read_b128 v[216:219], v15 offset:2048
  v_mfma_f32_16x16x32_bf16 v[80:83], v[236:239], v[168:171], v[80:83]
  v_mfma_f32_16x16x32_bf16 v[100:103], v[236:239], v[172:175], v[100:103]
  ds_read_b128 v[220:223], v15 offset:3072
  v_mfma_f32_16x16x32_bf16 v[120:123], v[236:239], v[176:179], v[120:123]
  v_mfma_f32_16x16x32_bf16 v[140:143], v[236:239], v[180:183], v[140:143]
  ds_read_b128 v[224:227], v15 offset:4096
  v_mfma_f32_16x16x32_bf16 v[84:87], v[240:243], v[168:171], v[84:87]
  v_mfma_f32_16x16x32_bf16 v[104:107], v[240:243], v[172:175], v[104:107]
  v_mfma_f32_16x16x32_bf16 v[124:127], v[240:243], v[176:179], v[124:127]
  v_mfma_f32_16x16x32_bf16 v[144:147], v[240:243], v[180:183], v[144:147]
  v_mfma_f32_16x16x32_bf16 v[88:91], v[244:247], v[168:171], v[88:91]
  v_mfma_f32_16x16x32_bf16 v[108:111], v[244:247], v[172:175], v[108:111]
  v_mfma_f32_16x16x32_bf16 v[128:131], v[244:247], v[176:179], v[128:131]
  v_mfma_f32_16x16x32_bf16 v[148:151], v[244:247], v[180:183], v[148:151]
  s_waitcnt vmcnt(0)
  v_cmp_ne_u32 vcc, 0, v4
  s_nop 0
  s_cbranch_vccnz P2_OOK
  s_mov_b32 s89, 0x80000
POLL_62:
  buffer_load_dword v4, v11, s[48:51], s78 offen offset:8 sc1
  s_waitcnt vmcnt(0)
  v_cmp_eq_u32 vcc, 0, v4
  s_nop 0
  s_cbranch_vccz POLLD_63
  s_sleep 3
  s_sub_u32 s89, s89, 1
  s_cbranch_scc0 POLL_62
POLLD_63:
P2_OOK:
  s_mov_b32 s89, 0x40000
  v_mfma_f32_16x16x32_bf16 v[72:75], v[32:35], v[184:187], v[72:75]
  s_add_u32 s67, s18, 155648
  buffer_load_dwordx4 v[152:155], v16, s[48:51], s67 offen sc1
  v_mfma_f32_16x16x32_bf16 v[92:95], v[32:35], v[188:191], v[92:95]
  buffer_load_dwordx4 v[156:159], v17, s[48:51], s67 offen sc1
  v_mfma_f32_16x16x32_bf16 v[112:115], v[32:35], v[192:195], v[112:115]
  buffer_load_dwordx4 v[160:163], v18, s[48:51], s67 offen sc1
  v_mfma_f32_16x16x32_bf16 v[132:135], v[32:35], v[196:199], v[132:135]
  buffer_load_dwordx4 v[164:167], v19, s[48:51], s67 offen sc1
  v_mfma_f32_16x16x32_bf16 v[76:79], v[36:39], v[184:187], v[76:79]
  s_add_u32 s67, s18, 172032
  buffer_load_dwordx4 v[168:171], v16, s[48:51], s67 offen sc1
  v_mfma_f32_16x16x32_bf16 v[96:99], v[36:39], v[188:191], v[96:99]
  buffer_load_dwordx4 v[172:175], v17, s[48:51], s67 offen sc1
  v_mfma_f32_16x16x32_bf16 v[116:119], v[36:39], v[192:195], v[116:119]
  buffer_load_dwordx4 v[176:179], v18, s[48:51], s67 offen sc1
  v_mfma_f32_16x16x32_bf16 v[136:139], v[36:39], v[196:199], v[136:139]
  buffer_load_dwordx4 v[180:183], v19, s[48:51], s67 offen sc1
  v_mfma_f32_16x16x32_bf16 v[80:83], v[40:43], v[184:187], v[80:83]
  ds_read_b128 v[228:231], v15 offset:20480
  v_mfma_f32_16x16x32_bf16 v[100:103], v[40:43], v[188:191], v[100:103]
  ds_read_b128 v[232:235], v15 offset:21504
  v_mfma_f32_16x16x32_bf16 v[120:123], v[40:43], v[192:195], v[120:123]
  ds_read_b128 v[236:239], v15 offset:22528
  v_mfma_f32_16x16x32_bf16 v[140:143], v[40:43], v[196:199], v[140:143]
  ds_read_b128 v[240:243], v15 offset:23552
  v_mfma_f32_16x16x32_bf16 v[84:87], v[44:47], v[184:187], v[84:87]
  ds_read_b128 v[244:247], v15 offset:24576
  v_mfma_f32_16x16x32_bf16 v[104:107], v[44:47], v[188:191], v[104:107]
  v_mfma_f32_16x16x32_bf16 v[124:127], v[44:47], v[192:195], v[124:127]
  v_mfma_f32_16x16x32_bf16 v[144:147], v[44:47], v[196:199], v[144:147]
  v_mfma_f32_16x16x32_bf16 v[88:91], v[48:51], v[184:187], v[88:91]
  v_mfma_f32_16x16x32_bf16 v[108:111], v[48:51], v[188:191], v[108:111]
  v_mfma_f32_16x16x32_bf16 v[128:131], v[48:51], v[192:195], v[128:131]
  v_mfma_f32_16x16x32_bf16 v[148:151], v[48:51], v[196:199], v[148:151]
  s_waitcnt vmcnt(8)
  v_mfma_f32_16x16x32_bf16 v[72:75], v[52:55], v[200:203], v[72:75]
  s_add_u32 s67, s18, 188416
  v_mfma_f32_16x16x32_bf16 v[92:95], v[52:55], v[204:207], v[92:95]
  buffer_load_dwordx4 v[184:187], v16, s[48:51], s67 offen sc1
  v_mfma_f32_16x16x32_bf16 v[112:115], v[52:55], v[248:251], v[112:115]
  v_mfma_f32_16x16x32_bf16 v[132:135], v[52:55], v[24:27], v[132:135]
  buffer_load_dwordx4 v[188:191], v17, s[48:51], s67 offen sc1
  v_mfma_f32_16x16x32_bf16 v[76:79], v[56:59], v[200:203], v[76:79]
  v_mfma_f32_16x16x32_bf16 v[96:99], v[56:59], v[204:207], v[96:99]
  buffer_load_dwordx4 v[192:195], v18, s[48:51], s67 offen sc1
  v_mfma_f32_16x16x32_bf16 v[116:119], v[56:59], v[248:251], v[116:119]
  v_mfma_f32_16x16x32_bf16 v[136:139], v[56:59], v[24:27], v[136:139]
  buffer_load_dwordx4 v[196:199], v19, s[48:51], s67 offen sc1
  v_mfma_f32_16x16x32_bf16 v[80:83], v[60:63], v[200:203], v[80:83]
  v_mfma_f32_16x16x32_bf16 v[100:103], v[60:63], v[204:207], v[100:103]
  ds_read_b128 v[32:35], v31 offset:0
  v_mfma_f32_16x16x32_bf16 v[120:123], v[60:63], v[248:251], v[120:123]
  v_mfma_f32_16x16x32_bf16 v[140:143], v[60:63], v[24:27], v[140:143]
  ds_read_b128 v[36:39], v31 offset:1024
  v_mfma_f32_16x16x32_bf16 v[84:87], v[64:67], v[200:203], v[84:87]
  v_mfma_f32_16x16x32_bf16 v[104:107], v[64:67], v[204:207], v[104:107]
  ds_read_b128 v[40:43], v31 offset:2048
  v_mfma_f32_16x16x32_bf16 v[124:127], v[64:67], v[248:251], v[124:127]
  v_mfma_f32_16x16x32_bf16 v[144:147], v[64:67], v[24:27], v[144:147]
  ds_read_b128 v[44:47], v31 offset:3072
  v_mfma_f32_16x16x32_bf16 v[88:91], v[68:71], v[200:203], v[88:91]
  v_mfma_f32_16x16x32_bf16 v[108:111], v[68:71], v[204:207], v[108:111]
  ds_read_b128 v[48:51], v31 offset:4096
  v_mfma_f32_16x16x32_bf16 v[128:131], v[68:71], v[248:251], v[128:131]
  v_mfma_f32_16x16x32_bf16 v[148:151], v[68:71], v[24:27], v[148:151]
  s_waitcnt vmcnt(8) lgkmcnt(0)
  s_setprio 0
  v_mfma_f32_16x16x32_bf16 v[72:75], v[208:211], v[152:155], v[72:75]
  s_add_u32 s67, s18, 204800
  v_mfma_f32_16x16x32_bf16 v[92:95], v[208:211], v[156:159], v[92:95]
  buffer_load_dwordx4 v[200:203], v16, s[48:51], s67 offen sc1
  v_mfma_f32_16x16x32_bf16 v[112:115], v[208:211], v[160:163], v[112:115]
  v_mfma_f32_16x16x32_bf16 v[132:135], v[208:211], v[164:167], v[132:135]
  buffer_load_dwordx4 v[204:207], v17, s[48:51], s67 offen sc1
  v_mfma_f32_16x16x32_bf16 v[76:79], v[212:215], v[152:155], v[76:79]
  v_mfma_f32_16x16x32_bf16 v[96:99], v[212:215], v[156:159], v[96:99]
  buffer_load_dwordx4 v[248:251], v18, s[48:51], s67 offen sc1
  v_mfma_f32_16x16x32_bf16 v[116:119], v[212:215], v[160:163], v[116:119]
  v_mfma_f32_16x16x32_bf16 v[136:139], v[212:215], v[164:167], v[136:139]
  buffer_load_dwordx4 v[24:27], v19, s[48:51], s67 offen sc1
  v_mfma_f32_16x16x32_bf16 v[80:83], v[216:219], v[152:155], v[80:83]
  s_add_u32 s4, s20, 2048000
  v_mfma_f32_16x16x32_bf16 v[100:103], v[216:219], v[156:159], v[100:103]
  buffer_load_dwordx4 v[52:55], v20, s[48:51], s4 offen offset:0 sc1
  v_mfma_f32_16x16x32_bf16 v[120:123], v[216:219], v[160:163], v[120:123]
  v_mfma_f32_16x16x32_bf16 v[140:143], v[216:219], v[164:167], v[140:143]
  buffer_load_dwordx4 v[56:59], v20, s[48:51], s4 offen offset:1024 sc1
  v_mfma_f32_16x16x32_bf16 v[84:87], v[220:223], v[152:155], v[84:87]
  v_mfma_f32_16x16x32_bf16 v[104:107], v[220:223], v[156:159], v[104:107]
  buffer_load_dwordx4 v[60:63], v20, s[48:51], s4 offen offset:2048 sc1
  v_mfma_f32_16x16x32_bf16 v[124:127], v[220:223], v[160:163], v[124:127]
  v_mfma_f32_16x16x32_bf16 v[144:147], v[220:223], v[164:167], v[144:147]
  buffer_load_dwordx4 v[64:67], v20, s[48:51], s4 offen offset:3072 sc1
  v_mfma_f32_16x16x32_bf16 v[88:91], v[224:227], v[152:155], v[88:91]
  v_mfma_f32_16x16x32_bf16 v[108:111], v[224:227], v[156:159], v[108:111]
  buffer_load_dwordx4 v[68:71], v21, s[48:51], s4 offen sc1
  v_mfma_f32_16x16x32_bf16 v[128:131], v[224:227], v[160:163], v[128:131]
  v_mfma_f32_16x16x32_bf16 v[148:151], v[224:227], v[164:167], v[148:151]
  s_waitcnt vmcnt(13)
  v_mfma_f32_16x16x32_bf16 v[72:75], v[228:231], v[168:171], v[72:75]
  s_add_u32 s67, s18, 221184
  v_mfma_f32_16x16x32_bf16 v[92:95], v[228:231], v[172:175], v[92:95]
  buffer_load_dwordx4 v[152:155], v16, s[48:51], s67 offen sc1
  v_mfma_f32_16x16x32_bf16 v[112:115], v[228:231], v[176:179], v[112:115]
  v_mfma_f32_16x16x32_bf16 v[132:135], v[228:231], v[180:183], v[132:135]
  buffer_load_dwordx4 v[156:159], v17, s[48:51], s67 offen sc1
  v_mfma_f32_16x16x32_bf16 v[76:79], v[232:235], v[168:171], v[76:79]
  v_mfma_f32_16x16x32_bf16 v[96:99], v[232:235], v[172:175], v[96:99]
  buffer_load_dwordx4 v[160:163], v18, s[48:51], s67 offen sc1
  v_mfma_f32_16x16x32_bf16 v[116:119], v[232:235], v[176:179], v[116:119]
  v_mfma_f32_16x16x32_bf16 v[136:139], v[232:235], v[180:183], v[136:139]
  buffer_load_dwordx4 v[164:167], v19, s[48:51], s67 offen sc1
  v_mfma_f32_16x16x32_bf16 v[80:83], v[236:239], v[168:171], v[80:83]
  s_add_u32 s4, s20, 2211840
  v_mfma_f32_16x16x32_bf16 v[100:103], v[236:239], v[172:175], v[100:103]
  buffer_load_dwordx4 v[208:211], v20, s[48:51], s4 offen offset:0 sc1
  v_mfma_f32_16x16x32_bf16 v[120:123], v[236:239], v[176:179], v[120:123]
  v_mfma_f32_16x16x32_bf16 v[140:143], v[236:239], v[180:183], v[140:143]
  buffer_load_dwordx4 v[212:215], v20, s[48:51], s4 offen offset:1024 sc1
  v_mfma_f32_16x16x32_bf16 v[84:87], v[240:243], v[168:171], v[84:87]
  v_mfma_f32_16x16x32_bf16 v[104:107], v[240:243], v[172:175], v[104:107]
  buffer_load_dwordx4 v[216:219], v20, s[48:51], s4 offen offset:2048 sc1
  v_mfma_f32_16x16x32_bf16 v[124:127], v[240:243], v[176:179], v[124:127]
  v_mfma_f32_16x16x32_bf16 v[144:147], v[240:243], v[180:183], v[144:147]
  buffer_load_dwordx4 v[220:223], v20, s[48:51], s4 offen offset:3072 sc1
  v_mfma_f32_16x16x32_bf16 v[88:91], v[244:247], v[168:171], v[88:91]
  v_mfma_f32_16x16x32_bf16 v[108:111], v[244:247], v[172:175], v[108:111]
  buffer_load_dwordx4 v[224:227], v21, s[48:51], s4 offen sc1
  v_mfma_f32_16x16x32_bf16 v[128:131], v[244:247], v[176:179], v[128:131]
  v_mfma_f32_16x16x32_bf16 v[148:151], v[244:247], v[180:183], v[148:151]
  s_waitcnt vmcnt(18)
  v_mfma_f32_16x16x32_bf16 v[72:75], v[32:35], v[184:187], v[72:75]
  v_mfma_f32_16x16x32_bf16 v[92:95], v[32:35], v[188:191], v[92:95]
  v_mfma_f32_16x16x32_bf16 v[112:115], v[32:35], v[192:195], v[112:115]
  v_mfma_f32_16x16x32_bf16 v[132:135], v[32:35], v[196:199], v[132:135]
  v_mfma_f32_16x16x32_bf16 v[76:79], v[36:39], v[184:187], v[76:79]
  v_mfma_f32_16x16x32_bf16 v[96:99], v[36:39], v[188:191], v[96:99]
  v_mfma_f32_16x16x32_bf16 v[116:119], v[36:39], v[192:195], v[116:119]
  v_mfma_f32_16x16x32_bf16 v[136:139], v[36:39], v[196:199], v[136:139]
  v_mfma_f32_16x16x32_bf16 v[80:83], v[40:43], v[184:187], v[80:83]
  v_mfma_f32_16x16x32_bf16 v[100:103], v[40:43], v[188:191], v[100:103]
  v_mfma_f32_16x16x32_bf16 v[120:123], v[40:43], v[192:195], v[120:123]
  v_mfma_f32_16x16x32_bf16 v[140:143], v[40:43], v[196:199], v[140:143]
  v_mfma_f32_16x16x32_bf16 v[84:87], v[44:47], v[184:187], v[84:87]
  v_mfma_f32_16x16x32_bf16 v[104:107], v[44:47], v[188:191], v[104:107]
  v_mfma_f32_16x16x32_bf16 v[124:127], v[44:47], v[192:195], v[124:127]
  v_mfma_f32_16x16x32_bf16 v[144:147], v[44:47], v[196:199], v[144:147]
  v_mfma_f32_16x16x32_bf16 v[88:91], v[48:51], v[184:187], v[88:91]
  v_mfma_f32_16x16x32_bf16 v[108:111], v[48:51], v[188:191], v[108:111]
  v_mfma_f32_16x16x32_bf16 v[128:131], v[48:51], v[192:195], v[128:131]
  v_mfma_f32_16x16x32_bf16 v[148:151], v[48:51], v[196:199], v[148:151]
  s_waitcnt vmcnt(9)
  v_mfma_f32_16x16x32_bf16 v[72:75], v[52:55], v[200:203], v[72:75]
  v_mfma_f32_16x16x32_bf16 v[92:95], v[52:55], v[204:207], v[92:95]
  v_mfma_f32_16x16x32_bf16 v[112:115], v[52:55], v[248:251], v[112:115]
  v_mfma_f32_16x16x32_bf16 v[132:135], v[52:55], v[24:27], v[132:135]
  v_mfma_f32_16x16x32_bf16 v[76:79], v[56:59], v[200:203], v[76:79]
  v_mfma_f32_16x16x32_bf16 v[96:99], v[56:59], v[204:207], v[96:99]
  v_mfma_f32_16x16x32_bf16 v[116:119], v[56:59], v[248:251], v[116:119]
  v_mfma_f32_16x16x32_bf16 v[136:139], v[56:59], v[24:27], v[136:139]
  v_mfma_f32_16x16x32_bf16 v[80:83], v[60:63], v[200:203], v[80:83]
  v_mfma_f32_16x16x32_bf16 v[100:103], v[60:63], v[204:207], v[100:103]
  v_mfma_f32_16x16x32_bf16 v[120:123], v[60:63], v[248:251], v[120:123]
  v_mfma_f32_16x16x32_bf16 v[140:143], v[60:63], v[24:27], v[140:143]
  v_mfma_f32_16x16x32_bf16 v[84:87], v[64:67], v[200:203], v[84:87]
  v_mfma_f32_16x16x32_bf16 v[104:107], v[64:67], v[204:207], v[104:107]
  v_mfma_f32_16x16x32_bf16 v[124:127], v[64:67], v[248:251], v[124:127]
  v_mfma_f32_16x16x32_bf16 v[144:147], v[64:67], v[24:27], v[144:147]
  v_mfma_f32_16x16x32_bf16 v[88:91], v[68:71], v[200:203], v[88:91]
  v_mfma_f32_16x16x32_bf16 v[108:111], v[68:71], v[204:207], v[108:111]
  v_mfma_f32_16x16x32_bf16 v[128:131], v[68:71], v[248:251], v[128:131]
  v_mfma_f32_16x16x32_bf16 v[148:151], v[68:71], v[24:27], v[148:151]
LW_64:
  ds_read_b32 v3, v14 offset:4
  s_waitcnt lgkmcnt(0)
  v_readfirstlane_b32 s67, v3
  s_nop 0
  s_cmp_ge_u32 s67, 4
  s_cbranch_scc1 LW_64d
  s_sleep 1
  s_branch LW_64
LW_64d:
  ds_read_b128 v[228:231], v12 offset:0
  ds_read_b128 v[232:235], v12 offset:1024
  ds_read_b128 v[236:239], v12 offset:2048
  ds_read_b128 v[240:243], v12 offset:3072
  ds_read_b128 v[244:247], v12 offset:4096
  ds_read_b128 v[32:35], v12 offset:5120
  ds_read_b128 v[36:39], v12 offset:6144
  ds_read_b128 v[40:43], v12 offset:7168
  ds_read_b128 v[44:47], v12 offset:8192
  ds_read_b128 v[48:51], v12 offset:9216
  s_waitcnt vmcnt(0)
  v_mfma_f32_16x16x32_bf16 v[92:95], v[208:211], v[156:159], v[92:95]
  ds_read_b128 v[52:55], v12 offset:10240
  v_mfma_f32_16x16x32_bf16 v[96:99], v[212:215], v[156:159], v[96:99]
  ds_read_b128 v[56:59], v12 offset:11264
  v_mfma_f32_16x16x32_bf16 v[100:103], v[216:219], v[156:159], v[100:103]
  ds_read_b128 v[60:63], v12 offset:12288
  v_mfma_f32_16x16x32_bf16 v[104:107], v[220:223], v[156:159], v[104:107]
  ds_read_b128 v[64:67], v12 offset:13312
  v_mfma_f32_16x16x32_bf16 v[108:111], v[224:227], v[156:159], v[108:111]
  ds_read_b128 v[68:71], v12 offset:14336
  v_mfma_f32_16x16x32_bf16 v[112:115], v[208:211], v[160:163], v[112:115]
  ds_read_b128 v[168:171], v12 offset:15360
  v_mfma_f32_16x16x32_bf16 v[116:119], v[212:215], v[160:163], v[116:119]
  ds_read_b128 v[172:175], v12 offset:16384
  v_mfma_f32_16x16x32_bf16 v[120:123], v[216:219], v[160:163], v[120:123]
  ds_read_b128 v[176:179], v12 offset:17408
  v_mfma_f32_16x16x32_bf16 v[124:127], v[220:223], v[160:163], v[124:127]
  ds_read_b128 v[180:183], v12 offset:18432
  v_mfma_f32_16x16x32_bf16 v[128:131], v[224:227], v[160:163], v[128:131]
  ds_read_b128 v[184:187], v12 offset:19456
  v_mfma_f32_16x16x32_bf16 v[132:135], v[208:211], v[164:167], v[132:135]
  ds_write_b128 v15, v[92:95] offset:0
  v_mfma_f32_16x16x32_bf16 v[136:139], v[212:215], v[164:167], v[136:139]
  ds_write_b128 v15, v[96:99] offset:1024
  v_mfma_f32_16x16x32_bf16 v[140:143], v[216:219], v[164:167], v[140:143]
  ds_write_b128 v15, v[100:103] offset:2048
  v_mfma_f32_16x16x32_bf16 v[144:147], v[220:223], v[164:167], v[144:147]
  ds_write_b128 v15, v[104:107] offset:3072
  v_mfma_f32_16x16x32_bf16 v[148:151], v[224:227], v[164:167], v[148:151]
  ds_write_b128 v15, v[108:111] offset:4096
  v_mfma_f32_16x16x32_bf16 v[72:75], v[208:211], v[152:155], v[72:75]
  ds_write_b128 v15, v[112:115] offset:20480
  v_mfma_f32_16x16x32_bf16 v[76:79], v[212:215], v[152:155], v[76:79]
  ds_write_b128 v15, v[116:119] offset:21504
  v_mfma_f32_16x16x32_bf16 v[80:83], v[216:219], v[152:155], v[80:83]
  ds_write_b128 v15, v[120:123] offset:22528
  v_mfma_f32_16x16x32_bf16 v[84:87], v[220:223], v[152:155], v[84:87]
  ds_write_b128 v15, v[124:127] offset:23552
  v_mfma_f32_16x16x32_bf16 v[88:91], v[224:227], v[152:155], v[88:91]
  ds_write_b128 v15, v[128:131] offset:24576
  ds_write_b128 v31, v[132:135] offset:0
  ds_write_b128 v31, v[136:139] offset:1024
  ds_write_b128 v31, v[140:143] offset:2048
  ds_write_b128 v31, v[144:147] offset:3072
  ds_write_b128 v31, v[148:151] offset:4096
  s_waitcnt lgkmcnt(15)
  v_pk_add_f32 v[228:229], v[228:229], v[32:33]
  v_pk_add_f32 v[52:53], v[52:53], v[168:169]
  v_pk_add_f32 v[230:231], v[230:231], v[34:35]
  v_pk_add_f32 v[54:55], v[54:55], v[170:171]
  v_pk_add_f32 v[232:233], v[232:233], v[36:37]
  v_pk_add_f32 v[56:57], v[56:57], v[172:173]
  v_pk_add_f32 v[234:235], v[234:235], v[38:39]
  v_pk_add_f32 v[58:59], v[58:59], v[174:175]
  v_pk_add_f32 v[236:237], v[236:237], v[40:41]
  v_pk_add_f32 v[60:61], v[60:61], v[176:177]
  v_pk_add_f32 v[238:239], v[238:239], v[42:43]
  v_pk_add_f32 v[62:63], v[62:63], v[178:179]
  v_pk_add_f32 v[240:241], v[240:241], v[44:45]
  v_pk_add_f32 v[64:65], v[64:65], v[180:181]
  v_pk_add_f32 v[242:243], v[242:243], v[46:47]
  v_pk_add_f32 v[66:67], v[66:67], v[182:183]
  v_pk_add_f32 v[244:245], v[244:245], v[48:49]
  v_pk_add_f32 v[68:69], v[68:69], v[184:185]
  v_pk_add_f32 v[246:247], v[246:247], v[50:51]
  v_pk_add_f32 v[70:71], v[70:71], v[186:187]
  v_mov_b32 v3, 1
  s_waitcnt lgkmcnt(0)
  s_mov_b64 exec, 1
  ds_add_u32 v14, v3 offset:8
  s_mov_b64 exec, -1
  v_pk_add_f32 v[228:229], v[228:229], v[52:53]
  v_pk_add_f32 v[72:73], v[228:229], v[72:73]
  v_pk_add_f32 v[230:231], v[230:231], v[54:55]
  v_pk_add_f32 v[74:75], v[230:231], v[74:75]
  v_pk_add_f32 v[232:233], v[232:233], v[56:57]
  v_pk_add_f32 v[76:77], v[232:233], v[76:77]
  v_pk_add_f32 v[234:235], v[234:235], v[58:59]
  v_pk_add_f32 v[78:79], v[234:235], v[78:79]
  v_pk_add_f32 v[236:237], v[236:237], v[60:61]
  v_pk_add_f32 v[80:81], v[236:237], v[80:81]
  v_pk_add_f32 v[238:239], v[238:239], v[62:63]
  v_pk_add_f32 v[82:83], v[238:239], v[82:83]
  v_pk_add_f32 v[240:241], v[240:241], v[64:65]
  v_pk_add_f32 v[84:85], v[240:241], v[84:85]
  v_pk_add_f32 v[242:243], v[242:243], v[66:67]
  v_pk_add_f32 v[86:87], v[242:243], v[86:87]
  v_pk_add_f32 v[244:245], v[244:245], v[68:69]
  v_pk_add_f32 v[88:89], v[244:245], v[88:89]
  v_pk_add_f32 v[246:247], v[246:247], v[70:71]
  v_pk_add_f32 v[90:91], v[246:247], v[90:91]
LW_65:
  ds_read_b32 v3, v14 offset:8
  s_waitcnt lgkmcnt(0)
  v_readfirstlane_b32 s67, v3
  s_nop 0
  s_cmp_ge_u32 s67, 4
  s_cbranch_scc1 LW_65d
  s_sleep 1
  s_branch LW_65
LW_65d:
  ds_read_b128 v[92:95], v28 offset:0
  ds_read_b128 v[112:115], v13 offset:0
  ds_read_b128 v[132:135], v30 offset:0
  ds_read_b128 v[96:99], v28 offset:1024
  ds_read_b128 v[116:119], v13 offset:1024
  ds_read_b128 v[136:139], v30 offset:1024
  ds_read_b128 v[100:103], v28 offset:2048
  ds_read_b128 v[120:123], v13 offset:2048
  ds_read_b128 v[140:143], v30 offset:2048
  ds_read_b128 v[104:107], v28 offset:3072
  ds_read_b128 v[124:127], v13 offset:3072
  ds_read_b128 v[144:147], v30 offset:3072
  ds_read_b128 v[108:111], v28 offset:4096
  ds_read_b128 v[128:131], v13 offset:4096
  ds_read_b128 v[148:151], v30 offset:4096
  s_waitcnt lgkmcnt(12)
  v_pk_add_f32 v[92:93], v[92:93], v[112:113]
  v_pk_add_f32 v[72:73], v[72:73], v[132:133]
  v_pk_add_f32 v[94:95], v[94:95], v[114:115]
  v_pk_add_f32 v[74:75], v[74:75], v[134:135]
  v_pk_add_f32 v[72:73], v[72:73], v[92:93]
  v_pk_add_f32 v[74:75], v[74:75], v[94:95]
  v_pk_mul_f32 v[72:73], v[72:73], v[22:23] op_sel_hi:[1,0]
  v_pk_mul_f32 v[74:75], v[74:75], v[22:23] op_sel_hi:[1,0]
  v_cvt_pk_bf16_f32 v32, v72, v73
  v_cvt_pk_bf16_f32 v33, v74, v75
  s_waitcnt lgkmcnt(9)
  v_pk_add_f32 v[96:97], v[96:97], v[116:117]
  v_pk_add_f32 v[76:77], v[76:77], v[136:137]
  v_pk_add_f32 v[98:99], v[98:99], v[118:119]
  v_pk_add_f32 v[78:79], v[78:79], v[138:139]
  v_pk_add_f32 v[76:77], v[76:77], v[96:97]
  v_pk_add_f32 v[78:79], v[78:79], v[98:99]
  v_pk_mul_f32 v[76:77], v[76:77], v[22:23] op_sel_hi:[1,0]
  v_pk_mul_f32 v[78:79], v[78:79], v[22:23] op_sel_hi:[1,0]
  v_cvt_pk_bf16_f32 v34, v76, v77
  v_cvt_pk_bf16_f32 v35, v78, v79
  s_nop 0
  v_permlane16_swap_b32 v32, v34
  v_permlane16_swap_b32 v33, v35
  buffer_store_dwordx4 v[32:35], v5, s[40:43], s69 offen offset:0 nt
  s_waitcnt lgkmcnt(6)
  v_pk_add_f32 v[100:101], v[100:101], v[120:121]
  v_pk_add_f32 v[80:81], v[80:81], v[140:141]
  v_pk_add_f32 v[102:103], v[102:103], v[122:123]
  v_pk_add_f32 v[82:83], v[82:83], v[142:143]
  v_pk_add_f32 v[80:81], v[80:81], v[100:101]
  v_pk_add_f32 v[82:83], v[82:83], v[102:103]
  v_pk_mul_f32 v[80:81], v[80:81], v[22:23] op_sel_hi:[1,0]
  v_pk_mul_f32 v[82:83], v[82:83], v[22:23] op_sel_hi:[1,0]
  v_cvt_pk_bf16_f32 v36, v80, v81
  v_cvt_pk_bf16_f32 v37, v82, v83
  s_waitcnt lgkmcnt(3)
  v_pk_add_f32 v[104:105], v[104:105], v[124:125]
  v_pk_add_f32 v[84:85], v[84:85], v[144:145]
  v_pk_add_f32 v[106:107], v[106:107], v[126:127]
  v_pk_add_f32 v[86:87], v[86:87], v[146:147]
  v_pk_add_f32 v[84:85], v[84:85], v[104:105]
  v_pk_add_f32 v[86:87], v[86:87], v[106:107]
  v_pk_mul_f32 v[84:85], v[84:85], v[22:23] op_sel_hi:[1,0]
  v_pk_mul_f32 v[86:87], v[86:87], v[22:23] op_sel_hi:[1,0]
  v_cvt_pk_bf16_f32 v38, v84, v85
  v_cvt_pk_bf16_f32 v39, v86, v87
  s_nop 0
  v_permlane16_swap_b32 v36, v38
  v_permlane16_swap_b32 v37, v39
  buffer_store_dwordx4 v[36:39], v5, s[40:43], s69 offen offset:64 nt
  s_waitcnt lgkmcnt(0)
  v_pk_add_f32 v[108:109], v[108:109], v[128:129]
  v_pk_add_f32 v[88:89], v[88:89], v[148:149]
  v_pk_add_f32 v[110:111], v[110:111], v[130:131]
  v_pk_add_f32 v[90:91], v[90:91], v[150:151]
  v_pk_add_f32 v[88:89], v[88:89], v[108:109]
  v_pk_add_f32 v[90:91], v[90:91], v[110:111]
  v_pk_mul_f32 v[88:89], v[88:89], v[22:23] op_sel_hi:[1,0]
  v_pk_mul_f32 v[90:91], v[90:91], v[22:23] op_sel_hi:[1,0]
  v_cvt_pk_bf16_f32 v40, v88, v89
  v_cvt_pk_bf16_f32 v41, v90, v91
  buffer_store_dwordx2 v[40:41], v2, s[40:43], s69 offen offset:128 nt
P2_FIN:
K_END:
K_LAST:
  s_endpgm
.section .rodata,"a"
.p2align 6
.amdhsa_kernel gated_mix__linear_kernel_hedgehog__swiglu_ffn__prompt_kernel
  .amdhsa_next_free_vgpr 256
  .amdhsa_next_free_sgpr 102
  .amdhsa_accum_offset 256
  .amdhsa_group_segment_fixed_size 0
  .amdhsa_kernarg_size 96
  .amdhsa_user_sgpr_count 2
  .amdhsa_user_sgpr_kernarg_segment_ptr 1
  .amdhsa_system_sgpr_workgroup_id_x 1
.end_amdhsa_kernel
```
